```python
import torch

def _softmax(x, axis=-1):
    return torch.softmax(x, dim=axis)
def _gelu(x):
    return torch.nn.functional.gelu(x, approximate="tanh")
def _silu(x):
    return torch.nn.functional.silu(x)
def _sigmoid(x):
    return torch.sigmoid(x)
def _layernorm(x, axis=-1, eps=1e-5):
    m = x.mean(dim=axis, keepdim=True)
    v = x.var(dim=axis, keepdim=True, unbiased=False)
    return (x - m) / torch.sqrt(v + eps)
def _scatter_add(tgt, idx, src, axis=0):
    return tgt.clone().index_add_(axis, idx, src)
def _segment_sum(src, seg, n):
    out = torch.zeros((n,) + src.shape[1:], dtype=src.dtype)
    return out.index_add_(0, seg, src)
def _pad(x, pw):
    flat = tuple(v for pair in reversed(pw) for v in pair)
    return torch.nn.functional.pad(x, flat)

kernel_name = 'sequential_preLN__mha_block_cached__mixer_channel_mlp__decode'

def setup_inputs():

    _w = (lambda a: (lambda t: t.to(torch.bfloat16) if t.is_floating_point() else t)(torch.as_tensor(a)))
    def _A_setup():
        B, Sq, D = 8, 1, 448
        H, Sk, Dh = 16, 4096, 256
        return {
            "x": _w((lambda *s: torch.randn(*s, dtype=torch.bfloat16) * 0.05)(B, Sq, D)),
            "k_cache": _w((lambda *s: torch.randn(*s, dtype=torch.bfloat16) * 3.2)(B, H, Sk, Dh)),
            "v_cache": _w((lambda *s: torch.randn(*s, dtype=torch.bfloat16) * 0.4)(B, H, Sk, Dh)),
            "wq": _w((lambda *s: torch.randn(*s, dtype=torch.bfloat16) * 3.2)(D, H * Dh) * (D ** -0.5)),
            "wo": _w((lambda *s: torch.randn(*s, dtype=torch.bfloat16) * 0.4)(H * Dh, D) * ((H * Dh) ** -0.5)),
        }
    _A_in = _A_setup()

    def _B_setup():
        B, S, D, F = 8, 1, 448, 1792
        return {
            "x": _w((lambda *s: torch.randn(*s, dtype=torch.bfloat16) * 0.05)(B, S, D)),
            "w1": _w((lambda *s: torch.randn(*s, dtype=torch.bfloat16) * 3.2)(D, F) * (D ** -0.5)),
            "b1": _w((lambda *s: torch.randn(*s, dtype=torch.bfloat16) * 1.6)(F)),
            "w2": _w((lambda *s: torch.randn(*s, dtype=torch.bfloat16) * 0.8)(F, D) * (F ** -0.5)),
            "b2": _w((lambda *s: torch.randn(*s, dtype=torch.bfloat16) * 1.6)(D)),
        }
    _B_in = _B_setup()

    return {
        "A_x": _A_in["x"],
        "A_k_cache": _A_in["k_cache"],
        "A_v_cache": _A_in["v_cache"],
        "A_wq": _A_in["wq"],
        "A_wo": _A_in["wo"],
        "B_x": _B_in["x"],
        "B_w1": _B_in["w1"],
        "B_b1": _B_in["b1"],
        "B_w2": _B_in["w2"],
        "B_b2": _B_in["b2"],
    }

def reference(A_x, A_k_cache, A_v_cache, A_wq, A_wo, B_x, B_w1, B_b1, B_w2, B_b2):
    def _A_ref(x, k_cache, v_cache, wq, wo):
        B, Sq, D = x.shape
        H, Dh = 16, 256
        q = (lambda x, *d: x.permute(*d))((x @ wq).reshape(B, Sq, H, Dh), 0, 2, 1, 3)
        scores = torch.einsum("bhqd,bhkd->bhqk", q, k_cache) * (Dh ** -0.5)
        p = _softmax(scores, axis=-1)
        o = torch.einsum("bhqk,bhkd->bhqd", p, v_cache)
        return (lambda x, *d: x.permute(*d))(o, 0, 2, 1, 3).reshape(B, Sq, H * Dh) @ wo

    def _B_ref(x, w1, b1, w2, b2):
        y = _layernorm(x, axis=-1)
        h = _gelu(torch.einsum("bsd,df->bsf", y, w1) + b1)
        return torch.einsum("bsf,fd->bsd", h, w2) + b2

    x = A_x
    h = x + _A_ref(_layernorm(x, axis=-1), A_k_cache, A_v_cache, A_wq, A_wo)
    h2 = h + _B_ref(_layernorm(h, axis=-1), B_w1, B_b1, B_w2, B_b2)
    return h2
```

```asm
; @launch grid=(256,1,1) block=(256,1,1) lds=16384
.amdgcn_target "amdgcn-amd-amdhsa--gfx950"
.text
.globl sequential_preLN__mha_block_cached__mixer_channel_mlp__decode_kernel
.p2align 8
.type sequential_preLN__mha_block_cached__mixer_channel_mlp__decode_kernel,@function
sequential_preLN__mha_block_cached__mixer_channel_mlp__decode_kernel:
    s_cmp_ge_u32 s2, 256
    s_cbranch_scc1 L_end
    s_load_dwordx16 s[36:51], s[0:1], 0
    s_load_dwordx8 s[52:59], s[0:1], 64
    s_load_dwordx2 s[60:61], s[0:1], 96
    v_lshrrev_b32 v2, 6, v0
    v_and_b32 v0, 63, v0
    v_readfirstlane_b32 s62, v2
    s_and_b32 s63, s2, 7
    s_lshl_b32 s63, s63, 5
    s_lshr_b32 s71, s2, 3
    s_add_u32 s63, s63, s71
    s_lshr_b32 s64, s63, 4
    s_bfe_u32 s65, s63, 0x30001
    s_and_b32 s71, s63, 1
    s_lshl_b32 s66, s64, 1
    s_add_u32 s66, s66, s71
    v_lshrrev_b32 v2, 4, v0
    v_and_b32 v3, 15, v0
    v_lshlrev_b32 v4, 4, v3
    v_and_b32 v5, 1, v2
    v_lshl_add_u32 v1, v5, 10, v4
    v_lshrrev_b32 v5, 1, v2
    v_lshl_add_u32 v1, v5, 13, v1
    s_and_b32 s71, s62, 1
    s_lshl_b32 s71, s71, 12
    s_lshr_b32 s72, s62, 1
    s_lshl_b32 s72, s72, 16
    s_or_b32 s71, s71, s72
    v_add_u32 v1, s71, v1
    s_mul_i32 s71, s62, 917504
    v_lshl_add_u32 v5, v2, 15, v4
    v_add_u32 v5, s71, v5
    v_lshrrev_b32 v7, 2, v3
    v_lshl_add_u32 v7, v7, 2, v2
    v_and_b32 v6, 3, v3
    v_lshl_add_u32 v7, v7, 2, v6
    v_lshlrev_b32 v6, 4, v0
    s_mul_i32 s71, s62, 112
    v_add_u32 v7, s71, v7
    v_lshlrev_b32 v7, 1, v7
    s_lshl_b32 s72, s65, 5
    s_add_u32 s72, s72, s66
    s_lshl_b32 s72, s72, 20
    s_mov_b32 s69, 0
    s_bitcmp1_b32 s63, 2
    s_cselect_b32 s71, 16384, 0
    s_xor_b32 s69, s69, s71
    s_bitcmp1_b32 s63, 0
    s_cselect_b32 s71, 131072, 0
    s_xor_b32 s69, s69, s71
    s_and_b32 s71, s63, 132
    s_bcnt1_i32_b32 s71, s71
    s_bitcmp1_b32 s71, 0
    s_cselect_b32 s71, 524288, 0
    s_xor_b32 s69, s69, s71
    s_mov_b32 s6, 1048576
    s_mov_b32 s7, 0x20000
    s_waitcnt lgkmcnt(0)
    s_add_u32 s4, s38, s72
    s_addc_u32 s5, s39, 0
    s_and_b32 s5, s5, 0xffff
    s_xor_b32 s68, s69, 0x0
    buffer_load_dwordx4 a[0:3], v1, s[4:7], s68 offen nt
    buffer_load_dwordx4 a[4:7], v1, s[4:7], s68 offen offset:256 nt
    s_xor_b32 s68, s69, 0x800
    buffer_load_dwordx4 a[8:11], v1, s[4:7], s68 offen nt
    buffer_load_dwordx4 a[12:15], v1, s[4:7], s68 offen offset:256 nt
    s_add_u32 s3, s66, 0
    s_and_b32 s3, s3, 31
    s_min_u32 s67, s3, 27
    s_mul_i32 s71, s65, 896
    s_add_u32 s28, s36, s71
    s_addc_u32 s29, s37, 0
    s_and_b32 s29, s29, 0xffff
    s_mov_b32 s30, 896
    s_mov_b32 s31, 0x20000
    buffer_load_dwordx4 v[62:65], v6, s[28:31], 0 offen nt
    buffer_load_ushort v22, v7, s[28:31], 0 offen nt
    buffer_load_ushort v23, v7, s[28:31], 0 offen offset:128 nt
    s_lshl_b32 s71, s64, 9
    s_add_u32 s12, s42, s71
    s_addc_u32 s13, s43, 0
    s_and_b32 s13, s13, 0xffff
    s_mov_b32 s14, 0
    s_mov_b32 s15, 0x20000
    s_sub_u32 s14, 3670016, s71
    s_mov_b32 s71, 0
    buffer_load_dwordx4 v[136:139], v5, s[12:15], s71 offen
    buffer_load_dwordx4 v[140:143], v5, s[12:15], s71 offen offset:256
    s_xor_b32 s68, s69, 0x200
    buffer_load_dwordx4 a[16:19], v1, s[4:7], s68 offen nt
    buffer_load_dwordx4 a[20:23], v1, s[4:7], s68 offen offset:256 nt
    s_xor_b32 s68, s69, 0xa00
    buffer_load_dwordx4 a[24:27], v1, s[4:7], s68 offen nt
    s_and_b32 s96, s63, 31
    s_lshl_b32 s96, s96, 2
    s_add_u32 s96, s96, s62
    s_lshr_b32 s97, s63, 5
    s_mov_b32 s27, 0x20000
    s_cmp_ge_u32 s96, 96
    s_cbranch_scc1 L_bw1
    s_cmp_ge_u32 s96, 64
    s_cbranch_scc1 L_bw2
    s_mov_b32 s24, s44
    s_and_b32 s25, s45, 0xffff
    s_mul_i32 s98, s97, 458752
    s_add_u32 s26, s98, 458752
    s_lshl_b32 s96, s96, 9
    s_add_u32 s98, s98, s96
    v_lshrrev_b32 v7, 2, v0
    v_and_b32 v8, 3, v0
    v_lshlrev_b32 v7, 15, v7
    s_branch L_bgo
L_bw2:
    s_lshr_b32 s97, s3, 2
    s_mov_b32 s24, s52
    s_and_b32 s25, s53, 0xffff
    s_mul_i32 s98, s97, 229376
    s_add_u32 s26, s98, 229376
    s_min_u32 s26, s26, 1605632
    s_sub_u32 s96, s96, 64
    s_lshl_b32 s96, s96, 10
    s_add_u32 s98, s98, s96
    v_lshrrev_b32 v7, 3, v0
    v_and_b32 v8, 7, v0
    v_lshlrev_b32 v7, 15, v7
    s_branch L_bgo
L_bw1:
    s_lshr_b32 s97, s3, 2
    s_mov_b32 s24, s48
    s_and_b32 s25, s49, 0xffff
    s_cmp_eq_u32 s97, 7
    s_cselect_b32 s26, 0, 1605632
    s_sub_u32 s96, s96, 96
    s_mul_i32 s98, s96, 57344
    s_lshl_b32 s97, s97, 9
    s_add_u32 s98, s98, s97
    v_lshrrev_b32 v7, 2, v0
    v_and_b32 v8, 3, v0
    v_mul_u32_u24 v7, 3584, v7
L_bgo:
    v_lshl_add_u32 v7, v8, 7, v7
    buffer_load_dword v71, v7, s[24:27], s98 offen
    s_mov_b32 s32, s60
    s_and_b32 s33, s61, 0xffff
    s_mov_b32 s34, 2097152
    s_mov_b32 s35, 0x20000
    s_lshl_b32 s96, s63, 2
    s_add_u32 s96, s96, s62
    s_lshl_b32 s97, s96, 9
    s_lshl_b32 s96, s96, 5
    v_and_b32 v7, 3, v0
    v_lshlrev_b32 v7, 7, v7
    v_add_u32 v7, s97, v7
    v_bfe_u32 v8, v0, 2, 1
    v_mul_u32_u24 v8, 0xf0000, v8
    s_add_u32 s96, s96, 32768
    s_mov_b32 s97, 65536
    v_add3_u32 v7, v7, v8, s97
    v_writelane_b32 v7, s96, 8
    s_mov_b64 exec, 0x1ff
    buffer_load_dword v70, v7, s[32:35], 0 offen sc1
    s_mov_b64 exec, -1
    s_mov_b32 s71, 8192
    buffer_load_dwordx4 v[144:147], v5, s[12:15], s71 offen
    buffer_load_dwordx4 v[148:151], v5, s[12:15], s71 offen offset:256
    buffer_load_dwordx4 a[28:31], v1, s[4:7], s68 offen offset:256 nt
    s_xor_b32 s68, s69, 0x8000
    buffer_load_dwordx4 a[32:35], v1, s[4:7], s68 offen nt
    buffer_load_dwordx4 a[36:39], v1, s[4:7], s68 offen offset:256 nt
    s_add_u32 s8, s40, s72
    s_addc_u32 s9, s41, 0
    s_and_b32 s9, s9, 0xffff
    s_mov_b32 s10, 1048576
    s_mov_b32 s11, 0x20000
    s_lshl_b32 s71, s65, 7
    s_load_dword s73, s[60:61], s71
    s_mov_b32 s71, 16384
    buffer_load_dwordx4 v[152:155], v5, s[12:15], s71 offen
    buffer_load_dwordx4 v[156:159], v5, s[12:15], s71 offen offset:256
    s_xor_b32 s68, s69, 0x8800
    buffer_load_dwordx4 a[40:43], v1, s[4:7], s68 offen nt
    buffer_load_dwordx4 a[44:47], v1, s[4:7], s68 offen offset:256 nt
    s_xor_b32 s68, s69, 0x8200
    buffer_load_dwordx4 a[48:51], v1, s[4:7], s68 offen nt
    s_mov_b32 s76, 0xffff0000
    s_mov_b32 s77, 0xffffff00
    s_mov_b32 s75, 0x3db8aa3b
    v_and_b32 v8, 1, v0
    v_lshlrev_b32 v8, 4, v8
    v_mov_b32 v4, 0xffff
    v_lshlrev_b32 v4, v8, v4
    v_bfe_u32 v8, v0, 1, 2
    v_cmp_eq_u32 vcc, 0, v8
    s_nop 1
    v_cndmask_b32 v10, 0, v4, vcc
    v_cmp_eq_u32 vcc, 1, v8
    s_nop 1
    v_cndmask_b32 v11, 0, v4, vcc
    v_cmp_eq_u32 vcc, 2, v8
    s_nop 1
    v_cndmask_b32 v12, 0, v4, vcc
    v_cmp_eq_u32 vcc, 3, v8
    s_nop 1
    v_cndmask_b32 v13, 0, v4, vcc
    s_waitcnt vmcnt(17)
    v_lshlrev_b32 v38, 16, v62
    v_and_b32 v39, s76, v62
    v_lshlrev_b32 v40, 16, v63
    v_and_b32 v41, s76, v63
    v_lshlrev_b32 v42, 16, v64
    v_and_b32 v43, s76, v64
    v_lshlrev_b32 v44, 16, v65
    v_and_b32 v45, s76, v65
    v_lshlrev_b32 v22, 16, v22
    v_lshlrev_b32 v23, 16, v23
    v_readlane_b32 s71, v38, 0
    v_mov_b32 v46, 0
    v_mov_b32 v47, 0
    s_mov_b32 exec_hi, 0x00ffffff
    v_subrev_f32 v48, s71, v38
    v_add_f32 v46, v46, v48
    v_fmac_f32 v47, v48, v48
    v_subrev_f32 v48, s71, v39
    v_add_f32 v46, v46, v48
    v_fmac_f32 v47, v48, v48
    v_subrev_f32 v48, s71, v40
    v_add_f32 v46, v46, v48
    v_fmac_f32 v47, v48, v48
    v_subrev_f32 v48, s71, v41
    v_add_f32 v46, v46, v48
    v_fmac_f32 v47, v48, v48
    v_subrev_f32 v48, s71, v42
    v_add_f32 v46, v46, v48
    v_fmac_f32 v47, v48, v48
    v_subrev_f32 v48, s71, v43
    v_add_f32 v46, v46, v48
    v_fmac_f32 v47, v48, v48
    v_subrev_f32 v48, s71, v44
    v_add_f32 v46, v46, v48
    v_fmac_f32 v47, v48, v48
    v_subrev_f32 v48, s71, v45
    v_add_f32 v46, v46, v48
    v_fmac_f32 v47, v48, v48
    s_mov_b32 exec_hi, -1
    s_nop 0
    v_add_f32_dpp v46, v46, v46 row_ror:8 row_mask:0xf bank_mask:0xf
    v_add_f32_dpp v47, v47, v47 row_ror:8 row_mask:0xf bank_mask:0xf
    s_nop 0
    v_add_f32_dpp v46, v46, v46 row_ror:4 row_mask:0xf bank_mask:0xf
    v_add_f32_dpp v47, v47, v47 row_ror:4 row_mask:0xf bank_mask:0xf
    s_nop 0
    v_add_f32_dpp v46, v46, v46 row_ror:2 row_mask:0xf bank_mask:0xf
    v_add_f32_dpp v47, v47, v47 row_ror:2 row_mask:0xf bank_mask:0xf
    s_nop 0
    v_add_f32_dpp v46, v46, v46 row_ror:1 row_mask:0xf bank_mask:0xf
    v_add_f32_dpp v47, v47, v47 row_ror:1 row_mask:0xf bank_mask:0xf
    v_mov_b32 v48, v46
    v_mov_b32 v49, v47
    s_nop 1
    v_permlane16_swap_b32 v48, v46
    v_permlane16_swap_b32 v49, v47
    s_nop 1
    v_add_f32 v46, v46, v48
    v_add_f32 v47, v47, v49
    v_mov_b32 v48, v46
    v_mov_b32 v49, v47
    s_nop 1
    v_permlane32_swap_b32 v48, v46
    v_permlane32_swap_b32 v49, v47
    s_nop 1
    v_add_f32 v46, v46, v48
    v_add_f32 v47, v47, v49
    v_mul_f32 v46, 0x3b124925, v46
    v_mul_f32 v47, 0x3b124925, v47
    v_fma_f32 v47, -v46, v46, v47
    v_add_f32 v46, s71, v46
    v_max_f32 v47, 0, v47
    v_cvt_pk_bf16_f32 v46, v46, v46
    v_and_b32 v46, s76, v46
    v_cvt_pk_bf16_f32 v47, v47, v47
    v_and_b32 v47, s76, v47
    v_add_f32 v47, 0x3727c5ac, v47
    v_cvt_pk_bf16_f32 v47, v47, v47
    v_and_b32 v47, s76, v47
    v_sqrt_f32 v47, v47
    s_nop 0
    v_cvt_pk_bf16_f32 v47, v47, v47
    v_and_b32 v47, s76, v47
    v_rcp_f32 v47, v47
    s_nop 0
    v_sub_f32 v22, v22, v46
    v_cvt_pk_bf16_f32 v22, v22, v22
    v_and_b32 v22, s76, v22
    v_mul_f32 v22, v22, v47
    v_cvt_pk_bf16_f32 v22, v22, v22
    v_sub_f32 v23, v23, v46
    v_cvt_pk_bf16_f32 v23, v23, v23
    v_and_b32 v23, s76, v23
    v_mul_f32 v23, v23, v47
    v_cvt_pk_bf16_f32 v23, v23, v23
    s_nop 1
    v_and_b32_dpp v62, v22, v10 row_newbcast:0 row_mask:0xf bank_mask:0xf
    v_and_b32_dpp v63, v22, v11 row_newbcast:0 row_mask:0xf bank_mask:0xf
    v_and_b32_dpp v64, v22, v12 row_newbcast:0 row_mask:0xf bank_mask:0xf
    v_and_b32_dpp v65, v22, v13 row_newbcast:0 row_mask:0xf bank_mask:0xf
    s_nop 0
    s_waitcnt vmcnt(16)
    v_mfma_f32_16x16x32_bf16 v[54:57], v[62:65], v[136:139], 0
    s_waitcnt vmcnt(15)
    v_mfma_f32_16x16x32_bf16 v[58:61], v[62:65], v[140:143], 0
    s_mov_b32 s71, 24576
    buffer_load_dwordx4 v[136:139], v5, s[12:15], s71 offen
    buffer_load_dwordx4 v[140:143], v5, s[12:15], s71 offen offset:256
    buffer_load_dwordx4 a[52:55], v1, s[4:7], s68 offen offset:256 nt
    s_xor_b32 s68, s69, 0x8a00
    buffer_load_dwordx4 a[56:59], v1, s[4:7], s68 offen nt
    buffer_load_dwordx4 a[60:63], v1, s[4:7], s68 offen offset:256 nt
    v_and_b32_dpp v66, v22, v10 row_newbcast:1 row_mask:0xf bank_mask:0xf
    v_and_b32_dpp v67, v22, v11 row_newbcast:1 row_mask:0xf bank_mask:0xf
    v_and_b32_dpp v68, v22, v12 row_newbcast:1 row_mask:0xf bank_mask:0xf
    v_and_b32_dpp v69, v22, v13 row_newbcast:1 row_mask:0xf bank_mask:0xf
    s_nop 0
    s_waitcnt vmcnt(14)
    v_mfma_f32_16x16x32_bf16 v[54:57], v[66:69], v[144:147], v[54:57]
    s_waitcnt vmcnt(13)
    v_mfma_f32_16x16x32_bf16 v[58:61], v[66:69], v[148:151], v[58:61]
    s_mov_b32 s71, 131072
    buffer_load_dwordx4 v[144:147], v5, s[12:15], s71 offen
    buffer_load_dwordx4 v[148:151], v5, s[12:15], s71 offen offset:256
    s_xor_b32 s68, s69, 0x40000
    buffer_load_dwordx4 a[64:67], v1, s[4:7], s68 offen nt
    buffer_load_dwordx4 a[68:71], v1, s[4:7], s68 offen offset:256 nt
    s_xor_b32 s68, s69, 0x40800
    buffer_load_dwordx4 a[72:75], v1, s[4:7], s68 offen nt
    v_and_b32_dpp v62, v22, v10 row_newbcast:2 row_mask:0xf bank_mask:0xf
    v_and_b32_dpp v63, v22, v11 row_newbcast:2 row_mask:0xf bank_mask:0xf
    v_and_b32_dpp v64, v22, v12 row_newbcast:2 row_mask:0xf bank_mask:0xf
    v_and_b32_dpp v65, v22, v13 row_newbcast:2 row_mask:0xf bank_mask:0xf
    s_nop 0
    s_waitcnt vmcnt(14)
    v_mfma_f32_16x16x32_bf16 v[54:57], v[62:65], v[152:155], v[54:57]
    s_waitcnt vmcnt(13)
    v_mfma_f32_16x16x32_bf16 v[58:61], v[62:65], v[156:159], v[58:61]
    s_mov_b32 s71, 139264
    buffer_load_dwordx4 v[152:155], v5, s[12:15], s71 offen
    buffer_load_dwordx4 v[156:159], v5, s[12:15], s71 offen offset:256
    buffer_load_dwordx4 a[76:79], v1, s[4:7], s68 offen offset:256 nt
    s_xor_b32 s68, s69, 0x40200
    buffer_load_dwordx4 a[80:83], v1, s[4:7], s68 offen nt
    buffer_load_dwordx4 a[84:87], v1, s[4:7], s68 offen offset:256 nt
    v_and_b32_dpp v66, v22, v10 row_newbcast:3 row_mask:0xf bank_mask:0xf
    v_and_b32_dpp v67, v22, v11 row_newbcast:3 row_mask:0xf bank_mask:0xf
    v_and_b32_dpp v68, v22, v12 row_newbcast:3 row_mask:0xf bank_mask:0xf
    v_and_b32_dpp v69, v22, v13 row_newbcast:3 row_mask:0xf bank_mask:0xf
    s_nop 0
    s_waitcnt vmcnt(14)
    v_mfma_f32_16x16x32_bf16 v[54:57], v[66:69], v[136:139], v[54:57]
    s_waitcnt vmcnt(13)
    v_mfma_f32_16x16x32_bf16 v[58:61], v[66:69], v[140:143], v[58:61]
    s_mov_b32 s71, 147456
    buffer_load_dwordx4 v[136:139], v5, s[12:15], s71 offen
    buffer_load_dwordx4 v[140:143], v5, s[12:15], s71 offen offset:256
    s_xor_b32 s68, s69, 0x40a00
    buffer_load_dwordx4 a[88:91], v1, s[4:7], s68 offen nt
    buffer_load_dwordx4 a[92:95], v1, s[4:7], s68 offen offset:256 nt
    s_xor_b32 s68, s69, 0x48000
    buffer_load_dwordx4 a[96:99], v1, s[4:7], s68 offen nt
    v_and_b32_dpp v62, v22, v10 row_newbcast:4 row_mask:0xf bank_mask:0xf
    v_and_b32_dpp v63, v22, v11 row_newbcast:4 row_mask:0xf bank_mask:0xf
    v_and_b32_dpp v64, v22, v12 row_newbcast:4 row_mask:0xf bank_mask:0xf
    v_and_b32_dpp v65, v22, v13 row_newbcast:4 row_mask:0xf bank_mask:0xf
    s_nop 0
    s_waitcnt vmcnt(14)
    v_mfma_f32_16x16x32_bf16 v[54:57], v[62:65], v[144:147], v[54:57]
    s_waitcnt vmcnt(13)
    v_mfma_f32_16x16x32_bf16 v[58:61], v[62:65], v[148:151], v[58:61]
    s_mov_b32 s71, 155648
    buffer_load_dwordx4 v[144:147], v5, s[12:15], s71 offen
    buffer_load_dwordx4 v[148:151], v5, s[12:15], s71 offen offset:256
    buffer_load_dwordx4 a[100:103], v1, s[4:7], s68 offen offset:256 nt
    s_xor_b32 s68, s69, 0x48800
    buffer_load_dwordx4 a[104:107], v1, s[4:7], s68 offen nt
    buffer_load_dwordx4 a[108:111], v1, s[4:7], s68 offen offset:256 nt
    v_and_b32_dpp v66, v22, v10 row_newbcast:5 row_mask:0xf bank_mask:0xf
    v_and_b32_dpp v67, v22, v11 row_newbcast:5 row_mask:0xf bank_mask:0xf
    v_and_b32_dpp v68, v22, v12 row_newbcast:5 row_mask:0xf bank_mask:0xf
    v_and_b32_dpp v69, v22, v13 row_newbcast:5 row_mask:0xf bank_mask:0xf
    s_nop 0
    s_waitcnt vmcnt(14)
    v_mfma_f32_16x16x32_bf16 v[54:57], v[66:69], v[152:155], v[54:57]
    s_waitcnt vmcnt(13)
    v_mfma_f32_16x16x32_bf16 v[58:61], v[66:69], v[156:159], v[58:61]
    s_mov_b32 s71, 262144
    buffer_load_dwordx4 v[152:155], v5, s[12:15], s71 offen
    buffer_load_dwordx4 v[156:159], v5, s[12:15], s71 offen offset:256
    s_xor_b32 s68, s69, 0x48200
    buffer_load_dwordx4 a[112:115], v1, s[4:7], s68 offen nt
    buffer_load_dwordx4 a[116:119], v1, s[4:7], s68 offen offset:256 nt
    s_xor_b32 s68, s69, 0x48a00
    buffer_load_dwordx4 a[120:123], v1, s[4:7], s68 offen nt
    v_and_b32_dpp v62, v22, v10 row_newbcast:6 row_mask:0xf bank_mask:0xf
    v_and_b32_dpp v63, v22, v11 row_newbcast:6 row_mask:0xf bank_mask:0xf
    v_and_b32_dpp v64, v22, v12 row_newbcast:6 row_mask:0xf bank_mask:0xf
    v_and_b32_dpp v65, v22, v13 row_newbcast:6 row_mask:0xf bank_mask:0xf
    s_nop 0
    s_waitcnt vmcnt(14)
    v_mfma_f32_16x16x32_bf16 v[54:57], v[62:65], v[136:139], v[54:57]
    s_waitcnt vmcnt(13)
    v_mfma_f32_16x16x32_bf16 v[58:61], v[62:65], v[140:143], v[58:61]
    s_mov_b32 s71, 270336
    buffer_load_dwordx4 v[136:139], v5, s[12:15], s71 offen
    buffer_load_dwordx4 v[140:143], v5, s[12:15], s71 offen offset:256
    buffer_load_dwordx4 a[124:127], v1, s[4:7], s68 offen offset:256 nt
    s_xor_b32 s68, s69, 0x4000
    buffer_load_dwordx4 a[128:131], v1, s[4:7], s68 offen nt
    buffer_load_dwordx4 a[132:135], v1, s[4:7], s68 offen offset:256 nt
    v_and_b32_dpp v66, v22, v10 row_newbcast:7 row_mask:0xf bank_mask:0xf
    v_and_b32_dpp v67, v22, v11 row_newbcast:7 row_mask:0xf bank_mask:0xf
    v_and_b32_dpp v68, v22, v12 row_newbcast:7 row_mask:0xf bank_mask:0xf
    v_and_b32_dpp v69, v22, v13 row_newbcast:7 row_mask:0xf bank_mask:0xf
    s_nop 0
    s_waitcnt vmcnt(14)
    v_mfma_f32_16x16x32_bf16 v[54:57], v[66:69], v[144:147], v[54:57]
    s_waitcnt vmcnt(13)
    v_mfma_f32_16x16x32_bf16 v[58:61], v[66:69], v[148:151], v[58:61]
    s_mov_b32 s71, 278528
    buffer_load_dwordx4 v[144:147], v5, s[12:15], s71 offen
    buffer_load_dwordx4 v[148:151], v5, s[12:15], s71 offen offset:256
    s_xor_b32 s68, s69, 0x4800
    buffer_load_dwordx4 a[136:139], v1, s[4:7], s68 offen nt
    buffer_load_dwordx4 a[140:143], v1, s[4:7], s68 offen offset:256 nt
    s_xor_b32 s68, s69, 0x4200
    buffer_load_dwordx4 a[144:147], v1, s[4:7], s68 offen nt
    v_and_b32_dpp v62, v22, v10 row_newbcast:8 row_mask:0xf bank_mask:0xf
    v_and_b32_dpp v63, v22, v11 row_newbcast:8 row_mask:0xf bank_mask:0xf
    v_and_b32_dpp v64, v22, v12 row_newbcast:8 row_mask:0xf bank_mask:0xf
    v_and_b32_dpp v65, v22, v13 row_newbcast:8 row_mask:0xf bank_mask:0xf
    s_nop 0
    s_waitcnt vmcnt(14)
    v_mfma_f32_16x16x32_bf16 v[54:57], v[62:65], v[152:155], v[54:57]
    s_waitcnt vmcnt(13)
    v_mfma_f32_16x16x32_bf16 v[58:61], v[62:65], v[156:159], v[58:61]
    s_mov_b32 s71, 286720
    buffer_load_dwordx4 v[152:155], v5, s[12:15], s71 offen
    buffer_load_dwordx4 v[156:159], v5, s[12:15], s71 offen offset:256
    buffer_load_dwordx4 a[148:151], v1, s[4:7], s68 offen offset:256 nt
    s_xor_b32 s68, s69, 0x4a00
    buffer_load_dwordx4 a[152:155], v1, s[4:7], s68 offen nt
    buffer_load_dwordx4 a[156:159], v1, s[4:7], s68 offen offset:256 nt
    v_and_b32_dpp v66, v22, v10 row_newbcast:9 row_mask:0xf bank_mask:0xf
    v_and_b32_dpp v67, v22, v11 row_newbcast:9 row_mask:0xf bank_mask:0xf
    v_and_b32_dpp v68, v22, v12 row_newbcast:9 row_mask:0xf bank_mask:0xf
    v_and_b32_dpp v69, v22, v13 row_newbcast:9 row_mask:0xf bank_mask:0xf
    s_nop 0
    s_waitcnt vmcnt(14)
    v_mfma_f32_16x16x32_bf16 v[54:57], v[66:69], v[136:139], v[54:57]
    s_waitcnt vmcnt(13)
    v_mfma_f32_16x16x32_bf16 v[58:61], v[66:69], v[140:143], v[58:61]
    s_mov_b32 s71, 393216
    buffer_load_dwordx4 v[136:139], v5, s[12:15], s71 offen
    buffer_load_dwordx4 v[140:143], v5, s[12:15], s71 offen offset:256
    s_xor_b32 s68, s69, 0xc000
    buffer_load_dwordx4 a[160:163], v1, s[4:7], s68 offen nt
    buffer_load_dwordx4 a[164:167], v1, s[4:7], s68 offen offset:256 nt
    s_xor_b32 s68, s69, 0xc800
    buffer_load_dwordx4 a[168:171], v1, s[4:7], s68 offen nt
    v_and_b32_dpp v62, v22, v10 row_newbcast:10 row_mask:0xf bank_mask:0xf
    v_and_b32_dpp v63, v22, v11 row_newbcast:10 row_mask:0xf bank_mask:0xf
    v_and_b32_dpp v64, v22, v12 row_newbcast:10 row_mask:0xf bank_mask:0xf
    v_and_b32_dpp v65, v22, v13 row_newbcast:10 row_mask:0xf bank_mask:0xf
    s_nop 0
    s_waitcnt vmcnt(14)
    v_mfma_f32_16x16x32_bf16 v[54:57], v[62:65], v[144:147], v[54:57]
    s_waitcnt vmcnt(13)
    v_mfma_f32_16x16x32_bf16 v[58:61], v[62:65], v[148:151], v[58:61]
    s_mov_b32 s71, 401408
    buffer_load_dwordx4 v[144:147], v5, s[12:15], s71 offen
    buffer_load_dwordx4 v[148:151], v5, s[12:15], s71 offen offset:256
    buffer_load_dwordx4 a[172:175], v1, s[4:7], s68 offen offset:256 nt
    s_xor_b32 s68, s69, 0xc200
    buffer_load_dwordx4 a[176:179], v1, s[4:7], s68 offen nt
    buffer_load_dwordx4 a[180:183], v1, s[4:7], s68 offen offset:256 nt
    v_and_b32_dpp v66, v22, v10 row_newbcast:11 row_mask:0xf bank_mask:0xf
    v_and_b32_dpp v67, v22, v11 row_newbcast:11 row_mask:0xf bank_mask:0xf
    v_and_b32_dpp v68, v22, v12 row_newbcast:11 row_mask:0xf bank_mask:0xf
    v_and_b32_dpp v69, v22, v13 row_newbcast:11 row_mask:0xf bank_mask:0xf
    s_nop 0
    s_waitcnt vmcnt(14)
    v_mfma_f32_16x16x32_bf16 v[54:57], v[66:69], v[152:155], v[54:57]
    s_waitcnt vmcnt(13)
    v_mfma_f32_16x16x32_bf16 v[58:61], v[66:69], v[156:159], v[58:61]
    s_mov_b32 s71, 409600
    buffer_load_dwordx4 v[152:155], v5, s[12:15], s71 offen
    buffer_load_dwordx4 v[156:159], v5, s[12:15], s71 offen offset:256
    s_xor_b32 s68, s69, 0xca00
    buffer_load_dwordx4 a[184:187], v1, s[4:7], s68 offen nt
    buffer_load_dwordx4 a[188:191], v1, s[4:7], s68 offen offset:256 nt
    s_xor_b32 s68, s69, 0x44000
    buffer_load_dwordx4 a[192:195], v1, s[4:7], s68 offen nt
    v_and_b32_dpp v62, v22, v10 row_newbcast:12 row_mask:0xf bank_mask:0xf
    v_and_b32_dpp v63, v22, v11 row_newbcast:12 row_mask:0xf bank_mask:0xf
    v_and_b32_dpp v64, v22, v12 row_newbcast:12 row_mask:0xf bank_mask:0xf
    v_and_b32_dpp v65, v22, v13 row_newbcast:12 row_mask:0xf bank_mask:0xf
    s_nop 0
    s_waitcnt vmcnt(14)
    v_mfma_f32_16x16x32_bf16 v[54:57], v[62:65], v[136:139], v[54:57]
    s_waitcnt vmcnt(13)
    v_mfma_f32_16x16x32_bf16 v[58:61], v[62:65], v[140:143], v[58:61]
    s_mov_b32 s71, 417792
    buffer_load_dwordx4 v[136:139], v5, s[12:15], s71 offen
    buffer_load_dwordx4 v[140:143], v5, s[12:15], s71 offen offset:256
    buffer_load_dwordx4 a[196:199], v1, s[4:7], s68 offen offset:256 nt
    s_xor_b32 s68, s69, 0x44800
    buffer_load_dwordx4 a[200:203], v1, s[4:7], s68 offen nt
    buffer_load_dwordx4 a[204:207], v1, s[4:7], s68 offen offset:256 nt
    v_and_b32_dpp v66, v22, v10 row_newbcast:13 row_mask:0xf bank_mask:0xf
    v_and_b32_dpp v67, v22, v11 row_newbcast:13 row_mask:0xf bank_mask:0xf
    v_and_b32_dpp v68, v22, v12 row_newbcast:13 row_mask:0xf bank_mask:0xf
    v_and_b32_dpp v69, v22, v13 row_newbcast:13 row_mask:0xf bank_mask:0xf
    s_nop 0
    s_waitcnt vmcnt(14)
    v_mfma_f32_16x16x32_bf16 v[54:57], v[66:69], v[144:147], v[54:57]
    s_waitcnt vmcnt(13)
    v_mfma_f32_16x16x32_bf16 v[58:61], v[66:69], v[148:151], v[58:61]
    s_mov_b32 s71, 524288
    buffer_load_dwordx4 v[144:147], v5, s[12:15], s71 offen
    buffer_load_dwordx4 v[148:151], v5, s[12:15], s71 offen offset:256
    s_xor_b32 s68, s69, 0x44200
    buffer_load_dwordx4 a[208:211], v1, s[4:7], s68 offen nt
    buffer_load_dwordx4 a[212:215], v1, s[4:7], s68 offen offset:256 nt
    s_xor_b32 s68, s69, 0x44a00
    buffer_load_dwordx4 a[216:219], v1, s[4:7], s68 offen nt
    v_and_b32_dpp v62, v22, v10 row_newbcast:14 row_mask:0xf bank_mask:0xf
    v_and_b32_dpp v63, v22, v11 row_newbcast:14 row_mask:0xf bank_mask:0xf
    v_and_b32_dpp v64, v22, v12 row_newbcast:14 row_mask:0xf bank_mask:0xf
    v_and_b32_dpp v65, v22, v13 row_newbcast:14 row_mask:0xf bank_mask:0xf
    s_nop 0
    s_waitcnt vmcnt(14)
    v_mfma_f32_16x16x32_bf16 v[54:57], v[62:65], v[152:155], v[54:57]
    s_waitcnt vmcnt(13)
    v_mfma_f32_16x16x32_bf16 v[58:61], v[62:65], v[156:159], v[58:61]
    s_mov_b32 s71, 532480
    buffer_load_dwordx4 v[152:155], v5, s[12:15], s71 offen
    buffer_load_dwordx4 v[156:159], v5, s[12:15], s71 offen offset:256
    buffer_load_dwordx4 a[220:223], v1, s[4:7], s68 offen offset:256 nt
    s_xor_b32 s68, s69, 0x4c000
    buffer_load_dwordx4 a[224:227], v1, s[4:7], s68 offen nt
    buffer_load_dwordx4 a[228:231], v1, s[4:7], s68 offen offset:256 nt
    v_and_b32_dpp v66, v22, v10 row_newbcast:15 row_mask:0xf bank_mask:0xf
    v_and_b32_dpp v67, v22, v11 row_newbcast:15 row_mask:0xf bank_mask:0xf
    v_and_b32_dpp v68, v22, v12 row_newbcast:15 row_mask:0xf bank_mask:0xf
    v_and_b32_dpp v69, v22, v13 row_newbcast:15 row_mask:0xf bank_mask:0xf
    s_nop 0
    s_waitcnt vmcnt(14)
    v_mfma_f32_16x16x32_bf16 v[54:57], v[66:69], v[136:139], v[54:57]
    s_waitcnt vmcnt(13)
    v_mfma_f32_16x16x32_bf16 v[58:61], v[66:69], v[140:143], v[58:61]
    s_mov_b32 s71, 540672
    buffer_load_dwordx4 v[136:139], v5, s[12:15], s71 offen
    buffer_load_dwordx4 v[140:143], v5, s[12:15], s71 offen offset:256
    s_xor_b32 s68, s69, 0x4c800
    buffer_load_dwordx4 a[232:235], v1, s[4:7], s68 offen nt
    buffer_load_dwordx4 a[236:239], v1, s[4:7], s68 offen offset:256 nt
    s_xor_b32 s68, s69, 0x4c200
    buffer_load_dwordx4 a[240:243], v1, s[4:7], s68 offen nt
    v_and_b32_dpp v62, v23, v10 row_newbcast:0 row_mask:0xf bank_mask:0xf
    v_and_b32_dpp v63, v23, v11 row_newbcast:0 row_mask:0xf bank_mask:0xf
    v_and_b32_dpp v64, v23, v12 row_newbcast:0 row_mask:0xf bank_mask:0xf
    v_and_b32_dpp v65, v23, v13 row_newbcast:0 row_mask:0xf bank_mask:0xf
    s_nop 0
    s_waitcnt vmcnt(14)
    v_mfma_f32_16x16x32_bf16 v[54:57], v[62:65], v[144:147], v[54:57]
    s_waitcnt vmcnt(13)
    v_mfma_f32_16x16x32_bf16 v[58:61], v[62:65], v[148:151], v[58:61]
    s_mov_b32 s71, 548864
    buffer_load_dwordx4 v[144:147], v5, s[12:15], s71 offen
    buffer_load_dwordx4 v[148:151], v5, s[12:15], s71 offen offset:256
    buffer_load_dwordx4 a[244:247], v1, s[4:7], s68 offen offset:256 nt
    s_xor_b32 s68, s69, 0x4ca00
    buffer_load_dwordx4 a[248:251], v1, s[4:7], s68 offen nt
    buffer_load_dwordx4 a[252:255], v1, s[4:7], s68 offen offset:256 nt
    v_and_b32_dpp v66, v23, v10 row_newbcast:1 row_mask:0xf bank_mask:0xf
    v_and_b32_dpp v67, v23, v11 row_newbcast:1 row_mask:0xf bank_mask:0xf
    v_and_b32_dpp v68, v23, v12 row_newbcast:1 row_mask:0xf bank_mask:0xf
    v_and_b32_dpp v69, v23, v13 row_newbcast:1 row_mask:0xf bank_mask:0xf
    s_nop 0
    s_waitcnt vmcnt(14)
    v_mfma_f32_16x16x32_bf16 v[54:57], v[66:69], v[152:155], v[54:57]
    s_waitcnt vmcnt(13)
    v_mfma_f32_16x16x32_bf16 v[58:61], v[66:69], v[156:159], v[58:61]
    s_mov_b32 s71, 655360
    buffer_load_dwordx4 v[152:155], v5, s[12:15], s71 offen
    buffer_load_dwordx4 v[156:159], v5, s[12:15], s71 offen offset:256
    s_xor_b32 s68, s69, 0x20000
    buffer_load_dwordx4 v[160:163], v1, s[4:7], s68 offen nt
    buffer_load_dwordx4 v[164:167], v1, s[4:7], s68 offen offset:256 nt
    s_xor_b32 s68, s69, 0x20800
    buffer_load_dwordx4 v[168:171], v1, s[4:7], s68 offen nt
    v_and_b32_dpp v62, v23, v10 row_newbcast:2 row_mask:0xf bank_mask:0xf
    v_and_b32_dpp v63, v23, v11 row_newbcast:2 row_mask:0xf bank_mask:0xf
    v_and_b32_dpp v64, v23, v12 row_newbcast:2 row_mask:0xf bank_mask:0xf
    v_and_b32_dpp v65, v23, v13 row_newbcast:2 row_mask:0xf bank_mask:0xf
    s_nop 0
    s_waitcnt vmcnt(14)
    v_mfma_f32_16x16x32_bf16 v[54:57], v[62:65], v[136:139], v[54:57]
    s_waitcnt vmcnt(13)
    v_mfma_f32_16x16x32_bf16 v[58:61], v[62:65], v[140:143], v[58:61]
    s_mov_b32 s71, 663552
    buffer_load_dwordx4 v[136:139], v5, s[12:15], s71 offen
    buffer_load_dwordx4 v[140:143], v5, s[12:15], s71 offen offset:256
    buffer_load_dwordx4 v[172:175], v1, s[4:7], s68 offen offset:256 nt
    s_xor_b32 s68, s69, 0x20200
    buffer_load_dwordx4 v[176:179], v1, s[4:7], s68 offen nt
    buffer_load_dwordx4 v[180:183], v1, s[4:7], s68 offen offset:256 nt
    v_and_b32_dpp v66, v23, v10 row_newbcast:3 row_mask:0xf bank_mask:0xf
    v_and_b32_dpp v67, v23, v11 row_newbcast:3 row_mask:0xf bank_mask:0xf
    v_and_b32_dpp v68, v23, v12 row_newbcast:3 row_mask:0xf bank_mask:0xf
    v_and_b32_dpp v69, v23, v13 row_newbcast:3 row_mask:0xf bank_mask:0xf
    s_nop 0
    s_waitcnt vmcnt(14)
    v_mfma_f32_16x16x32_bf16 v[54:57], v[66:69], v[144:147], v[54:57]
    s_waitcnt vmcnt(13)
    v_mfma_f32_16x16x32_bf16 v[58:61], v[66:69], v[148:151], v[58:61]
    s_mov_b32 s71, 671744
    buffer_load_dwordx4 v[144:147], v5, s[12:15], s71 offen
    buffer_load_dwordx4 v[148:151], v5, s[12:15], s71 offen offset:256
    s_xor_b32 s68, s69, 0x20a00
    buffer_load_dwordx4 v[184:187], v1, s[4:7], s68 offen nt
    buffer_load_dwordx4 v[188:191], v1, s[4:7], s68 offen offset:256 nt
    s_xor_b32 s68, s69, 0x28000
    buffer_load_dwordx4 v[192:195], v1, s[4:7], s68 offen nt
    v_and_b32_dpp v62, v23, v10 row_newbcast:4 row_mask:0xf bank_mask:0xf
    v_and_b32_dpp v63, v23, v11 row_newbcast:4 row_mask:0xf bank_mask:0xf
    v_and_b32_dpp v64, v23, v12 row_newbcast:4 row_mask:0xf bank_mask:0xf
    v_and_b32_dpp v65, v23, v13 row_newbcast:4 row_mask:0xf bank_mask:0xf
    s_nop 0
    s_waitcnt vmcnt(14)
    v_mfma_f32_16x16x32_bf16 v[54:57], v[62:65], v[152:155], v[54:57]
    s_waitcnt vmcnt(13)
    v_mfma_f32_16x16x32_bf16 v[58:61], v[62:65], v[156:159], v[58:61]
    s_mov_b32 s71, 679936
    buffer_load_dwordx4 v[152:155], v5, s[12:15], s71 offen
    buffer_load_dwordx4 v[156:159], v5, s[12:15], s71 offen offset:256
    buffer_load_dwordx4 v[196:199], v1, s[4:7], s68 offen offset:256 nt
    s_xor_b32 s68, s69, 0x28800
    buffer_load_dwordx4 v[200:203], v1, s[4:7], s68 offen nt
    buffer_load_dwordx4 v[204:207], v1, s[4:7], s68 offen offset:256 nt
    v_and_b32_dpp v66, v23, v10 row_newbcast:5 row_mask:0xf bank_mask:0xf
    v_and_b32_dpp v67, v23, v11 row_newbcast:5 row_mask:0xf bank_mask:0xf
    v_and_b32_dpp v68, v23, v12 row_newbcast:5 row_mask:0xf bank_mask:0xf
    v_and_b32_dpp v69, v23, v13 row_newbcast:5 row_mask:0xf bank_mask:0xf
    s_nop 0
    s_waitcnt vmcnt(14)
    v_mfma_f32_16x16x32_bf16 v[54:57], v[66:69], v[136:139], v[54:57]
    s_waitcnt vmcnt(13)
    v_mfma_f32_16x16x32_bf16 v[58:61], v[66:69], v[140:143], v[58:61]
    s_mov_b32 s71, 786432
    buffer_load_dwordx4 v[136:139], v5, s[12:15], s71 offen
    buffer_load_dwordx4 v[140:143], v5, s[12:15], s71 offen offset:256
    s_xor_b32 s68, s69, 0x28200
    buffer_load_dwordx4 v[208:211], v1, s[4:7], s68 offen nt
    buffer_load_dwordx4 v[212:215], v1, s[4:7], s68 offen offset:256 nt
    s_xor_b32 s68, s69, 0x28a00
    buffer_load_dwordx4 v[216:219], v1, s[4:7], s68 offen nt
    v_and_b32_dpp v62, v23, v10 row_newbcast:6 row_mask:0xf bank_mask:0xf
    v_and_b32_dpp v63, v23, v11 row_newbcast:6 row_mask:0xf bank_mask:0xf
    v_and_b32_dpp v64, v23, v12 row_newbcast:6 row_mask:0xf bank_mask:0xf
    v_and_b32_dpp v65, v23, v13 row_newbcast:6 row_mask:0xf bank_mask:0xf
    s_nop 0
    s_waitcnt vmcnt(14)
    v_mfma_f32_16x16x32_bf16 v[54:57], v[62:65], v[144:147], v[54:57]
    s_waitcnt vmcnt(13)
    v_mfma_f32_16x16x32_bf16 v[58:61], v[62:65], v[148:151], v[58:61]
    s_mov_b32 s71, 794624
    buffer_load_dwordx4 v[144:147], v5, s[12:15], s71 offen
    buffer_load_dwordx4 v[148:151], v5, s[12:15], s71 offen offset:256
    buffer_load_dwordx4 v[220:223], v1, s[4:7], s68 offen offset:256 nt
    s_xor_b32 s68, s69, 0x60000
    buffer_load_dwordx4 v[224:227], v1, s[4:7], s68 offen nt
    buffer_load_dwordx4 v[228:231], v1, s[4:7], s68 offen offset:256 nt
    v_and_b32_dpp v66, v23, v10 row_newbcast:7 row_mask:0xf bank_mask:0xf
    v_and_b32_dpp v67, v23, v11 row_newbcast:7 row_mask:0xf bank_mask:0xf
    v_and_b32_dpp v68, v23, v12 row_newbcast:7 row_mask:0xf bank_mask:0xf
    v_and_b32_dpp v69, v23, v13 row_newbcast:7 row_mask:0xf bank_mask:0xf
    s_nop 0
    s_waitcnt vmcnt(14)
    v_mfma_f32_16x16x32_bf16 v[54:57], v[66:69], v[152:155], v[54:57]
    s_waitcnt vmcnt(13)
    v_mfma_f32_16x16x32_bf16 v[58:61], v[66:69], v[156:159], v[58:61]
    s_mov_b32 s71, 802816
    buffer_load_dwordx4 v[152:155], v5, s[12:15], s71 offen
    buffer_load_dwordx4 v[156:159], v5, s[12:15], s71 offen offset:256
    s_xor_b32 s68, s69, 0x60800
    buffer_load_dwordx4 v[232:235], v1, s[4:7], s68 offen nt
    buffer_load_dwordx4 v[236:239], v1, s[4:7], s68 offen offset:256 nt
    s_xor_b32 s68, s69, 0x60200
    buffer_load_dwordx4 v[240:243], v1, s[4:7], s68 offen nt
    v_and_b32_dpp v62, v23, v10 row_newbcast:8 row_mask:0xf bank_mask:0xf
    v_and_b32_dpp v63, v23, v11 row_newbcast:8 row_mask:0xf bank_mask:0xf
    v_and_b32_dpp v64, v23, v12 row_newbcast:8 row_mask:0xf bank_mask:0xf
    v_and_b32_dpp v65, v23, v13 row_newbcast:8 row_mask:0xf bank_mask:0xf
    s_nop 0
    s_waitcnt vmcnt(14)
    v_mfma_f32_16x16x32_bf16 v[54:57], v[62:65], v[136:139], v[54:57]
    s_waitcnt vmcnt(13)
    v_mfma_f32_16x16x32_bf16 v[58:61], v[62:65], v[140:143], v[58:61]
    s_mov_b32 s71, 811008
    buffer_load_dwordx4 v[136:139], v5, s[12:15], s71 offen
    buffer_load_dwordx4 v[140:143], v5, s[12:15], s71 offen offset:256
    buffer_load_dwordx4 v[244:247], v1, s[4:7], s68 offen offset:256 nt
    s_xor_b32 s68, s69, 0x60a00
    buffer_load_dwordx4 v[248:251], v1, s[4:7], s68 offen nt
    buffer_load_dwordx4 v[252:255], v1, s[4:7], s68 offen offset:256 nt
    v_and_b32_dpp v66, v23, v10 row_newbcast:9 row_mask:0xf bank_mask:0xf
    v_and_b32_dpp v67, v23, v11 row_newbcast:9 row_mask:0xf bank_mask:0xf
    v_and_b32_dpp v68, v23, v12 row_newbcast:9 row_mask:0xf bank_mask:0xf
    v_and_b32_dpp v69, v23, v13 row_newbcast:9 row_mask:0xf bank_mask:0xf
    s_nop 0
    s_waitcnt vmcnt(14)
    v_mfma_f32_16x16x32_bf16 v[54:57], v[66:69], v[144:147], v[54:57]
    s_waitcnt vmcnt(13)
    v_mfma_f32_16x16x32_bf16 v[58:61], v[66:69], v[148:151], v[58:61]
    v_and_b32_dpp v62, v23, v10 row_newbcast:10 row_mask:0xf bank_mask:0xf
    v_and_b32_dpp v63, v23, v11 row_newbcast:10 row_mask:0xf bank_mask:0xf
    v_and_b32_dpp v64, v23, v12 row_newbcast:10 row_mask:0xf bank_mask:0xf
    v_and_b32_dpp v65, v23, v13 row_newbcast:10 row_mask:0xf bank_mask:0xf
    s_nop 0
    s_waitcnt vmcnt(9)
    v_mfma_f32_16x16x32_bf16 v[54:57], v[62:65], v[152:155], v[54:57]
    s_waitcnt vmcnt(8)
    v_mfma_f32_16x16x32_bf16 v[58:61], v[62:65], v[156:159], v[58:61]
    v_and_b32_dpp v66, v23, v10 row_newbcast:11 row_mask:0xf bank_mask:0xf
    v_and_b32_dpp v67, v23, v11 row_newbcast:11 row_mask:0xf bank_mask:0xf
    v_and_b32_dpp v68, v23, v12 row_newbcast:11 row_mask:0xf bank_mask:0xf
    v_and_b32_dpp v69, v23, v13 row_newbcast:11 row_mask:0xf bank_mask:0xf
    s_nop 0
    s_waitcnt vmcnt(4)
    v_mfma_f32_16x16x32_bf16 v[54:57], v[66:69], v[136:139], v[54:57]
    s_waitcnt vmcnt(3)
    v_mfma_f32_16x16x32_bf16 v[58:61], v[66:69], v[140:143], v[58:61]
    s_xor_b32 s68, s69, 0x68000
    buffer_load_dwordx4 v[104:107], v1, s[4:7], s68 offen nt
    buffer_load_dwordx4 v[108:111], v1, s[4:7], s68 offen offset:256 nt
    s_xor_b32 s68, s69, 0x68800
    buffer_load_dwordx4 v[112:115], v1, s[4:7], s68 offen nt
    buffer_load_dwordx4 v[116:119], v1, s[4:7], s68 offen offset:256 nt
    s_xor_b32 s68, s69, 0x68200
    buffer_load_dwordx4 v[120:123], v1, s[4:7], s68 offen nt
    buffer_load_dwordx4 v[124:127], v1, s[4:7], s68 offen offset:256 nt
    v_and_b32 v2, 15, v0
    v_lshlrev_b32 v2, 5, v2
    v_and_b32 v3, 16, v0
    v_add_u32 v3, v2, v3
    s_lshl_b32 s71, s62, 10
    v_add_u32 v3, s71, v3
    s_nop 2
    ds_write_b128 v3, v[54:57]
    ds_write_b128 v3, v[58:61] offset:512
    s_waitcnt lgkmcnt(0)
    s_barrier
    ds_read_b128 v[136:139], v2 offset:0
    ds_read_b128 v[140:143], v2 offset:16
    ds_read_b128 v[144:147], v2 offset:1024
    ds_read_b128 v[148:151], v2 offset:1040
    ds_read_b128 v[152:155], v2 offset:2048
    ds_read_b128 v[156:159], v2 offset:2064
    ds_read_b128 v[72:75], v2 offset:3072
    ds_read_b128 v[76:79], v2 offset:3088
    ds_read_b128 v[80:83], v2 offset:512
    ds_read_b128 v[84:87], v2 offset:528
    ds_read_b128 v[88:91], v2 offset:1536
    ds_read_b128 v[92:95], v2 offset:1552
    ds_read_b128 v[96:99], v2 offset:2560
    ds_read_b128 v[100:103], v2 offset:2576
    ds_read_b128 v[128:131], v2 offset:3584
    ds_read_b128 v[132:135], v2 offset:3600
    s_mul_i32 s71, s64, 229376
    s_add_u32 s16, s44, s71
    s_addc_u32 s17, s45, 0
    s_and_b32 s17, s17, 0xffff
    s_mov_b32 s18, 229376
    s_mov_b32 s19, 0x20000
    s_lshl_b32 s71, s67, 7
    s_add_u32 s20, s48, s71
    s_addc_u32 s21, s49, 0
    s_and_b32 s21, s21, 0xffff
    s_mov_b32 s22, 0
    s_mov_b32 s23, 0x20000
    s_sub_u32 s22, 1605632, s71
    s_mul_i32 s71, s67, 57344
    s_add_u32 s24, s52, s71
    s_addc_u32 s25, s53, 0
    s_and_b32 s25, s25, 0xffff
    s_mov_b32 s26, 57344
    s_mov_b32 s27, 0x20000
    s_cmp_ge_u32 s3, 28
    s_cselect_b32 s22, 0, s22
    s_cselect_b32 s26, 0, s26
    s_or_b32 s71, s66, s62
    s_cbranch_scc1 L_noclr
    s_lshl_b32 s71, s65, 12
    s_add_u32 s71, s71, 589824
    v_mov_b32 v70, 0
    s_mov_b64 exec, 1
    buffer_store_dword v70, v70, s[32:35], s71 offen sc1
    s_mov_b64 exec, -1
L_noclr:
    s_waitcnt lgkmcnt(8)
    v_pk_add_f32 v[136:137], v[136:137], v[144:145]
    v_pk_add_f32 v[152:153], v[152:153], v[72:73]
    v_pk_add_f32 v[138:139], v[138:139], v[146:147]
    v_pk_add_f32 v[154:155], v[154:155], v[74:75]
    v_pk_add_f32 v[140:141], v[140:141], v[148:149]
    v_pk_add_f32 v[156:157], v[156:157], v[76:77]
    v_pk_add_f32 v[142:143], v[142:143], v[150:151]
    v_pk_add_f32 v[158:159], v[158:159], v[78:79]
    v_pk_add_f32 v[136:137], v[136:137], v[152:153]
    v_pk_add_f32 v[138:139], v[138:139], v[154:155]
    v_pk_add_f32 v[140:141], v[140:141], v[156:157]
    v_pk_add_f32 v[142:143], v[142:143], v[158:159]
    v_cvt_pk_bf16_f32 v14, v136, v137
    v_cvt_pk_bf16_f32 v15, v138, v139
    v_cvt_pk_bf16_f32 v16, v140, v141
    v_cvt_pk_bf16_f32 v17, v142, v143
    s_waitcnt lgkmcnt(0)
    v_pk_add_f32 v[80:81], v[80:81], v[88:89]
    v_pk_add_f32 v[96:97], v[96:97], v[128:129]
    v_pk_add_f32 v[82:83], v[82:83], v[90:91]
    v_pk_add_f32 v[98:99], v[98:99], v[130:131]
    v_pk_add_f32 v[84:85], v[84:85], v[92:93]
    v_pk_add_f32 v[100:101], v[100:101], v[132:133]
    v_pk_add_f32 v[86:87], v[86:87], v[94:95]
    v_pk_add_f32 v[102:103], v[102:103], v[134:135]
    v_pk_add_f32 v[80:81], v[80:81], v[96:97]
    v_pk_add_f32 v[82:83], v[82:83], v[98:99]
    v_pk_add_f32 v[84:85], v[84:85], v[100:101]
    v_pk_add_f32 v[86:87], v[86:87], v[102:103]
    v_cvt_pk_bf16_f32 v18, v80, v81
    v_cvt_pk_bf16_f32 v19, v82, v83
    v_cvt_pk_bf16_f32 v20, v84, v85
    v_cvt_pk_bf16_f32 v21, v86, v87
    s_add_u32 s74, s73, 1
    v_lshrrev_b32 v2, 4, v0
    v_bfe_u32 v3, v0, 3, 1
    v_lshl_add_u32 v2, v2, 1, v3
    v_and_b32 v3, 7, v0
    s_lshl_b32 s71, s62, 4
    v_add_u32 v6, s71, v3
    v_lshlrev_b32 v6, 4, v6
    s_movk_i32 s71, 896
    v_mad_u32_u24 v4, v2, s71, v6
    s_cmp_eq_u32 s62, 3
    s_cselect_b32 s71, 0x10000000, 0
    s_add_u32 s71, s71, 128
    v_add_u32 v6, s71, v4
    s_mul_i32 s71, s62, 112
    v_add_u32 v2, s71, v2
    v_lshlrev_b32 v3, 4, v3
    s_movk_i32 s71, 3584
    v_mad_u32_u24 v5, v2, s71, v3
    s_waitcnt vmcnt(5)
    s_xor_b32 s68, s69, 0x68a00
    buffer_load_dwordx4 v[128:131], v1, s[4:7], s68 offen nt
    v_accvgpr_read_b32 v54, a0
    v_accvgpr_read_b32 v55, a1
    v_accvgpr_read_b32 v56, a2
    v_accvgpr_read_b32 v57, a3
    v_dot2_f32_bf16 v38, v54, v14, 0
    v_dot2_f32_bf16 v38, v55, v15, v38
    v_dot2_f32_bf16 v38, v56, v16, v38
    v_dot2_f32_bf16 v38, v57, v17, v38
    v_accvgpr_read_b32 v58, a4
    v_accvgpr_read_b32 v59, a5
    v_accvgpr_read_b32 v60, a6
    v_accvgpr_read_b32 v61, a7
    v_dot2_f32_bf16 v38, v58, v18, v38
    v_dot2_f32_bf16 v38, v59, v19, v38
    v_dot2_f32_bf16 v38, v60, v20, v38
    v_dot2_f32_bf16 v38, v61, v21, v38
    v_accvgpr_read_b32 v54, a8
    v_accvgpr_read_b32 v55, a9
    v_accvgpr_read_b32 v56, a10
    v_accvgpr_read_b32 v57, a11
    v_dot2_f32_bf16 v39, v54, v14, 0
    v_dot2_f32_bf16 v39, v55, v15, v39
    v_dot2_f32_bf16 v39, v56, v16, v39
    v_dot2_f32_bf16 v39, v57, v17, v39
    v_accvgpr_read_b32 v58, a12
    v_accvgpr_read_b32 v59, a13
    v_accvgpr_read_b32 v60, a14
    v_accvgpr_read_b32 v61, a15
    v_dot2_f32_bf16 v39, v58, v18, v39
    v_dot2_f32_bf16 v39, v59, v19, v39
    v_dot2_f32_bf16 v39, v60, v20, v39
    v_dot2_f32_bf16 v39, v61, v21, v39
    v_accvgpr_read_b32 v54, a16
    v_accvgpr_read_b32 v55, a17
    v_accvgpr_read_b32 v56, a18
    v_accvgpr_read_b32 v57, a19
    v_dot2_f32_bf16 v40, v54, v14, 0
    v_dot2_f32_bf16 v40, v55, v15, v40
    v_dot2_f32_bf16 v40, v56, v16, v40
    v_dot2_f32_bf16 v40, v57, v17, v40
    v_accvgpr_read_b32 v58, a20
    v_accvgpr_read_b32 v59, a21
    v_accvgpr_read_b32 v60, a22
    v_accvgpr_read_b32 v61, a23
    v_dot2_f32_bf16 v40, v58, v18, v40
    v_dot2_f32_bf16 v40, v59, v19, v40
    v_dot2_f32_bf16 v40, v60, v20, v40
    v_dot2_f32_bf16 v40, v61, v21, v40
    v_accvgpr_read_b32 v54, a24
    v_accvgpr_read_b32 v55, a25
    v_accvgpr_read_b32 v56, a26
    v_accvgpr_read_b32 v57, a27
    v_dot2_f32_bf16 v41, v54, v14, 0
    v_dot2_f32_bf16 v41, v55, v15, v41
    v_dot2_f32_bf16 v41, v56, v16, v41
    v_dot2_f32_bf16 v41, v57, v17, v41
    s_waitcnt vmcnt(5)
    buffer_load_dwordx4 v[132:135], v1, s[4:7], s68 offen offset:256 nt
    v_accvgpr_read_b32 v58, a28
    v_accvgpr_read_b32 v59, a29
    v_accvgpr_read_b32 v60, a30
    v_accvgpr_read_b32 v61, a31
    v_dot2_f32_bf16 v41, v58, v18, v41
    v_dot2_f32_bf16 v41, v59, v19, v41
    v_dot2_f32_bf16 v41, v60, v20, v41
    v_dot2_f32_bf16 v41, v61, v21, v41
    v_accvgpr_read_b32 v54, a32
    v_accvgpr_read_b32 v55, a33
    v_accvgpr_read_b32 v56, a34
    v_accvgpr_read_b32 v57, a35
    v_dot2_f32_bf16 v42, v54, v14, 0
    v_dot2_f32_bf16 v42, v55, v15, v42
    v_dot2_f32_bf16 v42, v56, v16, v42
    v_dot2_f32_bf16 v42, v57, v17, v42
    v_accvgpr_read_b32 v58, a36
    v_accvgpr_read_b32 v59, a37
    v_accvgpr_read_b32 v60, a38
    v_accvgpr_read_b32 v61, a39
    v_dot2_f32_bf16 v42, v58, v18, v42
    v_dot2_f32_bf16 v42, v59, v19, v42
    v_dot2_f32_bf16 v42, v60, v20, v42
    v_dot2_f32_bf16 v42, v61, v21, v42
    v_accvgpr_read_b32 v54, a40
    v_accvgpr_read_b32 v55, a41
    v_accvgpr_read_b32 v56, a42
    v_accvgpr_read_b32 v57, a43
    v_dot2_f32_bf16 v43, v54, v14, 0
    v_dot2_f32_bf16 v43, v55, v15, v43
    v_dot2_f32_bf16 v43, v56, v16, v43
    v_dot2_f32_bf16 v43, v57, v17, v43
    v_accvgpr_read_b32 v58, a44
    v_accvgpr_read_b32 v59, a45
    v_accvgpr_read_b32 v60, a46
    v_accvgpr_read_b32 v61, a47
    v_dot2_f32_bf16 v43, v58, v18, v43
    v_dot2_f32_bf16 v43, v59, v19, v43
    v_dot2_f32_bf16 v43, v60, v20, v43
    v_dot2_f32_bf16 v43, v61, v21, v43
    v_accvgpr_read_b32 v54, a48
    v_accvgpr_read_b32 v55, a49
    v_accvgpr_read_b32 v56, a50
    v_accvgpr_read_b32 v57, a51
    v_dot2_f32_bf16 v44, v54, v14, 0
    v_dot2_f32_bf16 v44, v55, v15, v44
    v_dot2_f32_bf16 v44, v56, v16, v44
    v_dot2_f32_bf16 v44, v57, v17, v44
    v_accvgpr_read_b32 v58, a52
    v_accvgpr_read_b32 v59, a53
    v_accvgpr_read_b32 v60, a54
    v_accvgpr_read_b32 v61, a55
    v_dot2_f32_bf16 v44, v58, v18, v44
    v_dot2_f32_bf16 v44, v59, v19, v44
    v_dot2_f32_bf16 v44, v60, v20, v44
    v_dot2_f32_bf16 v44, v61, v21, v44
    s_waitcnt vmcnt(5)
    s_xor_b32 s68, s69, 0x24000
    buffer_load_dwordx4 v[72:75], v1, s[4:7], s68 offen nt
    s_movk_i32 s71, 0
    buffer_load_dwordx4 v[136:139], v5, s[20:23], s71 offen
    v_accvgpr_read_b32 v54, a56
    v_accvgpr_read_b32 v55, a57
    v_accvgpr_read_b32 v56, a58
    v_accvgpr_read_b32 v57, a59
    v_dot2_f32_bf16 v45, v54, v14, 0
    v_dot2_f32_bf16 v45, v55, v15, v45
    v_dot2_f32_bf16 v45, v56, v16, v45
    v_dot2_f32_bf16 v45, v57, v17, v45
    v_accvgpr_read_b32 v58, a60
    v_accvgpr_read_b32 v59, a61
    v_accvgpr_read_b32 v60, a62
    v_accvgpr_read_b32 v61, a63
    v_dot2_f32_bf16 v45, v58, v18, v45
    v_dot2_f32_bf16 v45, v59, v19, v45
    v_dot2_f32_bf16 v45, v60, v20, v45
    v_dot2_f32_bf16 v45, v61, v21, v45
    v_accvgpr_read_b32 v54, a64
    v_accvgpr_read_b32 v55, a65
    v_accvgpr_read_b32 v56, a66
    v_accvgpr_read_b32 v57, a67
    v_dot2_f32_bf16 v46, v54, v14, 0
    v_dot2_f32_bf16 v46, v55, v15, v46
    v_dot2_f32_bf16 v46, v56, v16, v46
    v_dot2_f32_bf16 v46, v57, v17, v46
    v_accvgpr_read_b32 v58, a68
    v_accvgpr_read_b32 v59, a69
    v_accvgpr_read_b32 v60, a70
    v_accvgpr_read_b32 v61, a71
    v_dot2_f32_bf16 v46, v58, v18, v46
    v_dot2_f32_bf16 v46, v59, v19, v46
    v_dot2_f32_bf16 v46, v60, v20, v46
    v_dot2_f32_bf16 v46, v61, v21, v46
    v_accvgpr_read_b32 v54, a72
    v_accvgpr_read_b32 v55, a73
    v_accvgpr_read_b32 v56, a74
    v_accvgpr_read_b32 v57, a75
    v_dot2_f32_bf16 v47, v54, v14, 0
    v_dot2_f32_bf16 v47, v55, v15, v47
    v_dot2_f32_bf16 v47, v56, v16, v47
    v_dot2_f32_bf16 v47, v57, v17, v47
    v_accvgpr_read_b32 v58, a76
    v_accvgpr_read_b32 v59, a77
    v_accvgpr_read_b32 v60, a78
    v_accvgpr_read_b32 v61, a79
    v_dot2_f32_bf16 v47, v58, v18, v47
    v_dot2_f32_bf16 v47, v59, v19, v47
    v_dot2_f32_bf16 v47, v60, v20, v47
    v_dot2_f32_bf16 v47, v61, v21, v47
    v_accvgpr_read_b32 v54, a80
    v_accvgpr_read_b32 v55, a81
    v_accvgpr_read_b32 v56, a82
    v_accvgpr_read_b32 v57, a83
    v_dot2_f32_bf16 v48, v54, v14, 0
    v_dot2_f32_bf16 v48, v55, v15, v48
    v_dot2_f32_bf16 v48, v56, v16, v48
    v_dot2_f32_bf16 v48, v57, v17, v48
    s_waitcnt vmcnt(6)
    buffer_load_dwordx4 v[76:79], v1, s[4:7], s68 offen offset:256 nt
    v_accvgpr_read_b32 v58, a84
    v_accvgpr_read_b32 v59, a85
    v_accvgpr_read_b32 v60, a86
    v_accvgpr_read_b32 v61, a87
    v_dot2_f32_bf16 v48, v58, v18, v48
    v_dot2_f32_bf16 v48, v59, v19, v48
    v_dot2_f32_bf16 v48, v60, v20, v48
    v_dot2_f32_bf16 v48, v61, v21, v48
    v_accvgpr_read_b32 v54, a88
    v_accvgpr_read_b32 v55, a89
    v_accvgpr_read_b32 v56, a90
    v_accvgpr_read_b32 v57, a91
    v_dot2_f32_bf16 v49, v54, v14, 0
    v_dot2_f32_bf16 v49, v55, v15, v49
    v_dot2_f32_bf16 v49, v56, v16, v49
    v_dot2_f32_bf16 v49, v57, v17, v49
    v_accvgpr_read_b32 v58, a92
    v_accvgpr_read_b32 v59, a93
    v_accvgpr_read_b32 v60, a94
    v_accvgpr_read_b32 v61, a95
    v_dot2_f32_bf16 v49, v58, v18, v49
    v_dot2_f32_bf16 v49, v59, v19, v49
    v_dot2_f32_bf16 v49, v60, v20, v49
    v_dot2_f32_bf16 v49, v61, v21, v49
    v_accvgpr_read_b32 v54, a96
    v_accvgpr_read_b32 v55, a97
    v_accvgpr_read_b32 v56, a98
    v_accvgpr_read_b32 v57, a99
    v_dot2_f32_bf16 v50, v54, v14, 0
    v_dot2_f32_bf16 v50, v55, v15, v50
    v_dot2_f32_bf16 v50, v56, v16, v50
    v_dot2_f32_bf16 v50, v57, v17, v50
    v_accvgpr_read_b32 v58, a100
    v_accvgpr_read_b32 v59, a101
    v_accvgpr_read_b32 v60, a102
    v_accvgpr_read_b32 v61, a103
    v_dot2_f32_bf16 v50, v58, v18, v50
    v_dot2_f32_bf16 v50, v59, v19, v50
    v_dot2_f32_bf16 v50, v60, v20, v50
    v_dot2_f32_bf16 v50, v61, v21, v50
    v_accvgpr_read_b32 v54, a104
    v_accvgpr_read_b32 v55, a105
    v_accvgpr_read_b32 v56, a106
    v_accvgpr_read_b32 v57, a107
    v_dot2_f32_bf16 v51, v54, v14, 0
    v_dot2_f32_bf16 v51, v55, v15, v51
    v_dot2_f32_bf16 v51, v56, v16, v51
    v_dot2_f32_bf16 v51, v57, v17, v51
    v_accvgpr_read_b32 v58, a108
    v_accvgpr_read_b32 v59, a109
    v_accvgpr_read_b32 v60, a110
    v_accvgpr_read_b32 v61, a111
    v_dot2_f32_bf16 v51, v58, v18, v51
    v_dot2_f32_bf16 v51, v59, v19, v51
    v_dot2_f32_bf16 v51, v60, v20, v51
    v_dot2_f32_bf16 v51, v61, v21, v51
    s_waitcnt vmcnt(6)
    s_xor_b32 s68, s69, 0x24800
    buffer_load_dwordx4 v[80:83], v1, s[4:7], s68 offen nt
    v_accvgpr_read_b32 v54, a112
    v_accvgpr_read_b32 v55, a113
    v_accvgpr_read_b32 v56, a114
    v_accvgpr_read_b32 v57, a115
    v_dot2_f32_bf16 v52, v54, v14, 0
    v_dot2_f32_bf16 v52, v55, v15, v52
    v_dot2_f32_bf16 v52, v56, v16, v52
    v_dot2_f32_bf16 v52, v57, v17, v52
    v_accvgpr_read_b32 v58, a116
    v_accvgpr_read_b32 v59, a117
    v_accvgpr_read_b32 v60, a118
    v_accvgpr_read_b32 v61, a119
    v_dot2_f32_bf16 v52, v58, v18, v52
    v_dot2_f32_bf16 v52, v59, v19, v52
    v_dot2_f32_bf16 v52, v60, v20, v52
    v_dot2_f32_bf16 v52, v61, v21, v52
    v_accvgpr_read_b32 v54, a120
    v_accvgpr_read_b32 v55, a121
    v_accvgpr_read_b32 v56, a122
    v_accvgpr_read_b32 v57, a123
    v_dot2_f32_bf16 v53, v54, v14, 0
    v_dot2_f32_bf16 v53, v55, v15, v53
    v_dot2_f32_bf16 v53, v56, v16, v53
    v_dot2_f32_bf16 v53, v57, v17, v53
    v_accvgpr_read_b32 v58, a124
    v_accvgpr_read_b32 v59, a125
    v_accvgpr_read_b32 v60, a126
    v_accvgpr_read_b32 v61, a127
    v_dot2_f32_bf16 v53, v58, v18, v53
    v_dot2_f32_bf16 v53, v59, v19, v53
    v_dot2_f32_bf16 v53, v60, v20, v53
    v_dot2_f32_bf16 v53, v61, v21, v53
    s_nop 2
    v_add_f32_dpp v38, v38, v38 row_mirror row_mask:0xf bank_mask:0x3
    v_add_f32_dpp v40, v40, v40 row_mirror row_mask:0xf bank_mask:0x3
    v_add_f32_dpp v42, v42, v42 row_mirror row_mask:0xf bank_mask:0x3
    v_add_f32_dpp v44, v44, v44 row_mirror row_mask:0xf bank_mask:0x3
    v_add_f32_dpp v46, v46, v46 row_mirror row_mask:0xf bank_mask:0x3
    v_add_f32_dpp v48, v48, v48 row_mirror row_mask:0xf bank_mask:0x3
    v_add_f32_dpp v50, v50, v50 row_mirror row_mask:0xf bank_mask:0x3
    v_add_f32_dpp v52, v52, v52 row_mirror row_mask:0xf bank_mask:0x3
    v_add_f32_dpp v38, v39, v39 row_mirror row_mask:0xf bank_mask:0xc
    v_add_f32_dpp v40, v41, v41 row_mirror row_mask:0xf bank_mask:0xc
    v_add_f32_dpp v42, v43, v43 row_mirror row_mask:0xf bank_mask:0xc
    v_add_f32_dpp v44, v45, v45 row_mirror row_mask:0xf bank_mask:0xc
    v_add_f32_dpp v46, v47, v47 row_mirror row_mask:0xf bank_mask:0xc
    v_add_f32_dpp v48, v49, v49 row_mirror row_mask:0xf bank_mask:0xc
    v_add_f32_dpp v50, v51, v51 row_mirror row_mask:0xf bank_mask:0xc
    v_add_f32_dpp v52, v53, v53 row_mirror row_mask:0xf bank_mask:0xc
    s_waitcnt vmcnt(6)
    buffer_load_dwordx4 v[84:87], v1, s[4:7], s68 offen offset:256 nt
    s_movk_i32 s71, 28672
    buffer_load_dwordx4 v[140:143], v5, s[20:23], s71 offen
    v_add_f32_dpp v38, v38, v38 row_half_mirror row_mask:0xf bank_mask:0x5
    v_add_f32_dpp v42, v42, v42 row_half_mirror row_mask:0xf bank_mask:0x5
    v_add_f32_dpp v46, v46, v46 row_half_mirror row_mask:0xf bank_mask:0x5
    v_add_f32_dpp v50, v50, v50 row_half_mirror row_mask:0xf bank_mask:0x5
    v_add_f32_dpp v38, v40, v40 row_half_mirror row_mask:0xf bank_mask:0xa
    v_add_f32_dpp v42, v44, v44 row_half_mirror row_mask:0xf bank_mask:0xa
    v_add_f32_dpp v46, v48, v48 row_half_mirror row_mask:0xf bank_mask:0xa
    v_add_f32_dpp v50, v52, v52 row_half_mirror row_mask:0xf bank_mask:0xa
    v_add_f32_dpp v38, v38, v38 quad_perm:[1,0,3,2] row_mask:0xf bank_mask:0xf
    v_add_f32_dpp v42, v42, v42 quad_perm:[1,0,3,2] row_mask:0xf bank_mask:0xf
    v_add_f32_dpp v46, v46, v46 quad_perm:[1,0,3,2] row_mask:0xf bank_mask:0xf
    v_add_f32_dpp v50, v50, v50 quad_perm:[1,0,3,2] row_mask:0xf bank_mask:0xf
    v_add_f32_dpp v38, v38, v38 quad_perm:[2,3,0,1] row_mask:0xf bank_mask:0xf
    v_add_f32_dpp v42, v42, v42 quad_perm:[2,3,0,1] row_mask:0xf bank_mask:0xf
    v_add_f32_dpp v46, v46, v46 quad_perm:[2,3,0,1] row_mask:0xf bank_mask:0xf
    v_add_f32_dpp v50, v50, v50 quad_perm:[2,3,0,1] row_mask:0xf bank_mask:0xf
    s_mov_b32 vcc_lo, 0xaaaaaaaa
    s_mov_b32 vcc_hi, 0xaaaaaaaa
    v_cndmask_b32 v38, v38, v42, vcc
    v_cndmask_b32 v46, v46, v50, vcc
    s_mov_b32 vcc_lo, 0xcccccccc
    s_mov_b32 vcc_hi, 0xcccccccc
    v_cndmask_b32 v22, v38, v46, vcc
    v_accvgpr_read_b32 v54, a128
    v_accvgpr_read_b32 v55, a129
    v_accvgpr_read_b32 v56, a130
    v_accvgpr_read_b32 v57, a131
    v_dot2_f32_bf16 v38, v54, v14, 0
    v_dot2_f32_bf16 v38, v55, v15, v38
    v_dot2_f32_bf16 v38, v56, v16, v38
    v_dot2_f32_bf16 v38, v57, v17, v38
    v_accvgpr_read_b32 v58, a132
    v_accvgpr_read_b32 v59, a133
    v_accvgpr_read_b32 v60, a134
    v_accvgpr_read_b32 v61, a135
    v_dot2_f32_bf16 v38, v58, v18, v38
    v_dot2_f32_bf16 v38, v59, v19, v38
    v_dot2_f32_bf16 v38, v60, v20, v38
    v_dot2_f32_bf16 v38, v61, v21, v38
    v_accvgpr_read_b32 v54, a136
    v_accvgpr_read_b32 v55, a137
    v_accvgpr_read_b32 v56, a138
    v_accvgpr_read_b32 v57, a139
    v_dot2_f32_bf16 v39, v54, v14, 0
    v_dot2_f32_bf16 v39, v55, v15, v39
    v_dot2_f32_bf16 v39, v56, v16, v39
    v_dot2_f32_bf16 v39, v57, v17, v39
    s_waitcnt vmcnt(7)
    s_xor_b32 s68, s69, 0x24200
    buffer_load_dwordx4 v[88:91], v1, s[4:7], s68 offen nt
    v_accvgpr_read_b32 v58, a140
    v_accvgpr_read_b32 v59, a141
    v_accvgpr_read_b32 v60, a142
    v_accvgpr_read_b32 v61, a143
    v_dot2_f32_bf16 v39, v58, v18, v39
    v_dot2_f32_bf16 v39, v59, v19, v39
    v_dot2_f32_bf16 v39, v60, v20, v39
    v_dot2_f32_bf16 v39, v61, v21, v39
    v_accvgpr_read_b32 v54, a144
    v_accvgpr_read_b32 v55, a145
    v_accvgpr_read_b32 v56, a146
    v_accvgpr_read_b32 v57, a147
    v_dot2_f32_bf16 v40, v54, v14, 0
    v_dot2_f32_bf16 v40, v55, v15, v40
    v_dot2_f32_bf16 v40, v56, v16, v40
    v_dot2_f32_bf16 v40, v57, v17, v40
    v_accvgpr_read_b32 v58, a148
    v_accvgpr_read_b32 v59, a149
    v_accvgpr_read_b32 v60, a150
    v_accvgpr_read_b32 v61, a151
    v_dot2_f32_bf16 v40, v58, v18, v40
    v_dot2_f32_bf16 v40, v59, v19, v40
    v_dot2_f32_bf16 v40, v60, v20, v40
    v_dot2_f32_bf16 v40, v61, v21, v40
    v_accvgpr_read_b32 v54, a152
    v_accvgpr_read_b32 v55, a153
    v_accvgpr_read_b32 v56, a154
    v_accvgpr_read_b32 v57, a155
    v_dot2_f32_bf16 v41, v54, v14, 0
    v_dot2_f32_bf16 v41, v55, v15, v41
    v_dot2_f32_bf16 v41, v56, v16, v41
    v_dot2_f32_bf16 v41, v57, v17, v41
    v_accvgpr_read_b32 v58, a156
    v_accvgpr_read_b32 v59, a157
    v_accvgpr_read_b32 v60, a158
    v_accvgpr_read_b32 v61, a159
    v_dot2_f32_bf16 v41, v58, v18, v41
    v_dot2_f32_bf16 v41, v59, v19, v41
    v_dot2_f32_bf16 v41, v60, v20, v41
    v_dot2_f32_bf16 v41, v61, v21, v41
    v_accvgpr_read_b32 v54, a160
    v_accvgpr_read_b32 v55, a161
    v_accvgpr_read_b32 v56, a162
    v_accvgpr_read_b32 v57, a163
    v_dot2_f32_bf16 v42, v54, v14, 0
    v_dot2_f32_bf16 v42, v55, v15, v42
    v_dot2_f32_bf16 v42, v56, v16, v42
    v_dot2_f32_bf16 v42, v57, v17, v42
    v_accvgpr_read_b32 v58, a164
    v_accvgpr_read_b32 v59, a165
    v_accvgpr_read_b32 v60, a166
    v_accvgpr_read_b32 v61, a167
    v_dot2_f32_bf16 v42, v58, v18, v42
    v_dot2_f32_bf16 v42, v59, v19, v42
    v_dot2_f32_bf16 v42, v60, v20, v42
    v_dot2_f32_bf16 v42, v61, v21, v42
    s_waitcnt vmcnt(7)
    buffer_load_dwordx4 v[92:95], v1, s[4:7], s68 offen offset:256 nt
    v_accvgpr_read_b32 v54, a168
    v_accvgpr_read_b32 v55, a169
    v_accvgpr_read_b32 v56, a170
    v_accvgpr_read_b32 v57, a171
    v_dot2_f32_bf16 v43, v54, v14, 0
    v_dot2_f32_bf16 v43, v55, v15, v43
    v_dot2_f32_bf16 v43, v56, v16, v43
    v_dot2_f32_bf16 v43, v57, v17, v43
    v_accvgpr_read_b32 v58, a172
    v_accvgpr_read_b32 v59, a173
    v_accvgpr_read_b32 v60, a174
    v_accvgpr_read_b32 v61, a175
    v_dot2_f32_bf16 v43, v58, v18, v43
    v_dot2_f32_bf16 v43, v59, v19, v43
    v_dot2_f32_bf16 v43, v60, v20, v43
    v_dot2_f32_bf16 v43, v61, v21, v43
    v_accvgpr_read_b32 v54, a176
    v_accvgpr_read_b32 v55, a177
    v_accvgpr_read_b32 v56, a178
    v_accvgpr_read_b32 v57, a179
    v_dot2_f32_bf16 v44, v54, v14, 0
    v_dot2_f32_bf16 v44, v55, v15, v44
    v_dot2_f32_bf16 v44, v56, v16, v44
    v_dot2_f32_bf16 v44, v57, v17, v44
    v_accvgpr_read_b32 v58, a180
    v_accvgpr_read_b32 v59, a181
    v_accvgpr_read_b32 v60, a182
    v_accvgpr_read_b32 v61, a183
    v_dot2_f32_bf16 v44, v58, v18, v44
    v_dot2_f32_bf16 v44, v59, v19, v44
    v_dot2_f32_bf16 v44, v60, v20, v44
    v_dot2_f32_bf16 v44, v61, v21, v44
    v_accvgpr_read_b32 v54, a184
    v_accvgpr_read_b32 v55, a185
    v_accvgpr_read_b32 v56, a186
    v_accvgpr_read_b32 v57, a187
    v_dot2_f32_bf16 v45, v54, v14, 0
    v_dot2_f32_bf16 v45, v55, v15, v45
    v_dot2_f32_bf16 v45, v56, v16, v45
    v_dot2_f32_bf16 v45, v57, v17, v45
    v_accvgpr_read_b32 v58, a188
    v_accvgpr_read_b32 v59, a189
    v_accvgpr_read_b32 v60, a190
    v_accvgpr_read_b32 v61, a191
    v_dot2_f32_bf16 v45, v58, v18, v45
    v_dot2_f32_bf16 v45, v59, v19, v45
    v_dot2_f32_bf16 v45, v60, v20, v45
    v_dot2_f32_bf16 v45, v61, v21, v45
    v_accvgpr_read_b32 v54, a192
    v_accvgpr_read_b32 v55, a193
    v_accvgpr_read_b32 v56, a194
    v_accvgpr_read_b32 v57, a195
    v_dot2_f32_bf16 v46, v54, v14, 0
    v_dot2_f32_bf16 v46, v55, v15, v46
    v_dot2_f32_bf16 v46, v56, v16, v46
    v_dot2_f32_bf16 v46, v57, v17, v46
    s_waitcnt vmcnt(7)
    s_xor_b32 s68, s69, 0x24a00
    buffer_load_dwordx4 v[96:99], v1, s[4:7], s68 offen nt
    s_mov_b32 s71, 57344
    buffer_load_dwordx4 v[144:147], v5, s[20:23], s71 offen
    v_accvgpr_read_b32 v58, a196
    v_accvgpr_read_b32 v59, a197
    v_accvgpr_read_b32 v60, a198
    v_accvgpr_read_b32 v61, a199
    v_dot2_f32_bf16 v46, v58, v18, v46
    v_dot2_f32_bf16 v46, v59, v19, v46
    v_dot2_f32_bf16 v46, v60, v20, v46
    v_dot2_f32_bf16 v46, v61, v21, v46
    v_accvgpr_read_b32 v54, a200
    v_accvgpr_read_b32 v55, a201
    v_accvgpr_read_b32 v56, a202
    v_accvgpr_read_b32 v57, a203
    v_dot2_f32_bf16 v47, v54, v14, 0
    v_dot2_f32_bf16 v47, v55, v15, v47
    v_dot2_f32_bf16 v47, v56, v16, v47
    v_dot2_f32_bf16 v47, v57, v17, v47
    v_accvgpr_read_b32 v58, a204
    v_accvgpr_read_b32 v59, a205
    v_accvgpr_read_b32 v60, a206
    v_accvgpr_read_b32 v61, a207
    v_dot2_f32_bf16 v47, v58, v18, v47
    v_dot2_f32_bf16 v47, v59, v19, v47
    v_dot2_f32_bf16 v47, v60, v20, v47
    v_dot2_f32_bf16 v47, v61, v21, v47
    v_accvgpr_read_b32 v54, a208
    v_accvgpr_read_b32 v55, a209
    v_accvgpr_read_b32 v56, a210
    v_accvgpr_read_b32 v57, a211
    v_dot2_f32_bf16 v48, v54, v14, 0
    v_dot2_f32_bf16 v48, v55, v15, v48
    v_dot2_f32_bf16 v48, v56, v16, v48
    v_dot2_f32_bf16 v48, v57, v17, v48
    v_accvgpr_read_b32 v58, a212
    v_accvgpr_read_b32 v59, a213
    v_accvgpr_read_b32 v60, a214
    v_accvgpr_read_b32 v61, a215
    v_dot2_f32_bf16 v48, v58, v18, v48
    v_dot2_f32_bf16 v48, v59, v19, v48
    v_dot2_f32_bf16 v48, v60, v20, v48
    v_dot2_f32_bf16 v48, v61, v21, v48
    v_accvgpr_read_b32 v54, a216
    v_accvgpr_read_b32 v55, a217
    v_accvgpr_read_b32 v56, a218
    v_accvgpr_read_b32 v57, a219
    v_dot2_f32_bf16 v49, v54, v14, 0
    v_dot2_f32_bf16 v49, v55, v15, v49
    v_dot2_f32_bf16 v49, v56, v16, v49
    v_dot2_f32_bf16 v49, v57, v17, v49
    v_accvgpr_read_b32 v58, a220
    v_accvgpr_read_b32 v59, a221
    v_accvgpr_read_b32 v60, a222
    v_accvgpr_read_b32 v61, a223
    v_dot2_f32_bf16 v49, v58, v18, v49
    v_dot2_f32_bf16 v49, v59, v19, v49
    v_dot2_f32_bf16 v49, v60, v20, v49
    v_dot2_f32_bf16 v49, v61, v21, v49
    s_waitcnt vmcnt(7)
    buffer_load_dwordx4 v[100:103], v1, s[4:7], s68 offen offset:256 nt
    v_accvgpr_read_b32 v54, a224
    v_accvgpr_read_b32 v55, a225
    v_accvgpr_read_b32 v56, a226
    v_accvgpr_read_b32 v57, a227
    v_dot2_f32_bf16 v50, v54, v14, 0
    v_dot2_f32_bf16 v50, v55, v15, v50
    v_dot2_f32_bf16 v50, v56, v16, v50
    v_dot2_f32_bf16 v50, v57, v17, v50
    v_accvgpr_read_b32 v58, a228
    v_accvgpr_read_b32 v59, a229
    v_accvgpr_read_b32 v60, a230
    v_accvgpr_read_b32 v61, a231
    v_dot2_f32_bf16 v50, v58, v18, v50
    v_dot2_f32_bf16 v50, v59, v19, v50
    v_dot2_f32_bf16 v50, v60, v20, v50
    v_dot2_f32_bf16 v50, v61, v21, v50
    v_accvgpr_read_b32 v54, a232
    v_accvgpr_read_b32 v55, a233
    v_accvgpr_read_b32 v56, a234
    v_accvgpr_read_b32 v57, a235
    v_dot2_f32_bf16 v51, v54, v14, 0
    v_dot2_f32_bf16 v51, v55, v15, v51
    v_dot2_f32_bf16 v51, v56, v16, v51
    v_dot2_f32_bf16 v51, v57, v17, v51
    v_accvgpr_read_b32 v58, a236
    v_accvgpr_read_b32 v59, a237
    v_accvgpr_read_b32 v60, a238
    v_accvgpr_read_b32 v61, a239
    v_dot2_f32_bf16 v51, v58, v18, v51
    v_dot2_f32_bf16 v51, v59, v19, v51
    v_dot2_f32_bf16 v51, v60, v20, v51
    v_dot2_f32_bf16 v51, v61, v21, v51
    v_accvgpr_read_b32 v54, a240
    v_accvgpr_read_b32 v55, a241
    v_accvgpr_read_b32 v56, a242
    v_accvgpr_read_b32 v57, a243
    v_dot2_f32_bf16 v52, v54, v14, 0
    v_dot2_f32_bf16 v52, v55, v15, v52
    v_dot2_f32_bf16 v52, v56, v16, v52
    v_dot2_f32_bf16 v52, v57, v17, v52
    v_accvgpr_read_b32 v58, a244
    v_accvgpr_read_b32 v59, a245
    v_accvgpr_read_b32 v60, a246
    v_accvgpr_read_b32 v61, a247
    v_dot2_f32_bf16 v52, v58, v18, v52
    v_dot2_f32_bf16 v52, v59, v19, v52
    v_dot2_f32_bf16 v52, v60, v20, v52
    v_dot2_f32_bf16 v52, v61, v21, v52
    v_accvgpr_read_b32 v54, a248
    v_accvgpr_read_b32 v55, a249
    v_accvgpr_read_b32 v56, a250
    v_accvgpr_read_b32 v57, a251
    v_dot2_f32_bf16 v53, v54, v14, 0
    v_dot2_f32_bf16 v53, v55, v15, v53
    v_dot2_f32_bf16 v53, v56, v16, v53
    v_dot2_f32_bf16 v53, v57, v17, v53
    v_accvgpr_read_b32 v58, a252
    v_accvgpr_read_b32 v59, a253
    v_accvgpr_read_b32 v60, a254
    v_accvgpr_read_b32 v61, a255
    v_dot2_f32_bf16 v53, v58, v18, v53
    v_dot2_f32_bf16 v53, v59, v19, v53
    v_dot2_f32_bf16 v53, v60, v20, v53
    v_dot2_f32_bf16 v53, v61, v21, v53
    s_nop 2
    v_add_f32_dpp v38, v38, v38 row_mirror row_mask:0xf bank_mask:0x3
    v_add_f32_dpp v40, v40, v40 row_mirror row_mask:0xf bank_mask:0x3
    v_add_f32_dpp v42, v42, v42 row_mirror row_mask:0xf bank_mask:0x3
    v_add_f32_dpp v44, v44, v44 row_mirror row_mask:0xf bank_mask:0x3
    v_add_f32_dpp v46, v46, v46 row_mirror row_mask:0xf bank_mask:0x3
    v_add_f32_dpp v48, v48, v48 row_mirror row_mask:0xf bank_mask:0x3
    v_add_f32_dpp v50, v50, v50 row_mirror row_mask:0xf bank_mask:0x3
    v_add_f32_dpp v52, v52, v52 row_mirror row_mask:0xf bank_mask:0x3
    v_add_f32_dpp v38, v39, v39 row_mirror row_mask:0xf bank_mask:0xc
    v_add_f32_dpp v40, v41, v41 row_mirror row_mask:0xf bank_mask:0xc
    v_add_f32_dpp v42, v43, v43 row_mirror row_mask:0xf bank_mask:0xc
    v_add_f32_dpp v44, v45, v45 row_mirror row_mask:0xf bank_mask:0xc
    v_add_f32_dpp v46, v47, v47 row_mirror row_mask:0xf bank_mask:0xc
    v_add_f32_dpp v48, v49, v49 row_mirror row_mask:0xf bank_mask:0xc
    v_add_f32_dpp v50, v51, v51 row_mirror row_mask:0xf bank_mask:0xc
    v_add_f32_dpp v52, v53, v53 row_mirror row_mask:0xf bank_mask:0xc
    v_add_f32_dpp v38, v38, v38 row_half_mirror row_mask:0xf bank_mask:0x5
    v_add_f32_dpp v42, v42, v42 row_half_mirror row_mask:0xf bank_mask:0x5
    v_add_f32_dpp v46, v46, v46 row_half_mirror row_mask:0xf bank_mask:0x5
    v_add_f32_dpp v50, v50, v50 row_half_mirror row_mask:0xf bank_mask:0x5
    v_add_f32_dpp v38, v40, v40 row_half_mirror row_mask:0xf bank_mask:0xa
    v_add_f32_dpp v42, v44, v44 row_half_mirror row_mask:0xf bank_mask:0xa
    v_add_f32_dpp v46, v48, v48 row_half_mirror row_mask:0xf bank_mask:0xa
    v_add_f32_dpp v50, v52, v52 row_half_mirror row_mask:0xf bank_mask:0xa
    v_add_f32_dpp v38, v38, v38 quad_perm:[1,0,3,2] row_mask:0xf bank_mask:0xf
    v_add_f32_dpp v42, v42, v42 quad_perm:[1,0,3,2] row_mask:0xf bank_mask:0xf
    v_add_f32_dpp v46, v46, v46 quad_perm:[1,0,3,2] row_mask:0xf bank_mask:0xf
    v_add_f32_dpp v50, v50, v50 quad_perm:[1,0,3,2] row_mask:0xf bank_mask:0xf
    v_add_f32_dpp v38, v38, v38 quad_perm:[2,3,0,1] row_mask:0xf bank_mask:0xf
    v_add_f32_dpp v42, v42, v42 quad_perm:[2,3,0,1] row_mask:0xf bank_mask:0xf
    v_add_f32_dpp v46, v46, v46 quad_perm:[2,3,0,1] row_mask:0xf bank_mask:0xf
    v_add_f32_dpp v50, v50, v50 quad_perm:[2,3,0,1] row_mask:0xf bank_mask:0xf
    s_mov_b32 vcc_lo, 0xaaaaaaaa
    s_mov_b32 vcc_hi, 0xaaaaaaaa
    v_cndmask_b32 v38, v38, v42, vcc
    v_cndmask_b32 v46, v46, v50, vcc
    s_mov_b32 vcc_lo, 0xcccccccc
    s_mov_b32 vcc_hi, 0xcccccccc
    v_cndmask_b32 v23, v38, v46, vcc
    v_dot2_f32_bf16 v38, v160, v14, 0
    v_dot2_f32_bf16 v38, v161, v15, v38
    v_dot2_f32_bf16 v38, v162, v16, v38
    v_dot2_f32_bf16 v38, v163, v17, v38
    v_dot2_f32_bf16 v38, v164, v18, v38
    v_dot2_f32_bf16 v38, v165, v19, v38
    v_dot2_f32_bf16 v38, v166, v20, v38
    v_dot2_f32_bf16 v38, v167, v21, v38
    v_dot2_f32_bf16 v39, v168, v14, 0
    v_dot2_f32_bf16 v39, v169, v15, v39
    v_dot2_f32_bf16 v39, v170, v16, v39
    v_dot2_f32_bf16 v39, v171, v17, v39
    v_dot2_f32_bf16 v39, v172, v18, v39
    v_dot2_f32_bf16 v39, v173, v19, v39
    v_dot2_f32_bf16 v39, v174, v20, v39
    v_dot2_f32_bf16 v39, v175, v21, v39
    v_dot2_f32_bf16 v40, v176, v14, 0
    v_dot2_f32_bf16 v40, v177, v15, v40
    v_dot2_f32_bf16 v40, v178, v16, v40
    v_dot2_f32_bf16 v40, v179, v17, v40
    v_dot2_f32_bf16 v40, v180, v18, v40
    v_dot2_f32_bf16 v40, v181, v19, v40
    v_dot2_f32_bf16 v40, v182, v20, v40
    v_dot2_f32_bf16 v40, v183, v21, v40
    v_dot2_f32_bf16 v41, v184, v14, 0
    v_dot2_f32_bf16 v41, v185, v15, v41
    v_dot2_f32_bf16 v41, v186, v16, v41
    v_dot2_f32_bf16 v41, v187, v17, v41
    v_dot2_f32_bf16 v41, v188, v18, v41
    v_dot2_f32_bf16 v41, v189, v19, v41
    v_dot2_f32_bf16 v41, v190, v20, v41
    v_dot2_f32_bf16 v41, v191, v21, v41
    v_dot2_f32_bf16 v42, v192, v14, 0
    v_dot2_f32_bf16 v42, v193, v15, v42
    v_dot2_f32_bf16 v42, v194, v16, v42
    v_dot2_f32_bf16 v42, v195, v17, v42
    v_dot2_f32_bf16 v42, v196, v18, v42
    v_dot2_f32_bf16 v42, v197, v19, v42
    v_dot2_f32_bf16 v42, v198, v20, v42
    v_dot2_f32_bf16 v42, v199, v21, v42
    v_dot2_f32_bf16 v43, v200, v14, 0
    v_dot2_f32_bf16 v43, v201, v15, v43
    v_dot2_f32_bf16 v43, v202, v16, v43
    v_dot2_f32_bf16 v43, v203, v17, v43
    v_dot2_f32_bf16 v43, v204, v18, v43
    v_dot2_f32_bf16 v43, v205, v19, v43
    v_dot2_f32_bf16 v43, v206, v20, v43
    v_dot2_f32_bf16 v43, v207, v21, v43
    v_dot2_f32_bf16 v44, v208, v14, 0
    v_dot2_f32_bf16 v44, v209, v15, v44
    v_dot2_f32_bf16 v44, v210, v16, v44
    v_dot2_f32_bf16 v44, v211, v17, v44
    v_dot2_f32_bf16 v44, v212, v18, v44
    v_dot2_f32_bf16 v44, v213, v19, v44
    v_dot2_f32_bf16 v44, v214, v20, v44
    v_dot2_f32_bf16 v44, v215, v21, v44
    v_dot2_f32_bf16 v45, v216, v14, 0
    v_dot2_f32_bf16 v45, v217, v15, v45
    v_dot2_f32_bf16 v45, v218, v16, v45
    v_dot2_f32_bf16 v45, v219, v17, v45
    v_dot2_f32_bf16 v45, v220, v18, v45
    v_dot2_f32_bf16 v45, v221, v19, v45
    v_dot2_f32_bf16 v45, v222, v20, v45
    v_dot2_f32_bf16 v45, v223, v21, v45
    v_dot2_f32_bf16 v46, v224, v14, 0
    v_dot2_f32_bf16 v46, v225, v15, v46
    v_dot2_f32_bf16 v46, v226, v16, v46
    v_dot2_f32_bf16 v46, v227, v17, v46
    v_dot2_f32_bf16 v46, v228, v18, v46
    v_dot2_f32_bf16 v46, v229, v19, v46
    v_dot2_f32_bf16 v46, v230, v20, v46
    v_dot2_f32_bf16 v46, v231, v21, v46
    v_dot2_f32_bf16 v47, v232, v14, 0
    v_dot2_f32_bf16 v47, v233, v15, v47
    v_dot2_f32_bf16 v47, v234, v16, v47
    v_dot2_f32_bf16 v47, v235, v17, v47
    v_dot2_f32_bf16 v47, v236, v18, v47
    v_dot2_f32_bf16 v47, v237, v19, v47
    v_dot2_f32_bf16 v47, v238, v20, v47
    v_dot2_f32_bf16 v47, v239, v21, v47
    v_dot2_f32_bf16 v48, v240, v14, 0
    v_dot2_f32_bf16 v48, v241, v15, v48
    v_dot2_f32_bf16 v48, v242, v16, v48
    v_dot2_f32_bf16 v48, v243, v17, v48
    v_dot2_f32_bf16 v48, v244, v18, v48
    v_dot2_f32_bf16 v48, v245, v19, v48
    v_dot2_f32_bf16 v48, v246, v20, v48
    v_dot2_f32_bf16 v48, v247, v21, v48
    v_dot2_f32_bf16 v49, v248, v14, 0
    v_dot2_f32_bf16 v49, v249, v15, v49
    v_dot2_f32_bf16 v49, v250, v16, v49
    v_dot2_f32_bf16 v49, v251, v17, v49
    v_dot2_f32_bf16 v49, v252, v18, v49
    v_dot2_f32_bf16 v49, v253, v19, v49
    v_dot2_f32_bf16 v49, v254, v20, v49
    v_dot2_f32_bf16 v49, v255, v21, v49
    v_dot2_f32_bf16 v50, v104, v14, 0
    v_dot2_f32_bf16 v50, v105, v15, v50
    v_dot2_f32_bf16 v50, v106, v16, v50
    v_dot2_f32_bf16 v50, v107, v17, v50
    v_dot2_f32_bf16 v50, v108, v18, v50
    v_dot2_f32_bf16 v50, v109, v19, v50
    v_dot2_f32_bf16 v50, v110, v20, v50
    v_dot2_f32_bf16 v50, v111, v21, v50
    v_dot2_f32_bf16 v51, v112, v14, 0
    v_dot2_f32_bf16 v51, v113, v15, v51
    v_dot2_f32_bf16 v51, v114, v16, v51
    v_dot2_f32_bf16 v51, v115, v17, v51
    s_waitcnt vmcnt(7)
    s_xor_b32 s68, s69, 0x2c000
    buffer_load_dwordx4 v[104:107], v1, s[4:7], s68 offen nt
    v_dot2_f32_bf16 v51, v116, v18, v51
    v_dot2_f32_bf16 v51, v117, v19, v51
    v_dot2_f32_bf16 v51, v118, v20, v51
    v_dot2_f32_bf16 v51, v119, v21, v51
    v_dot2_f32_bf16 v52, v120, v14, 0
    v_dot2_f32_bf16 v52, v121, v15, v52
    v_dot2_f32_bf16 v52, v122, v16, v52
    v_dot2_f32_bf16 v52, v123, v17, v52
    v_dot2_f32_bf16 v52, v124, v18, v52
    v_dot2_f32_bf16 v52, v125, v19, v52
    v_dot2_f32_bf16 v52, v126, v20, v52
    v_dot2_f32_bf16 v52, v127, v21, v52
    v_dot2_f32_bf16 v53, v128, v14, 0
    v_dot2_f32_bf16 v53, v129, v15, v53
    v_dot2_f32_bf16 v53, v130, v16, v53
    v_dot2_f32_bf16 v53, v131, v17, v53
    v_dot2_f32_bf16 v53, v132, v18, v53
    v_dot2_f32_bf16 v53, v133, v19, v53
    v_dot2_f32_bf16 v53, v134, v20, v53
    v_dot2_f32_bf16 v53, v135, v21, v53
    s_nop 2
    v_add_f32_dpp v38, v38, v38 row_mirror row_mask:0xf bank_mask:0x3
    v_add_f32_dpp v40, v40, v40 row_mirror row_mask:0xf bank_mask:0x3
    v_add_f32_dpp v42, v42, v42 row_mirror row_mask:0xf bank_mask:0x3
    v_add_f32_dpp v44, v44, v44 row_mirror row_mask:0xf bank_mask:0x3
    v_add_f32_dpp v46, v46, v46 row_mirror row_mask:0xf bank_mask:0x3
    v_add_f32_dpp v48, v48, v48 row_mirror row_mask:0xf bank_mask:0x3
    v_add_f32_dpp v50, v50, v50 row_mirror row_mask:0xf bank_mask:0x3
    v_add_f32_dpp v52, v52, v52 row_mirror row_mask:0xf bank_mask:0x3
    v_add_f32_dpp v38, v39, v39 row_mirror row_mask:0xf bank_mask:0xc
    v_add_f32_dpp v40, v41, v41 row_mirror row_mask:0xf bank_mask:0xc
    v_add_f32_dpp v42, v43, v43 row_mirror row_mask:0xf bank_mask:0xc
    v_add_f32_dpp v44, v45, v45 row_mirror row_mask:0xf bank_mask:0xc
    v_add_f32_dpp v46, v47, v47 row_mirror row_mask:0xf bank_mask:0xc
    v_add_f32_dpp v48, v49, v49 row_mirror row_mask:0xf bank_mask:0xc
    v_add_f32_dpp v50, v51, v51 row_mirror row_mask:0xf bank_mask:0xc
    v_add_f32_dpp v52, v53, v53 row_mirror row_mask:0xf bank_mask:0xc
    s_waitcnt vmcnt(7)
    buffer_load_dwordx4 v[108:111], v1, s[4:7], s68 offen offset:256 nt
    s_mov_b32 s71, 86016
    buffer_load_dwordx4 v[148:151], v5, s[20:23], s71 offen
    v_add_f32_dpp v38, v38, v38 row_half_mirror row_mask:0xf bank_mask:0x5
    v_add_f32_dpp v42, v42, v42 row_half_mirror row_mask:0xf bank_mask:0x5
    v_add_f32_dpp v46, v46, v46 row_half_mirror row_mask:0xf bank_mask:0x5
    v_add_f32_dpp v50, v50, v50 row_half_mirror row_mask:0xf bank_mask:0x5
    v_add_f32_dpp v38, v40, v40 row_half_mirror row_mask:0xf bank_mask:0xa
    v_add_f32_dpp v42, v44, v44 row_half_mirror row_mask:0xf bank_mask:0xa
    v_add_f32_dpp v46, v48, v48 row_half_mirror row_mask:0xf bank_mask:0xa
    v_add_f32_dpp v50, v52, v52 row_half_mirror row_mask:0xf bank_mask:0xa
    v_add_f32_dpp v38, v38, v38 quad_perm:[1,0,3,2] row_mask:0xf bank_mask:0xf
    v_add_f32_dpp v42, v42, v42 quad_perm:[1,0,3,2] row_mask:0xf bank_mask:0xf
    v_add_f32_dpp v46, v46, v46 quad_perm:[1,0,3,2] row_mask:0xf bank_mask:0xf
    v_add_f32_dpp v50, v50, v50 quad_perm:[1,0,3,2] row_mask:0xf bank_mask:0xf
    v_add_f32_dpp v38, v38, v38 quad_perm:[2,3,0,1] row_mask:0xf bank_mask:0xf
    v_add_f32_dpp v42, v42, v42 quad_perm:[2,3,0,1] row_mask:0xf bank_mask:0xf
    v_add_f32_dpp v46, v46, v46 quad_perm:[2,3,0,1] row_mask:0xf bank_mask:0xf
    v_add_f32_dpp v50, v50, v50 quad_perm:[2,3,0,1] row_mask:0xf bank_mask:0xf
    s_mov_b32 vcc_lo, 0xaaaaaaaa
    s_mov_b32 vcc_hi, 0xaaaaaaaa
    v_cndmask_b32 v38, v38, v42, vcc
    v_cndmask_b32 v46, v46, v50, vcc
    s_mov_b32 vcc_lo, 0xcccccccc
    s_mov_b32 vcc_hi, 0xcccccccc
    v_cndmask_b32 v24, v38, v46, vcc
    v_dot2_f32_bf16 v38, v72, v14, 0
    v_dot2_f32_bf16 v38, v73, v15, v38
    v_dot2_f32_bf16 v38, v74, v16, v38
    v_dot2_f32_bf16 v38, v75, v17, v38
    v_dot2_f32_bf16 v38, v76, v18, v38
    v_dot2_f32_bf16 v38, v77, v19, v38
    v_dot2_f32_bf16 v38, v78, v20, v38
    v_dot2_f32_bf16 v38, v79, v21, v38
    s_waitcnt vmcnt(7)
    s_xor_b32 s68, s69, 0x2c800
    buffer_load_dwordx4 v[112:115], v1, s[4:7], s68 offen nt
    v_dot2_f32_bf16 v39, v80, v14, 0
    v_dot2_f32_bf16 v39, v81, v15, v39
    v_dot2_f32_bf16 v39, v82, v16, v39
    v_dot2_f32_bf16 v39, v83, v17, v39
    v_dot2_f32_bf16 v39, v84, v18, v39
    v_dot2_f32_bf16 v39, v85, v19, v39
    v_dot2_f32_bf16 v39, v86, v20, v39
    v_dot2_f32_bf16 v39, v87, v21, v39
    v_dot2_f32_bf16 v40, v88, v14, 0
    v_dot2_f32_bf16 v40, v89, v15, v40
    v_dot2_f32_bf16 v40, v90, v16, v40
    v_dot2_f32_bf16 v40, v91, v17, v40
    s_waitcnt vmcnt(7)
    buffer_load_dwordx4 v[116:119], v1, s[4:7], s68 offen offset:256 nt
    v_dot2_f32_bf16 v40, v92, v18, v40
    v_dot2_f32_bf16 v40, v93, v19, v40
    v_dot2_f32_bf16 v40, v94, v20, v40
    v_dot2_f32_bf16 v40, v95, v21, v40
    s_waitcnt vmcnt(7)
    s_xor_b32 s68, s69, 0x2c200
    buffer_load_dwordx4 v[120:123], v1, s[4:7], s68 offen nt
    s_mov_b32 s71, 114688
    buffer_load_dwordx4 v[152:155], v5, s[20:23], s71 offen
    v_dot2_f32_bf16 v41, v96, v14, 0
    v_dot2_f32_bf16 v41, v97, v15, v41
    v_dot2_f32_bf16 v41, v98, v16, v41
    v_dot2_f32_bf16 v41, v99, v17, v41
    s_waitcnt vmcnt(7)
    buffer_load_dwordx4 v[124:127], v1, s[4:7], s68 offen offset:256 nt
    v_dot2_f32_bf16 v41, v100, v18, v41
    v_dot2_f32_bf16 v41, v101, v19, v41
    v_dot2_f32_bf16 v41, v102, v20, v41
    v_dot2_f32_bf16 v41, v103, v21, v41
    s_waitcnt vmcnt(7)
    s_xor_b32 s68, s69, 0x2ca00
    buffer_load_dwordx4 v[128:131], v1, s[4:7], s68 offen nt
    v_dot2_f32_bf16 v42, v104, v14, 0
    v_dot2_f32_bf16 v42, v105, v15, v42
    v_dot2_f32_bf16 v42, v106, v16, v42
    v_dot2_f32_bf16 v42, v107, v17, v42
    s_waitcnt vmcnt(7)
    buffer_load_dwordx4 v[132:135], v1, s[4:7], s68 offen offset:256 nt
    s_mov_b32 s71, 143360
    buffer_load_dwordx4 v[156:159], v5, s[20:23], s71 offen
    v_dot2_f32_bf16 v42, v108, v18, v42
    v_dot2_f32_bf16 v42, v109, v19, v42
    v_dot2_f32_bf16 v42, v110, v20, v42
    v_dot2_f32_bf16 v42, v111, v21, v42
    s_waitcnt vmcnt(7)
    s_xor_b32 s68, s69, 0x64000
    buffer_load_dwordx4 v[72:75], v1, s[4:7], s68 offen nt
    v_dot2_f32_bf16 v43, v112, v14, 0
    v_dot2_f32_bf16 v43, v113, v15, v43
    v_dot2_f32_bf16 v43, v114, v16, v43
    v_dot2_f32_bf16 v43, v115, v17, v43
    s_waitcnt vmcnt(7)
    buffer_load_dwordx4 v[76:79], v1, s[4:7], s68 offen offset:256 nt
    v_dot2_f32_bf16 v43, v116, v18, v43
    v_dot2_f32_bf16 v43, v117, v19, v43
    v_dot2_f32_bf16 v43, v118, v20, v43
    v_dot2_f32_bf16 v43, v119, v21, v43
    s_waitcnt vmcnt(7)
    s_xor_b32 s68, s69, 0x64800
    buffer_load_dwordx4 v[80:83], v1, s[4:7], s68 offen nt
    s_mov_b32 s71, 172032
    buffer_load_dwordx4 v[160:163], v5, s[20:23], s71 offen
    v_dot2_f32_bf16 v44, v120, v14, 0
    v_dot2_f32_bf16 v44, v121, v15, v44
    v_dot2_f32_bf16 v44, v122, v16, v44
    v_dot2_f32_bf16 v44, v123, v17, v44
    s_waitcnt vmcnt(7)
    buffer_load_dwordx4 v[84:87], v1, s[4:7], s68 offen offset:256 nt
    v_dot2_f32_bf16 v44, v124, v18, v44
    v_dot2_f32_bf16 v44, v125, v19, v44
    v_dot2_f32_bf16 v44, v126, v20, v44
    v_dot2_f32_bf16 v44, v127, v21, v44
    s_waitcnt vmcnt(7)
    s_xor_b32 s68, s69, 0x64200
    buffer_load_dwordx4 v[88:91], v1, s[4:7], s68 offen nt
    v_dot2_f32_bf16 v45, v128, v14, 0
    v_dot2_f32_bf16 v45, v129, v15, v45
    v_dot2_f32_bf16 v45, v130, v16, v45
    v_dot2_f32_bf16 v45, v131, v17, v45
    s_waitcnt vmcnt(7)
    buffer_load_dwordx4 v[92:95], v1, s[4:7], s68 offen offset:256 nt
    s_mov_b32 s71, 200704
    buffer_load_dwordx4 v[164:167], v5, s[20:23], s71 offen
    v_dot2_f32_bf16 v45, v132, v18, v45
    v_dot2_f32_bf16 v45, v133, v19, v45
    v_dot2_f32_bf16 v45, v134, v20, v45
    v_dot2_f32_bf16 v45, v135, v21, v45
    s_waitcnt vmcnt(7)
    s_xor_b32 s68, s69, 0x64a00
    buffer_load_dwordx4 v[96:99], v1, s[4:7], s68 offen nt
    v_dot2_f32_bf16 v46, v72, v14, 0
    v_dot2_f32_bf16 v46, v73, v15, v46
    v_dot2_f32_bf16 v46, v74, v16, v46
    v_dot2_f32_bf16 v46, v75, v17, v46
    s_waitcnt vmcnt(7)
    buffer_load_dwordx4 v[100:103], v1, s[4:7], s68 offen offset:256 nt
    v_dot2_f32_bf16 v46, v76, v18, v46
    v_dot2_f32_bf16 v46, v77, v19, v46
    v_dot2_f32_bf16 v46, v78, v20, v46
    v_dot2_f32_bf16 v46, v79, v21, v46
    s_waitcnt vmcnt(7)
    s_xor_b32 s68, s69, 0x6c000
    buffer_load_dwordx4 v[104:107], v1, s[4:7], s68 offen nt
    s_mov_b32 s71, 229376
    buffer_load_dwordx4 v[168:171], v5, s[20:23], s71 offen
    v_dot2_f32_bf16 v47, v80, v14, 0
    v_dot2_f32_bf16 v47, v81, v15, v47
    v_dot2_f32_bf16 v47, v82, v16, v47
    v_dot2_f32_bf16 v47, v83, v17, v47
    s_waitcnt vmcnt(7)
    buffer_load_dwordx4 v[108:111], v1, s[4:7], s68 offen offset:256 nt
    v_dot2_f32_bf16 v47, v84, v18, v47
    v_dot2_f32_bf16 v47, v85, v19, v47
    v_dot2_f32_bf16 v47, v86, v20, v47
    v_dot2_f32_bf16 v47, v87, v21, v47
    s_waitcnt vmcnt(7)
    s_xor_b32 s68, s69, 0x6c800
    buffer_load_dwordx4 v[112:115], v1, s[4:7], s68 offen nt
    v_dot2_f32_bf16 v48, v88, v14, 0
    v_dot2_f32_bf16 v48, v89, v15, v48
    v_dot2_f32_bf16 v48, v90, v16, v48
    v_dot2_f32_bf16 v48, v91, v17, v48
    s_waitcnt vmcnt(7)
    buffer_load_dwordx4 v[116:119], v1, s[4:7], s68 offen offset:256 nt
    s_mov_b32 s71, 258048
    buffer_load_dwordx4 v[172:175], v5, s[20:23], s71 offen
    v_dot2_f32_bf16 v48, v92, v18, v48
    v_dot2_f32_bf16 v48, v93, v19, v48
    v_dot2_f32_bf16 v48, v94, v20, v48
    v_dot2_f32_bf16 v48, v95, v21, v48
    s_waitcnt vmcnt(7)
    s_xor_b32 s68, s69, 0x6c200
    buffer_load_dwordx4 v[120:123], v1, s[4:7], s68 offen nt
    v_dot2_f32_bf16 v49, v96, v14, 0
    v_dot2_f32_bf16 v49, v97, v15, v49
    v_dot2_f32_bf16 v49, v98, v16, v49
    v_dot2_f32_bf16 v49, v99, v17, v49
    s_waitcnt vmcnt(7)
    buffer_load_dwordx4 v[124:127], v1, s[4:7], s68 offen offset:256 nt
    v_dot2_f32_bf16 v49, v100, v18, v49
    v_dot2_f32_bf16 v49, v101, v19, v49
    v_dot2_f32_bf16 v49, v102, v20, v49
    v_dot2_f32_bf16 v49, v103, v21, v49
    s_waitcnt vmcnt(7)
    s_xor_b32 s68, s69, 0x6ca00
    buffer_load_dwordx4 v[128:131], v1, s[4:7], s68 offen nt
    s_mov_b32 s71, 286720
    buffer_load_dwordx4 v[176:179], v5, s[20:23], s71 offen
    v_dot2_f32_bf16 v50, v104, v14, 0
    v_dot2_f32_bf16 v50, v105, v15, v50
    v_dot2_f32_bf16 v50, v106, v16, v50
    v_dot2_f32_bf16 v50, v107, v17, v50
    s_waitcnt vmcnt(7)
    buffer_load_dwordx4 v[132:135], v1, s[4:7], s68 offen offset:256 nt
    v_dot2_f32_bf16 v50, v108, v18, v50
    v_dot2_f32_bf16 v50, v109, v19, v50
    v_dot2_f32_bf16 v50, v110, v20, v50
    v_dot2_f32_bf16 v50, v111, v21, v50
    s_waitcnt vmcnt(7)
    s_xor_b32 s68, s69, 0x80000
    buffer_load_dwordx4 v[72:75], v1, s[4:7], s68 offen nt
    v_dot2_f32_bf16 v51, v112, v14, 0
    v_dot2_f32_bf16 v51, v113, v15, v51
    v_dot2_f32_bf16 v51, v114, v16, v51
    v_dot2_f32_bf16 v51, v115, v17, v51
    s_waitcnt vmcnt(7)
    buffer_load_dwordx4 v[76:79], v1, s[4:7], s68 offen offset:256 nt
    s_mov_b32 s71, 315392
    buffer_load_dwordx4 v[180:183], v5, s[20:23], s71 offen
    v_dot2_f32_bf16 v51, v116, v18, v51
    v_dot2_f32_bf16 v51, v117, v19, v51
    v_dot2_f32_bf16 v51, v118, v20, v51
    v_dot2_f32_bf16 v51, v119, v21, v51
    s_waitcnt vmcnt(7)
    s_xor_b32 s68, s69, 0x80800
    buffer_load_dwordx4 v[80:83], v1, s[4:7], s68 offen nt
    v_dot2_f32_bf16 v52, v120, v14, 0
    v_dot2_f32_bf16 v52, v121, v15, v52
    v_dot2_f32_bf16 v52, v122, v16, v52
    v_dot2_f32_bf16 v52, v123, v17, v52
    s_waitcnt vmcnt(7)
    buffer_load_dwordx4 v[84:87], v1, s[4:7], s68 offen offset:256 nt
    v_dot2_f32_bf16 v52, v124, v18, v52
    v_dot2_f32_bf16 v52, v125, v19, v52
    v_dot2_f32_bf16 v52, v126, v20, v52
    v_dot2_f32_bf16 v52, v127, v21, v52
    s_waitcnt vmcnt(7)
    s_xor_b32 s68, s69, 0x80200
    buffer_load_dwordx4 v[88:91], v1, s[4:7], s68 offen nt
    s_mov_b32 s71, 344064
    buffer_load_dwordx4 v[184:187], v5, s[20:23], s71 offen
    v_dot2_f32_bf16 v53, v128, v14, 0
    v_dot2_f32_bf16 v53, v129, v15, v53
    v_dot2_f32_bf16 v53, v130, v16, v53
    v_dot2_f32_bf16 v53, v131, v17, v53
    s_waitcnt vmcnt(7)
    buffer_load_dwordx4 v[92:95], v1, s[4:7], s68 offen offset:256 nt
    v_dot2_f32_bf16 v53, v132, v18, v53
    v_dot2_f32_bf16 v53, v133, v19, v53
    v_dot2_f32_bf16 v53, v134, v20, v53
    v_dot2_f32_bf16 v53, v135, v21, v53
    s_nop 2
    v_add_f32_dpp v38, v38, v38 row_mirror row_mask:0xf bank_mask:0x3
    v_add_f32_dpp v40, v40, v40 row_mirror row_mask:0xf bank_mask:0x3
    v_add_f32_dpp v42, v42, v42 row_mirror row_mask:0xf bank_mask:0x3
    v_add_f32_dpp v44, v44, v44 row_mirror row_mask:0xf bank_mask:0x3
    v_add_f32_dpp v46, v46, v46 row_mirror row_mask:0xf bank_mask:0x3
    v_add_f32_dpp v48, v48, v48 row_mirror row_mask:0xf bank_mask:0x3
    v_add_f32_dpp v50, v50, v50 row_mirror row_mask:0xf bank_mask:0x3
    v_add_f32_dpp v52, v52, v52 row_mirror row_mask:0xf bank_mask:0x3
    v_add_f32_dpp v38, v39, v39 row_mirror row_mask:0xf bank_mask:0xc
    v_add_f32_dpp v40, v41, v41 row_mirror row_mask:0xf bank_mask:0xc
    v_add_f32_dpp v42, v43, v43 row_mirror row_mask:0xf bank_mask:0xc
    v_add_f32_dpp v44, v45, v45 row_mirror row_mask:0xf bank_mask:0xc
    v_add_f32_dpp v46, v47, v47 row_mirror row_mask:0xf bank_mask:0xc
    v_add_f32_dpp v48, v49, v49 row_mirror row_mask:0xf bank_mask:0xc
    v_add_f32_dpp v50, v51, v51 row_mirror row_mask:0xf bank_mask:0xc
    v_add_f32_dpp v52, v53, v53 row_mirror row_mask:0xf bank_mask:0xc
    s_waitcnt vmcnt(7)
    s_xor_b32 s68, s69, 0x80a00
    buffer_load_dwordx4 v[96:99], v1, s[4:7], s68 offen nt
    v_add_f32_dpp v38, v38, v38 row_half_mirror row_mask:0xf bank_mask:0x5
    v_add_f32_dpp v42, v42, v42 row_half_mirror row_mask:0xf bank_mask:0x5
    v_add_f32_dpp v46, v46, v46 row_half_mirror row_mask:0xf bank_mask:0x5
    v_add_f32_dpp v50, v50, v50 row_half_mirror row_mask:0xf bank_mask:0x5
    v_add_f32_dpp v38, v40, v40 row_half_mirror row_mask:0xf bank_mask:0xa
    v_add_f32_dpp v42, v44, v44 row_half_mirror row_mask:0xf bank_mask:0xa
    v_add_f32_dpp v46, v48, v48 row_half_mirror row_mask:0xf bank_mask:0xa
    v_add_f32_dpp v50, v52, v52 row_half_mirror row_mask:0xf bank_mask:0xa
    v_add_f32_dpp v38, v38, v38 quad_perm:[1,0,3,2] row_mask:0xf bank_mask:0xf
    v_add_f32_dpp v42, v42, v42 quad_perm:[1,0,3,2] row_mask:0xf bank_mask:0xf
    v_add_f32_dpp v46, v46, v46 quad_perm:[1,0,3,2] row_mask:0xf bank_mask:0xf
    v_add_f32_dpp v50, v50, v50 quad_perm:[1,0,3,2] row_mask:0xf bank_mask:0xf
    v_add_f32_dpp v38, v38, v38 quad_perm:[2,3,0,1] row_mask:0xf bank_mask:0xf
    v_add_f32_dpp v42, v42, v42 quad_perm:[2,3,0,1] row_mask:0xf bank_mask:0xf
    v_add_f32_dpp v46, v46, v46 quad_perm:[2,3,0,1] row_mask:0xf bank_mask:0xf
    v_add_f32_dpp v50, v50, v50 quad_perm:[2,3,0,1] row_mask:0xf bank_mask:0xf
    s_mov_b32 vcc_lo, 0xaaaaaaaa
    s_mov_b32 vcc_hi, 0xaaaaaaaa
    v_cndmask_b32 v38, v38, v42, vcc
    v_cndmask_b32 v46, v46, v50, vcc
    s_mov_b32 vcc_lo, 0xcccccccc
    s_mov_b32 vcc_hi, 0xcccccccc
    v_cndmask_b32 v25, v38, v46, vcc
    v_dot2_f32_bf16 v38, v72, v14, 0
    v_dot2_f32_bf16 v38, v73, v15, v38
    v_dot2_f32_bf16 v38, v74, v16, v38
    v_dot2_f32_bf16 v38, v75, v17, v38
    s_waitcnt vmcnt(7)
    buffer_load_dwordx4 v[100:103], v1, s[4:7], s68 offen offset:256 nt
    s_mov_b32 s71, 372736
    buffer_load_dwordx4 v[188:191], v5, s[20:23], s71 offen
    v_dot2_f32_bf16 v38, v76, v18, v38
    v_dot2_f32_bf16 v38, v77, v19, v38
    v_dot2_f32_bf16 v38, v78, v20, v38
    v_dot2_f32_bf16 v38, v79, v21, v38
    s_waitcnt vmcnt(7)
    s_xor_b32 s68, s69, 0x88000
    buffer_load_dwordx4 v[104:107], v1, s[4:7], s68 offen nt
    v_dot2_f32_bf16 v39, v80, v14, 0
    v_dot2_f32_bf16 v39, v81, v15, v39
    v_dot2_f32_bf16 v39, v82, v16, v39
    v_dot2_f32_bf16 v39, v83, v17, v39
    s_waitcnt vmcnt(7)
    buffer_load_dwordx4 v[108:111], v1, s[4:7], s68 offen offset:256 nt
    v_dot2_f32_bf16 v39, v84, v18, v39
    v_dot2_f32_bf16 v39, v85, v19, v39
    v_dot2_f32_bf16 v39, v86, v20, v39
    v_dot2_f32_bf16 v39, v87, v21, v39
    s_waitcnt vmcnt(7)
    s_xor_b32 s68, s69, 0x88800
    buffer_load_dwordx4 v[112:115], v1, s[4:7], s68 offen nt
    s_movk_i32 s71, 0
    buffer_load_dwordx4 v[192:195], v4, s[24:27], s71 offen
    v_dot2_f32_bf16 v40, v88, v14, 0
    v_dot2_f32_bf16 v40, v89, v15, v40
    v_dot2_f32_bf16 v40, v90, v16, v40
    v_dot2_f32_bf16 v40, v91, v17, v40
    s_waitcnt vmcnt(7)
    buffer_load_dwordx4 v[116:119], v1, s[4:7], s68 offen offset:256 nt
    v_dot2_f32_bf16 v40, v92, v18, v40
    v_dot2_f32_bf16 v40, v93, v19, v40
    v_dot2_f32_bf16 v40, v94, v20, v40
    v_dot2_f32_bf16 v40, v95, v21, v40
    s_waitcnt vmcnt(7)
    s_xor_b32 s68, s69, 0x88200
    buffer_load_dwordx4 v[120:123], v1, s[4:7], s68 offen nt
    v_dot2_f32_bf16 v41, v96, v14, 0
    v_dot2_f32_bf16 v41, v97, v15, v41
    v_dot2_f32_bf16 v41, v98, v16, v41
    v_dot2_f32_bf16 v41, v99, v17, v41
    s_waitcnt vmcnt(7)
    buffer_load_dwordx4 v[124:127], v1, s[4:7], s68 offen offset:256 nt
    s_movk_i32 s71, 0
    buffer_load_dwordx4 v[200:203], v6, s[24:27], s71 offen
    v_dot2_f32_bf16 v41, v100, v18, v41
    v_dot2_f32_bf16 v41, v101, v19, v41
    v_dot2_f32_bf16 v41, v102, v20, v41
    v_dot2_f32_bf16 v41, v103, v21, v41
    s_waitcnt vmcnt(7)
    s_xor_b32 s68, s69, 0x88a00
    buffer_load_dwordx4 v[128:131], v1, s[4:7], s68 offen nt
    v_dot2_f32_bf16 v42, v104, v14, 0
    v_dot2_f32_bf16 v42, v105, v15, v42
    v_dot2_f32_bf16 v42, v106, v16, v42
    v_dot2_f32_bf16 v42, v107, v17, v42
    s_waitcnt vmcnt(7)
    buffer_load_dwordx4 v[132:135], v1, s[4:7], s68 offen offset:256 nt
    v_dot2_f32_bf16 v42, v108, v18, v42
    v_dot2_f32_bf16 v42, v109, v19, v42
    v_dot2_f32_bf16 v42, v110, v20, v42
    v_dot2_f32_bf16 v42, v111, v21, v42
    s_waitcnt vmcnt(7)
    s_xor_b32 s68, s69, 0xc0000
    buffer_load_dwordx4 v[72:75], v1, s[4:7], s68 offen nt
    s_movk_i32 s71, 7168
    buffer_load_dwordx4 v[196:199], v4, s[24:27], s71 offen
    v_dot2_f32_bf16 v43, v112, v14, 0
    v_dot2_f32_bf16 v43, v113, v15, v43
    v_dot2_f32_bf16 v43, v114, v16, v43
    v_dot2_f32_bf16 v43, v115, v17, v43
    s_waitcnt vmcnt(7)
    buffer_load_dwordx4 v[76:79], v1, s[4:7], s68 offen offset:256 nt
    v_dot2_f32_bf16 v43, v116, v18, v43
    v_dot2_f32_bf16 v43, v117, v19, v43
    v_dot2_f32_bf16 v43, v118, v20, v43
    v_dot2_f32_bf16 v43, v119, v21, v43
    s_waitcnt vmcnt(7)
    s_xor_b32 s68, s69, 0xc0800
    buffer_load_dwordx4 v[80:83], v1, s[4:7], s68 offen nt
    v_dot2_f32_bf16 v44, v120, v14, 0
    v_dot2_f32_bf16 v44, v121, v15, v44
    v_dot2_f32_bf16 v44, v122, v16, v44
    v_dot2_f32_bf16 v44, v123, v17, v44
    s_waitcnt vmcnt(7)
    buffer_load_dwordx4 v[84:87], v1, s[4:7], s68 offen offset:256 nt
    s_movk_i32 s71, 7168
    buffer_load_dwordx4 v[204:207], v6, s[24:27], s71 offen
    v_dot2_f32_bf16 v44, v124, v18, v44
    v_dot2_f32_bf16 v44, v125, v19, v44
    v_dot2_f32_bf16 v44, v126, v20, v44
    v_dot2_f32_bf16 v44, v127, v21, v44
    s_waitcnt vmcnt(7)
    s_xor_b32 s68, s69, 0xc0200
    buffer_load_dwordx4 v[88:91], v1, s[4:7], s68 offen nt
    v_dot2_f32_bf16 v45, v128, v14, 0
    v_dot2_f32_bf16 v45, v129, v15, v45
    v_dot2_f32_bf16 v45, v130, v16, v45
    v_dot2_f32_bf16 v45, v131, v17, v45
    s_waitcnt vmcnt(7)
    buffer_load_dwordx4 v[92:95], v1, s[4:7], s68 offen offset:256 nt
    v_dot2_f32_bf16 v45, v132, v18, v45
    v_dot2_f32_bf16 v45, v133, v19, v45
    v_dot2_f32_bf16 v45, v134, v20, v45
    v_dot2_f32_bf16 v45, v135, v21, v45
    s_waitcnt vmcnt(7)
    s_xor_b32 s68, s69, 0xc0a00
    buffer_load_dwordx4 v[96:99], v1, s[4:7], s68 offen nt
    s_movk_i32 s71, 14336
    buffer_load_dwordx4 v[208:211], v4, s[24:27], s71 offen
    v_dot2_f32_bf16 v46, v72, v14, 0
    v_dot2_f32_bf16 v46, v73, v15, v46
    v_dot2_f32_bf16 v46, v74, v16, v46
    v_dot2_f32_bf16 v46, v75, v17, v46
    s_waitcnt vmcnt(7)
    buffer_load_dwordx4 v[100:103], v1, s[4:7], s68 offen offset:256 nt
    v_dot2_f32_bf16 v46, v76, v18, v46
    v_dot2_f32_bf16 v46, v77, v19, v46
    v_dot2_f32_bf16 v46, v78, v20, v46
    v_dot2_f32_bf16 v46, v79, v21, v46
    s_waitcnt vmcnt(7)
    s_xor_b32 s68, s69, 0xc8000
    buffer_load_dwordx4 v[104:107], v1, s[4:7], s68 offen nt
    v_dot2_f32_bf16 v47, v80, v14, 0
    v_dot2_f32_bf16 v47, v81, v15, v47
    v_dot2_f32_bf16 v47, v82, v16, v47
    v_dot2_f32_bf16 v47, v83, v17, v47
    s_waitcnt vmcnt(7)
    buffer_load_dwordx4 v[108:111], v1, s[4:7], s68 offen offset:256 nt
    s_movk_i32 s71, 14336
    buffer_load_dwordx4 v[216:219], v6, s[24:27], s71 offen
    v_dot2_f32_bf16 v47, v84, v18, v47
    v_dot2_f32_bf16 v47, v85, v19, v47
    v_dot2_f32_bf16 v47, v86, v20, v47
    v_dot2_f32_bf16 v47, v87, v21, v47
    s_waitcnt vmcnt(7)
    s_xor_b32 s68, s69, 0xc8800
    buffer_load_dwordx4 v[112:115], v1, s[4:7], s68 offen nt
    v_dot2_f32_bf16 v48, v88, v14, 0
    v_dot2_f32_bf16 v48, v89, v15, v48
    v_dot2_f32_bf16 v48, v90, v16, v48
    v_dot2_f32_bf16 v48, v91, v17, v48
    s_waitcnt vmcnt(7)
    buffer_load_dwordx4 v[116:119], v1, s[4:7], s68 offen offset:256 nt
    v_dot2_f32_bf16 v48, v92, v18, v48
    v_dot2_f32_bf16 v48, v93, v19, v48
    v_dot2_f32_bf16 v48, v94, v20, v48
    v_dot2_f32_bf16 v48, v95, v21, v48
    s_waitcnt vmcnt(7)
    s_xor_b32 s68, s69, 0xc8200
    buffer_load_dwordx4 v[120:123], v1, s[4:7], s68 offen nt
    s_movk_i32 s71, 21504
    buffer_load_dwordx4 v[212:215], v4, s[24:27], s71 offen
    v_dot2_f32_bf16 v49, v96, v14, 0
    v_dot2_f32_bf16 v49, v97, v15, v49
    v_dot2_f32_bf16 v49, v98, v16, v49
    v_dot2_f32_bf16 v49, v99, v17, v49
    s_waitcnt vmcnt(7)
    buffer_load_dwordx4 v[124:127], v1, s[4:7], s68 offen offset:256 nt
    v_dot2_f32_bf16 v49, v100, v18, v49
    v_dot2_f32_bf16 v49, v101, v19, v49
    v_dot2_f32_bf16 v49, v102, v20, v49
    v_dot2_f32_bf16 v49, v103, v21, v49
    s_waitcnt vmcnt(7)
    s_xor_b32 s68, s69, 0xc8a00
    buffer_load_dwordx4 v[128:131], v1, s[4:7], s68 offen nt
    v_dot2_f32_bf16 v50, v104, v14, 0
    v_dot2_f32_bf16 v50, v105, v15, v50
    v_dot2_f32_bf16 v50, v106, v16, v50
    v_dot2_f32_bf16 v50, v107, v17, v50
    s_waitcnt vmcnt(7)
    buffer_load_dwordx4 v[132:135], v1, s[4:7], s68 offen offset:256 nt
    s_movk_i32 s71, 21504
    buffer_load_dwordx4 v[220:223], v6, s[24:27], s71 offen
    v_dot2_f32_bf16 v50, v108, v18, v50
    v_dot2_f32_bf16 v50, v109, v19, v50
    v_dot2_f32_bf16 v50, v110, v20, v50
    v_dot2_f32_bf16 v50, v111, v21, v50
    s_waitcnt vmcnt(7)
    s_xor_b32 s68, s69, 0x84000
    buffer_load_dwordx4 v[72:75], v1, s[4:7], s68 offen nt
    v_dot2_f32_bf16 v51, v112, v14, 0
    v_dot2_f32_bf16 v51, v113, v15, v51
    v_dot2_f32_bf16 v51, v114, v16, v51
    v_dot2_f32_bf16 v51, v115, v17, v51
    s_waitcnt vmcnt(7)
    buffer_load_dwordx4 v[76:79], v1, s[4:7], s68 offen offset:256 nt
    v_dot2_f32_bf16 v51, v116, v18, v51
    v_dot2_f32_bf16 v51, v117, v19, v51
    v_dot2_f32_bf16 v51, v118, v20, v51
    v_dot2_f32_bf16 v51, v119, v21, v51
    s_waitcnt vmcnt(7)
    s_xor_b32 s68, s69, 0x84800
    buffer_load_dwordx4 v[80:83], v1, s[4:7], s68 offen nt
    s_movk_i32 s71, 28672
    buffer_load_dwordx4 v[224:227], v4, s[24:27], s71 offen
    v_dot2_f32_bf16 v52, v120, v14, 0
    v_dot2_f32_bf16 v52, v121, v15, v52
    v_dot2_f32_bf16 v52, v122, v16, v52
    v_dot2_f32_bf16 v52, v123, v17, v52
    s_waitcnt vmcnt(7)
    buffer_load_dwordx4 v[84:87], v1, s[4:7], s68 offen offset:256 nt
    v_dot2_f32_bf16 v52, v124, v18, v52
    v_dot2_f32_bf16 v52, v125, v19, v52
    v_dot2_f32_bf16 v52, v126, v20, v52
    v_dot2_f32_bf16 v52, v127, v21, v52
    s_waitcnt vmcnt(7)
    s_xor_b32 s68, s69, 0x84200
    buffer_load_dwordx4 v[88:91], v1, s[4:7], s68 offen nt
    v_dot2_f32_bf16 v53, v128, v14, 0
    v_dot2_f32_bf16 v53, v129, v15, v53
    v_dot2_f32_bf16 v53, v130, v16, v53
    v_dot2_f32_bf16 v53, v131, v17, v53
    s_waitcnt vmcnt(7)
    buffer_load_dwordx4 v[92:95], v1, s[4:7], s68 offen offset:256 nt
    s_movk_i32 s71, 28672
    buffer_load_dwordx4 v[232:235], v6, s[24:27], s71 offen
    v_dot2_f32_bf16 v53, v132, v18, v53
    v_dot2_f32_bf16 v53, v133, v19, v53
    v_dot2_f32_bf16 v53, v134, v20, v53
    v_dot2_f32_bf16 v53, v135, v21, v53
    s_nop 2
    v_add_f32_dpp v38, v38, v38 row_mirror row_mask:0xf bank_mask:0x3
    v_add_f32_dpp v40, v40, v40 row_mirror row_mask:0xf bank_mask:0x3
    v_add_f32_dpp v42, v42, v42 row_mirror row_mask:0xf bank_mask:0x3
    v_add_f32_dpp v44, v44, v44 row_mirror row_mask:0xf bank_mask:0x3
    v_add_f32_dpp v46, v46, v46 row_mirror row_mask:0xf bank_mask:0x3
    v_add_f32_dpp v48, v48, v48 row_mirror row_mask:0xf bank_mask:0x3
    v_add_f32_dpp v50, v50, v50 row_mirror row_mask:0xf bank_mask:0x3
    v_add_f32_dpp v52, v52, v52 row_mirror row_mask:0xf bank_mask:0x3
    v_add_f32_dpp v38, v39, v39 row_mirror row_mask:0xf bank_mask:0xc
    v_add_f32_dpp v40, v41, v41 row_mirror row_mask:0xf bank_mask:0xc
    v_add_f32_dpp v42, v43, v43 row_mirror row_mask:0xf bank_mask:0xc
    v_add_f32_dpp v44, v45, v45 row_mirror row_mask:0xf bank_mask:0xc
    v_add_f32_dpp v46, v47, v47 row_mirror row_mask:0xf bank_mask:0xc
    v_add_f32_dpp v48, v49, v49 row_mirror row_mask:0xf bank_mask:0xc
    v_add_f32_dpp v50, v51, v51 row_mirror row_mask:0xf bank_mask:0xc
    v_add_f32_dpp v52, v53, v53 row_mirror row_mask:0xf bank_mask:0xc
    s_waitcnt vmcnt(7)
    s_xor_b32 s68, s69, 0x84a00
    buffer_load_dwordx4 v[96:99], v1, s[4:7], s68 offen nt
    v_add_f32_dpp v38, v38, v38 row_half_mirror row_mask:0xf bank_mask:0x5
    v_add_f32_dpp v42, v42, v42 row_half_mirror row_mask:0xf bank_mask:0x5
    v_add_f32_dpp v46, v46, v46 row_half_mirror row_mask:0xf bank_mask:0x5
    v_add_f32_dpp v50, v50, v50 row_half_mirror row_mask:0xf bank_mask:0x5
    v_add_f32_dpp v38, v40, v40 row_half_mirror row_mask:0xf bank_mask:0xa
    v_add_f32_dpp v42, v44, v44 row_half_mirror row_mask:0xf bank_mask:0xa
    v_add_f32_dpp v46, v48, v48 row_half_mirror row_mask:0xf bank_mask:0xa
    v_add_f32_dpp v50, v52, v52 row_half_mirror row_mask:0xf bank_mask:0xa
    v_add_f32_dpp v38, v38, v38 quad_perm:[1,0,3,2] row_mask:0xf bank_mask:0xf
    v_add_f32_dpp v42, v42, v42 quad_perm:[1,0,3,2] row_mask:0xf bank_mask:0xf
    v_add_f32_dpp v46, v46, v46 quad_perm:[1,0,3,2] row_mask:0xf bank_mask:0xf
    v_add_f32_dpp v50, v50, v50 quad_perm:[1,0,3,2] row_mask:0xf bank_mask:0xf
    v_add_f32_dpp v38, v38, v38 quad_perm:[2,3,0,1] row_mask:0xf bank_mask:0xf
    v_add_f32_dpp v42, v42, v42 quad_perm:[2,3,0,1] row_mask:0xf bank_mask:0xf
    v_add_f32_dpp v46, v46, v46 quad_perm:[2,3,0,1] row_mask:0xf bank_mask:0xf
    v_add_f32_dpp v50, v50, v50 quad_perm:[2,3,0,1] row_mask:0xf bank_mask:0xf
    s_mov_b32 vcc_lo, 0xaaaaaaaa
    s_mov_b32 vcc_hi, 0xaaaaaaaa
    v_cndmask_b32 v38, v38, v42, vcc
    v_cndmask_b32 v46, v46, v50, vcc
    s_mov_b32 vcc_lo, 0xcccccccc
    s_mov_b32 vcc_hi, 0xcccccccc
    v_cndmask_b32 v26, v38, v46, vcc
    v_dot2_f32_bf16 v38, v72, v14, 0
    v_dot2_f32_bf16 v38, v73, v15, v38
    v_dot2_f32_bf16 v38, v74, v16, v38
    v_dot2_f32_bf16 v38, v75, v17, v38
    s_waitcnt vmcnt(7)
    buffer_load_dwordx4 v[100:103], v1, s[4:7], s68 offen offset:256 nt
    v_dot2_f32_bf16 v38, v76, v18, v38
    v_dot2_f32_bf16 v38, v77, v19, v38
    v_dot2_f32_bf16 v38, v78, v20, v38
    v_dot2_f32_bf16 v38, v79, v21, v38
    s_waitcnt vmcnt(7)
    s_xor_b32 s68, s69, 0x8c000
    buffer_load_dwordx4 v[104:107], v1, s[4:7], s68 offen nt
    s_mov_b32 s71, 35840
    buffer_load_dwordx4 v[228:231], v4, s[24:27], s71 offen
    v_dot2_f32_bf16 v39, v80, v14, 0
    v_dot2_f32_bf16 v39, v81, v15, v39
    v_dot2_f32_bf16 v39, v82, v16, v39
    v_dot2_f32_bf16 v39, v83, v17, v39
    s_waitcnt vmcnt(7)
    buffer_load_dwordx4 v[108:111], v1, s[4:7], s68 offen offset:256 nt
    v_dot2_f32_bf16 v39, v84, v18, v39
    v_dot2_f32_bf16 v39, v85, v19, v39
    v_dot2_f32_bf16 v39, v86, v20, v39
    v_dot2_f32_bf16 v39, v87, v21, v39
    s_waitcnt vmcnt(7)
    s_xor_b32 s68, s69, 0x8c800
    buffer_load_dwordx4 v[112:115], v1, s[4:7], s68 offen nt
    v_dot2_f32_bf16 v40, v88, v14, 0
    v_dot2_f32_bf16 v40, v89, v15, v40
    v_dot2_f32_bf16 v40, v90, v16, v40
    v_dot2_f32_bf16 v40, v91, v17, v40
    s_waitcnt vmcnt(7)
    buffer_load_dwordx4 v[116:119], v1, s[4:7], s68 offen offset:256 nt
    s_mov_b32 s71, 35840
    buffer_load_dwordx4 v[236:239], v6, s[24:27], s71 offen
    v_dot2_f32_bf16 v40, v92, v18, v40
    v_dot2_f32_bf16 v40, v93, v19, v40
    v_dot2_f32_bf16 v40, v94, v20, v40
    v_dot2_f32_bf16 v40, v95, v21, v40
    s_waitcnt vmcnt(7)
    s_xor_b32 s68, s69, 0x8c200
    buffer_load_dwordx4 v[120:123], v1, s[4:7], s68 offen nt
    v_dot2_f32_bf16 v41, v96, v14, 0
    v_dot2_f32_bf16 v41, v97, v15, v41
    v_dot2_f32_bf16 v41, v98, v16, v41
    v_dot2_f32_bf16 v41, v99, v17, v41
    s_waitcnt vmcnt(7)
    buffer_load_dwordx4 v[124:127], v1, s[4:7], s68 offen offset:256 nt
    v_dot2_f32_bf16 v41, v100, v18, v41
    v_dot2_f32_bf16 v41, v101, v19, v41
    v_dot2_f32_bf16 v41, v102, v20, v41
    v_dot2_f32_bf16 v41, v103, v21, v41
    s_waitcnt vmcnt(7)
    s_xor_b32 s68, s69, 0x8ca00
    buffer_load_dwordx4 v[128:131], v1, s[4:7], s68 offen nt
    s_mov_b32 s71, 43008
    buffer_load_dwordx4 v[240:243], v4, s[24:27], s71 offen
    v_dot2_f32_bf16 v42, v104, v14, 0
    v_dot2_f32_bf16 v42, v105, v15, v42
    v_dot2_f32_bf16 v42, v106, v16, v42
    v_dot2_f32_bf16 v42, v107, v17, v42
    s_waitcnt vmcnt(7)
    buffer_load_dwordx4 v[132:135], v1, s[4:7], s68 offen offset:256 nt
    v_dot2_f32_bf16 v42, v108, v18, v42
    v_dot2_f32_bf16 v42, v109, v19, v42
    v_dot2_f32_bf16 v42, v110, v20, v42
    v_dot2_f32_bf16 v42, v111, v21, v42
    s_waitcnt vmcnt(7)
    s_xor_b32 s68, s69, 0xc4000
    buffer_load_dwordx4 v[72:75], v1, s[4:7], s68 offen nt
    v_dot2_f32_bf16 v43, v112, v14, 0
    v_dot2_f32_bf16 v43, v113, v15, v43
    v_dot2_f32_bf16 v43, v114, v16, v43
    v_dot2_f32_bf16 v43, v115, v17, v43
    s_waitcnt vmcnt(7)
    buffer_load_dwordx4 v[76:79], v1, s[4:7], s68 offen offset:256 nt
    s_mov_b32 s71, 43008
    buffer_load_dwordx4 v[248:251], v6, s[24:27], s71 offen
    v_dot2_f32_bf16 v43, v116, v18, v43
    v_dot2_f32_bf16 v43, v117, v19, v43
    v_dot2_f32_bf16 v43, v118, v20, v43
    v_dot2_f32_bf16 v43, v119, v21, v43
    s_waitcnt vmcnt(7)
    s_xor_b32 s68, s69, 0xc4800
    buffer_load_dwordx4 v[80:83], v1, s[4:7], s68 offen nt
    v_dot2_f32_bf16 v44, v120, v14, 0
    v_dot2_f32_bf16 v44, v121, v15, v44
    v_dot2_f32_bf16 v44, v122, v16, v44
    v_dot2_f32_bf16 v44, v123, v17, v44
    s_waitcnt vmcnt(7)
    buffer_load_dwordx4 v[84:87], v1, s[4:7], s68 offen offset:256 nt
    v_dot2_f32_bf16 v44, v124, v18, v44
    v_dot2_f32_bf16 v44, v125, v19, v44
    v_dot2_f32_bf16 v44, v126, v20, v44
    v_dot2_f32_bf16 v44, v127, v21, v44
    s_waitcnt vmcnt(7)
    s_xor_b32 s68, s69, 0xc4200
    buffer_load_dwordx4 v[88:91], v1, s[4:7], s68 offen nt
    s_mov_b32 s71, 50176
    buffer_load_dwordx4 v[244:247], v4, s[24:27], s71 offen
    v_dot2_f32_bf16 v45, v128, v14, 0
    v_dot2_f32_bf16 v45, v129, v15, v45
    v_dot2_f32_bf16 v45, v130, v16, v45
    v_dot2_f32_bf16 v45, v131, v17, v45
    s_waitcnt vmcnt(7)
    buffer_load_dwordx4 v[92:95], v1, s[4:7], s68 offen offset:256 nt
    v_dot2_f32_bf16 v45, v132, v18, v45
    v_dot2_f32_bf16 v45, v133, v19, v45
    v_dot2_f32_bf16 v45, v134, v20, v45
    v_dot2_f32_bf16 v45, v135, v21, v45
    s_waitcnt vmcnt(7)
    s_xor_b32 s68, s69, 0xc4a00
    buffer_load_dwordx4 v[96:99], v1, s[4:7], s68 offen nt
    v_dot2_f32_bf16 v46, v72, v14, 0
    v_dot2_f32_bf16 v46, v73, v15, v46
    v_dot2_f32_bf16 v46, v74, v16, v46
    v_dot2_f32_bf16 v46, v75, v17, v46
    s_waitcnt vmcnt(7)
    buffer_load_dwordx4 v[100:103], v1, s[4:7], s68 offen offset:256 nt
    s_mov_b32 s71, 50176
    buffer_load_dwordx4 v[252:255], v6, s[24:27], s71 offen
    v_dot2_f32_bf16 v46, v76, v18, v46
    v_dot2_f32_bf16 v46, v77, v19, v46
    v_dot2_f32_bf16 v46, v78, v20, v46
    v_dot2_f32_bf16 v46, v79, v21, v46
    s_waitcnt vmcnt(7)
    s_xor_b32 s68, s69, 0xcc000
    buffer_load_dwordx4 v[104:107], v1, s[4:7], s68 offen nt
    v_dot2_f32_bf16 v47, v80, v14, 0
    v_dot2_f32_bf16 v47, v81, v15, v47
    v_dot2_f32_bf16 v47, v82, v16, v47
    v_dot2_f32_bf16 v47, v83, v17, v47
    s_waitcnt vmcnt(7)
    buffer_load_dwordx4 v[108:111], v1, s[4:7], s68 offen offset:256 nt
    v_dot2_f32_bf16 v47, v84, v18, v47
    v_dot2_f32_bf16 v47, v85, v19, v47
    v_dot2_f32_bf16 v47, v86, v20, v47
    v_dot2_f32_bf16 v47, v87, v21, v47
    s_waitcnt vmcnt(7)
    s_xor_b32 s68, s69, 0xcc800
    buffer_load_dwordx4 v[112:115], v1, s[4:7], s68 offen nt
    s_movk_i32 s71, 0
    buffer_load_dwordx4 a[0:3], v4, s[16:19], s71 offen
    v_dot2_f32_bf16 v48, v88, v14, 0
    v_dot2_f32_bf16 v48, v89, v15, v48
    v_dot2_f32_bf16 v48, v90, v16, v48
    v_dot2_f32_bf16 v48, v91, v17, v48
    s_waitcnt vmcnt(7)
    buffer_load_dwordx4 v[116:119], v1, s[4:7], s68 offen offset:256 nt
    v_dot2_f32_bf16 v48, v92, v18, v48
    v_dot2_f32_bf16 v48, v93, v19, v48
    v_dot2_f32_bf16 v48, v94, v20, v48
    v_dot2_f32_bf16 v48, v95, v21, v48
    s_waitcnt vmcnt(7)
    s_xor_b32 s68, s69, 0xcc200
    buffer_load_dwordx4 v[120:123], v1, s[4:7], s68 offen nt
    v_dot2_f32_bf16 v49, v96, v14, 0
    v_dot2_f32_bf16 v49, v97, v15, v49
    v_dot2_f32_bf16 v49, v98, v16, v49
    v_dot2_f32_bf16 v49, v99, v17, v49
    s_waitcnt vmcnt(7)
    buffer_load_dwordx4 v[124:127], v1, s[4:7], s68 offen offset:256 nt
    s_movk_i32 s71, 0
    buffer_load_dwordx4 a[8:11], v6, s[16:19], s71 offen
    v_dot2_f32_bf16 v49, v100, v18, v49
    v_dot2_f32_bf16 v49, v101, v19, v49
    v_dot2_f32_bf16 v49, v102, v20, v49
    v_dot2_f32_bf16 v49, v103, v21, v49
    s_waitcnt vmcnt(7)
    s_xor_b32 s68, s69, 0xcca00
    buffer_load_dwordx4 v[128:131], v1, s[4:7], s68 offen nt
    v_dot2_f32_bf16 v50, v104, v14, 0
    v_dot2_f32_bf16 v50, v105, v15, v50
    v_dot2_f32_bf16 v50, v106, v16, v50
    v_dot2_f32_bf16 v50, v107, v17, v50
    s_waitcnt vmcnt(7)
    buffer_load_dwordx4 v[132:135], v1, s[4:7], s68 offen offset:256 nt
    v_dot2_f32_bf16 v50, v108, v18, v50
    v_dot2_f32_bf16 v50, v109, v19, v50
    v_dot2_f32_bf16 v50, v110, v20, v50
    v_dot2_f32_bf16 v50, v111, v21, v50
    s_waitcnt vmcnt(7)
    s_xor_b32 s68, s69, 0xa0000
    buffer_load_dwordx4 v[72:75], v1, s[4:7], s68 offen nt
    s_movk_i32 s71, 7168
    buffer_load_dwordx4 a[4:7], v4, s[16:19], s71 offen
    v_dot2_f32_bf16 v51, v112, v14, 0
    v_dot2_f32_bf16 v51, v113, v15, v51
    v_dot2_f32_bf16 v51, v114, v16, v51
    v_dot2_f32_bf16 v51, v115, v17, v51
    s_waitcnt vmcnt(7)
    buffer_load_dwordx4 v[76:79], v1, s[4:7], s68 offen offset:256 nt
    v_dot2_f32_bf16 v51, v116, v18, v51
    v_dot2_f32_bf16 v51, v117, v19, v51
    v_dot2_f32_bf16 v51, v118, v20, v51
    v_dot2_f32_bf16 v51, v119, v21, v51
    s_waitcnt vmcnt(7)
    s_xor_b32 s68, s69, 0xa0800
    buffer_load_dwordx4 v[80:83], v1, s[4:7], s68 offen nt
    v_dot2_f32_bf16 v52, v120, v14, 0
    v_dot2_f32_bf16 v52, v121, v15, v52
    v_dot2_f32_bf16 v52, v122, v16, v52
    v_dot2_f32_bf16 v52, v123, v17, v52
    s_waitcnt vmcnt(7)
    buffer_load_dwordx4 v[84:87], v1, s[4:7], s68 offen offset:256 nt
    s_movk_i32 s71, 7168
    buffer_load_dwordx4 a[12:15], v6, s[16:19], s71 offen
    v_dot2_f32_bf16 v52, v124, v18, v52
    v_dot2_f32_bf16 v52, v125, v19, v52
    v_dot2_f32_bf16 v52, v126, v20, v52
    v_dot2_f32_bf16 v52, v127, v21, v52
    s_waitcnt vmcnt(7)
    s_xor_b32 s68, s69, 0xa0200
    buffer_load_dwordx4 v[88:91], v1, s[4:7], s68 offen nt
    v_dot2_f32_bf16 v53, v128, v14, 0
    v_dot2_f32_bf16 v53, v129, v15, v53
    v_dot2_f32_bf16 v53, v130, v16, v53
    v_dot2_f32_bf16 v53, v131, v17, v53
    s_waitcnt vmcnt(7)
    buffer_load_dwordx4 v[92:95], v1, s[4:7], s68 offen offset:256 nt
    v_dot2_f32_bf16 v53, v132, v18, v53
    v_dot2_f32_bf16 v53, v133, v19, v53
    v_dot2_f32_bf16 v53, v134, v20, v53
    v_dot2_f32_bf16 v53, v135, v21, v53
    s_nop 2
    v_add_f32_dpp v38, v38, v38 row_mirror row_mask:0xf bank_mask:0x3
    v_add_f32_dpp v40, v40, v40 row_mirror row_mask:0xf bank_mask:0x3
    v_add_f32_dpp v42, v42, v42 row_mirror row_mask:0xf bank_mask:0x3
    v_add_f32_dpp v44, v44, v44 row_mirror row_mask:0xf bank_mask:0x3
    v_add_f32_dpp v46, v46, v46 row_mirror row_mask:0xf bank_mask:0x3
    v_add_f32_dpp v48, v48, v48 row_mirror row_mask:0xf bank_mask:0x3
    v_add_f32_dpp v50, v50, v50 row_mirror row_mask:0xf bank_mask:0x3
    v_add_f32_dpp v52, v52, v52 row_mirror row_mask:0xf bank_mask:0x3
    v_add_f32_dpp v38, v39, v39 row_mirror row_mask:0xf bank_mask:0xc
    v_add_f32_dpp v40, v41, v41 row_mirror row_mask:0xf bank_mask:0xc
    v_add_f32_dpp v42, v43, v43 row_mirror row_mask:0xf bank_mask:0xc
    v_add_f32_dpp v44, v45, v45 row_mirror row_mask:0xf bank_mask:0xc
    v_add_f32_dpp v46, v47, v47 row_mirror row_mask:0xf bank_mask:0xc
    v_add_f32_dpp v48, v49, v49 row_mirror row_mask:0xf bank_mask:0xc
    v_add_f32_dpp v50, v51, v51 row_mirror row_mask:0xf bank_mask:0xc
    v_add_f32_dpp v52, v53, v53 row_mirror row_mask:0xf bank_mask:0xc
    s_waitcnt vmcnt(7)
    s_xor_b32 s68, s69, 0xa0a00
    buffer_load_dwordx4 v[96:99], v1, s[4:7], s68 offen nt
    s_movk_i32 s71, 14336
    buffer_load_dwordx4 a[16:19], v4, s[16:19], s71 offen
    v_add_f32_dpp v38, v38, v38 row_half_mirror row_mask:0xf bank_mask:0x5
    v_add_f32_dpp v42, v42, v42 row_half_mirror row_mask:0xf bank_mask:0x5
    v_add_f32_dpp v46, v46, v46 row_half_mirror row_mask:0xf bank_mask:0x5
    v_add_f32_dpp v50, v50, v50 row_half_mirror row_mask:0xf bank_mask:0x5
    v_add_f32_dpp v38, v40, v40 row_half_mirror row_mask:0xf bank_mask:0xa
    v_add_f32_dpp v42, v44, v44 row_half_mirror row_mask:0xf bank_mask:0xa
    v_add_f32_dpp v46, v48, v48 row_half_mirror row_mask:0xf bank_mask:0xa
    v_add_f32_dpp v50, v52, v52 row_half_mirror row_mask:0xf bank_mask:0xa
    v_add_f32_dpp v38, v38, v38 quad_perm:[1,0,3,2] row_mask:0xf bank_mask:0xf
    v_add_f32_dpp v42, v42, v42 quad_perm:[1,0,3,2] row_mask:0xf bank_mask:0xf
    v_add_f32_dpp v46, v46, v46 quad_perm:[1,0,3,2] row_mask:0xf bank_mask:0xf
    v_add_f32_dpp v50, v50, v50 quad_perm:[1,0,3,2] row_mask:0xf bank_mask:0xf
    v_add_f32_dpp v38, v38, v38 quad_perm:[2,3,0,1] row_mask:0xf bank_mask:0xf
    v_add_f32_dpp v42, v42, v42 quad_perm:[2,3,0,1] row_mask:0xf bank_mask:0xf
    v_add_f32_dpp v46, v46, v46 quad_perm:[2,3,0,1] row_mask:0xf bank_mask:0xf
    v_add_f32_dpp v50, v50, v50 quad_perm:[2,3,0,1] row_mask:0xf bank_mask:0xf
    s_mov_b32 vcc_lo, 0xaaaaaaaa
    s_mov_b32 vcc_hi, 0xaaaaaaaa
    v_cndmask_b32 v38, v38, v42, vcc
    v_cndmask_b32 v46, v46, v50, vcc
    s_mov_b32 vcc_lo, 0xcccccccc
    s_mov_b32 vcc_hi, 0xcccccccc
    v_cndmask_b32 v27, v38, v46, vcc
    v_dot2_f32_bf16 v38, v72, v14, 0
    v_dot2_f32_bf16 v38, v73, v15, v38
    v_dot2_f32_bf16 v38, v74, v16, v38
    v_dot2_f32_bf16 v38, v75, v17, v38
    s_waitcnt vmcnt(7)
    buffer_load_dwordx4 v[100:103], v1, s[4:7], s68 offen offset:256 nt
    v_dot2_f32_bf16 v38, v76, v18, v38
    v_dot2_f32_bf16 v38, v77, v19, v38
    v_dot2_f32_bf16 v38, v78, v20, v38
    v_dot2_f32_bf16 v38, v79, v21, v38
    s_waitcnt vmcnt(7)
    s_xor_b32 s68, s69, 0xa8000
    buffer_load_dwordx4 v[104:107], v1, s[4:7], s68 offen nt
    v_dot2_f32_bf16 v39, v80, v14, 0
    v_dot2_f32_bf16 v39, v81, v15, v39
    v_dot2_f32_bf16 v39, v82, v16, v39
    v_dot2_f32_bf16 v39, v83, v17, v39
    s_waitcnt vmcnt(7)
    buffer_load_dwordx4 v[108:111], v1, s[4:7], s68 offen offset:256 nt
    s_movk_i32 s71, 14336
    buffer_load_dwordx4 a[24:27], v6, s[16:19], s71 offen
    v_dot2_f32_bf16 v39, v84, v18, v39
    v_dot2_f32_bf16 v39, v85, v19, v39
    v_dot2_f32_bf16 v39, v86, v20, v39
    v_dot2_f32_bf16 v39, v87, v21, v39
    s_waitcnt vmcnt(7)
    s_xor_b32 s68, s69, 0xa8800
    buffer_load_dwordx4 v[112:115], v1, s[4:7], s68 offen nt
    v_dot2_f32_bf16 v40, v88, v14, 0
    v_dot2_f32_bf16 v40, v89, v15, v40
    v_dot2_f32_bf16 v40, v90, v16, v40
    v_dot2_f32_bf16 v40, v91, v17, v40
    s_waitcnt vmcnt(7)
    buffer_load_dwordx4 v[116:119], v1, s[4:7], s68 offen offset:256 nt
    v_dot2_f32_bf16 v40, v92, v18, v40
    v_dot2_f32_bf16 v40, v93, v19, v40
    v_dot2_f32_bf16 v40, v94, v20, v40
    v_dot2_f32_bf16 v40, v95, v21, v40
    s_waitcnt vmcnt(7)
    s_xor_b32 s68, s69, 0xa8200
    buffer_load_dwordx4 v[120:123], v1, s[4:7], s68 offen nt
    s_movk_i32 s71, 21504
    buffer_load_dwordx4 a[20:23], v4, s[16:19], s71 offen
    v_dot2_f32_bf16 v41, v96, v14, 0
    v_dot2_f32_bf16 v41, v97, v15, v41
    v_dot2_f32_bf16 v41, v98, v16, v41
    v_dot2_f32_bf16 v41, v99, v17, v41
    s_waitcnt vmcnt(7)
    buffer_load_dwordx4 v[124:127], v1, s[4:7], s68 offen offset:256 nt
    v_dot2_f32_bf16 v41, v100, v18, v41
    v_dot2_f32_bf16 v41, v101, v19, v41
    v_dot2_f32_bf16 v41, v102, v20, v41
    v_dot2_f32_bf16 v41, v103, v21, v41
    s_waitcnt vmcnt(7)
    s_xor_b32 s68, s69, 0xa8a00
    buffer_load_dwordx4 v[128:131], v1, s[4:7], s68 offen nt
    v_dot2_f32_bf16 v42, v104, v14, 0
    v_dot2_f32_bf16 v42, v105, v15, v42
    v_dot2_f32_bf16 v42, v106, v16, v42
    v_dot2_f32_bf16 v42, v107, v17, v42
    s_waitcnt vmcnt(7)
    buffer_load_dwordx4 v[132:135], v1, s[4:7], s68 offen offset:256 nt
    s_movk_i32 s71, 21504
    buffer_load_dwordx4 a[28:31], v6, s[16:19], s71 offen
    v_dot2_f32_bf16 v42, v108, v18, v42
    v_dot2_f32_bf16 v42, v109, v19, v42
    v_dot2_f32_bf16 v42, v110, v20, v42
    v_dot2_f32_bf16 v42, v111, v21, v42
    s_waitcnt vmcnt(7)
    s_xor_b32 s68, s69, 0xe0000
    buffer_load_dwordx4 v[72:75], v1, s[4:7], s68 offen nt
    v_dot2_f32_bf16 v43, v112, v14, 0
    v_dot2_f32_bf16 v43, v113, v15, v43
    v_dot2_f32_bf16 v43, v114, v16, v43
    v_dot2_f32_bf16 v43, v115, v17, v43
    s_waitcnt vmcnt(7)
    buffer_load_dwordx4 v[76:79], v1, s[4:7], s68 offen offset:256 nt
    v_dot2_f32_bf16 v43, v116, v18, v43
    v_dot2_f32_bf16 v43, v117, v19, v43
    v_dot2_f32_bf16 v43, v118, v20, v43
    v_dot2_f32_bf16 v43, v119, v21, v43
    s_waitcnt vmcnt(7)
    s_xor_b32 s68, s69, 0xe0800
    buffer_load_dwordx4 v[80:83], v1, s[4:7], s68 offen nt
    s_movk_i32 s71, 28672
    buffer_load_dwordx4 a[32:35], v4, s[16:19], s71 offen
    v_dot2_f32_bf16 v44, v120, v14, 0
    v_dot2_f32_bf16 v44, v121, v15, v44
    v_dot2_f32_bf16 v44, v122, v16, v44
    v_dot2_f32_bf16 v44, v123, v17, v44
    s_waitcnt vmcnt(7)
    buffer_load_dwordx4 v[84:87], v1, s[4:7], s68 offen offset:256 nt
    v_dot2_f32_bf16 v44, v124, v18, v44
    v_dot2_f32_bf16 v44, v125, v19, v44
    v_dot2_f32_bf16 v44, v126, v20, v44
    v_dot2_f32_bf16 v44, v127, v21, v44
    s_waitcnt vmcnt(7)
    s_xor_b32 s68, s69, 0xe0200
    buffer_load_dwordx4 v[88:91], v1, s[4:7], s68 offen nt
    v_dot2_f32_bf16 v45, v128, v14, 0
    v_dot2_f32_bf16 v45, v129, v15, v45
    v_dot2_f32_bf16 v45, v130, v16, v45
    v_dot2_f32_bf16 v45, v131, v17, v45
    s_waitcnt vmcnt(7)
    buffer_load_dwordx4 v[92:95], v1, s[4:7], s68 offen offset:256 nt
    s_movk_i32 s71, 28672
    buffer_load_dwordx4 a[40:43], v6, s[16:19], s71 offen
    v_dot2_f32_bf16 v45, v132, v18, v45
    v_dot2_f32_bf16 v45, v133, v19, v45
    v_dot2_f32_bf16 v45, v134, v20, v45
    v_dot2_f32_bf16 v45, v135, v21, v45
    s_waitcnt vmcnt(7)
    s_xor_b32 s68, s69, 0xe0a00
    buffer_load_dwordx4 v[96:99], v1, s[4:7], s68 offen nt
    v_dot2_f32_bf16 v46, v72, v14, 0
    v_dot2_f32_bf16 v46, v73, v15, v46
    v_dot2_f32_bf16 v46, v74, v16, v46
    v_dot2_f32_bf16 v46, v75, v17, v46
    s_waitcnt vmcnt(7)
    buffer_load_dwordx4 v[100:103], v1, s[4:7], s68 offen offset:256 nt
    v_dot2_f32_bf16 v46, v76, v18, v46
    v_dot2_f32_bf16 v46, v77, v19, v46
    v_dot2_f32_bf16 v46, v78, v20, v46
    v_dot2_f32_bf16 v46, v79, v21, v46
    s_waitcnt vmcnt(7)
    s_xor_b32 s68, s69, 0xe8000
    buffer_load_dwordx4 v[104:107], v1, s[4:7], s68 offen nt
    s_mov_b32 s71, 35840
    buffer_load_dwordx4 a[36:39], v4, s[16:19], s71 offen
    v_dot2_f32_bf16 v47, v80, v14, 0
    v_dot2_f32_bf16 v47, v81, v15, v47
    v_dot2_f32_bf16 v47, v82, v16, v47
    v_dot2_f32_bf16 v47, v83, v17, v47
    s_waitcnt vmcnt(7)
    buffer_load_dwordx4 v[108:111], v1, s[4:7], s68 offen offset:256 nt
    v_dot2_f32_bf16 v47, v84, v18, v47
    v_dot2_f32_bf16 v47, v85, v19, v47
    v_dot2_f32_bf16 v47, v86, v20, v47
    v_dot2_f32_bf16 v47, v87, v21, v47
    s_waitcnt vmcnt(7)
    s_xor_b32 s68, s69, 0xe8800
    buffer_load_dwordx4 v[112:115], v1, s[4:7], s68 offen nt
    v_dot2_f32_bf16 v48, v88, v14, 0
    v_dot2_f32_bf16 v48, v89, v15, v48
    v_dot2_f32_bf16 v48, v90, v16, v48
    v_dot2_f32_bf16 v48, v91, v17, v48
    s_waitcnt vmcnt(7)
    buffer_load_dwordx4 v[116:119], v1, s[4:7], s68 offen offset:256 nt
    s_mov_b32 s71, 35840
    buffer_load_dwordx4 a[44:47], v6, s[16:19], s71 offen
    v_dot2_f32_bf16 v48, v92, v18, v48
    v_dot2_f32_bf16 v48, v93, v19, v48
    v_dot2_f32_bf16 v48, v94, v20, v48
    v_dot2_f32_bf16 v48, v95, v21, v48
    s_waitcnt vmcnt(7)
    s_xor_b32 s68, s69, 0xe8200
    buffer_load_dwordx4 v[120:123], v1, s[4:7], s68 offen nt
    v_dot2_f32_bf16 v49, v96, v14, 0
    v_dot2_f32_bf16 v49, v97, v15, v49
    v_dot2_f32_bf16 v49, v98, v16, v49
    v_dot2_f32_bf16 v49, v99, v17, v49
    s_waitcnt vmcnt(7)
    buffer_load_dwordx4 v[124:127], v1, s[4:7], s68 offen offset:256 nt
    v_dot2_f32_bf16 v49, v100, v18, v49
    v_dot2_f32_bf16 v49, v101, v19, v49
    v_dot2_f32_bf16 v49, v102, v20, v49
    v_dot2_f32_bf16 v49, v103, v21, v49
    s_waitcnt vmcnt(7)
    s_xor_b32 s68, s69, 0xe8a00
    buffer_load_dwordx4 v[128:131], v1, s[4:7], s68 offen nt
    s_mov_b32 s71, 43008
    buffer_load_dwordx4 a[48:51], v4, s[16:19], s71 offen
    v_dot2_f32_bf16 v50, v104, v14, 0
    v_dot2_f32_bf16 v50, v105, v15, v50
    v_dot2_f32_bf16 v50, v106, v16, v50
    v_dot2_f32_bf16 v50, v107, v17, v50
    s_waitcnt vmcnt(7)
    buffer_load_dwordx4 v[132:135], v1, s[4:7], s68 offen offset:256 nt
    v_dot2_f32_bf16 v50, v108, v18, v50
    v_dot2_f32_bf16 v50, v109, v19, v50
    v_dot2_f32_bf16 v50, v110, v20, v50
    v_dot2_f32_bf16 v50, v111, v21, v50
    s_waitcnt vmcnt(7)
    s_xor_b32 s68, s69, 0xa4000
    buffer_load_dwordx4 v[72:75], v1, s[4:7], s68 offen nt
    v_dot2_f32_bf16 v51, v112, v14, 0
    v_dot2_f32_bf16 v51, v113, v15, v51
    v_dot2_f32_bf16 v51, v114, v16, v51
    v_dot2_f32_bf16 v51, v115, v17, v51
    s_waitcnt vmcnt(7)
    buffer_load_dwordx4 v[76:79], v1, s[4:7], s68 offen offset:256 nt
    s_mov_b32 s71, 43008
    buffer_load_dwordx4 a[56:59], v6, s[16:19], s71 offen
    v_dot2_f32_bf16 v51, v116, v18, v51
    v_dot2_f32_bf16 v51, v117, v19, v51
    v_dot2_f32_bf16 v51, v118, v20, v51
    v_dot2_f32_bf16 v51, v119, v21, v51
    s_waitcnt vmcnt(7)
    s_xor_b32 s68, s69, 0xa4800
    buffer_load_dwordx4 v[80:83], v1, s[4:7], s68 offen nt
    v_dot2_f32_bf16 v52, v120, v14, 0
    v_dot2_f32_bf16 v52, v121, v15, v52
    v_dot2_f32_bf16 v52, v122, v16, v52
    v_dot2_f32_bf16 v52, v123, v17, v52
    s_waitcnt vmcnt(7)
    buffer_load_dwordx4 v[84:87], v1, s[4:7], s68 offen offset:256 nt
    v_dot2_f32_bf16 v52, v124, v18, v52
    v_dot2_f32_bf16 v52, v125, v19, v52
    v_dot2_f32_bf16 v52, v126, v20, v52
    v_dot2_f32_bf16 v52, v127, v21, v52
    s_waitcnt vmcnt(7)
    s_xor_b32 s68, s69, 0xa4200
    buffer_load_dwordx4 v[88:91], v1, s[4:7], s68 offen nt
    s_mov_b32 s71, 50176
    buffer_load_dwordx4 a[52:55], v4, s[16:19], s71 offen
    v_dot2_f32_bf16 v53, v128, v14, 0
    v_dot2_f32_bf16 v53, v129, v15, v53
    v_dot2_f32_bf16 v53, v130, v16, v53
    v_dot2_f32_bf16 v53, v131, v17, v53
    s_waitcnt vmcnt(7)
    buffer_load_dwordx4 v[92:95], v1, s[4:7], s68 offen offset:256 nt
    v_dot2_f32_bf16 v53, v132, v18, v53
    v_dot2_f32_bf16 v53, v133, v19, v53
    v_dot2_f32_bf16 v53, v134, v20, v53
    v_dot2_f32_bf16 v53, v135, v21, v53
    s_nop 2
    v_add_f32_dpp v38, v38, v38 row_mirror row_mask:0xf bank_mask:0x3
    v_add_f32_dpp v40, v40, v40 row_mirror row_mask:0xf bank_mask:0x3
    v_add_f32_dpp v42, v42, v42 row_mirror row_mask:0xf bank_mask:0x3
    v_add_f32_dpp v44, v44, v44 row_mirror row_mask:0xf bank_mask:0x3
    v_add_f32_dpp v46, v46, v46 row_mirror row_mask:0xf bank_mask:0x3
    v_add_f32_dpp v48, v48, v48 row_mirror row_mask:0xf bank_mask:0x3
    v_add_f32_dpp v50, v50, v50 row_mirror row_mask:0xf bank_mask:0x3
    v_add_f32_dpp v52, v52, v52 row_mirror row_mask:0xf bank_mask:0x3
    v_add_f32_dpp v38, v39, v39 row_mirror row_mask:0xf bank_mask:0xc
    v_add_f32_dpp v40, v41, v41 row_mirror row_mask:0xf bank_mask:0xc
    v_add_f32_dpp v42, v43, v43 row_mirror row_mask:0xf bank_mask:0xc
    v_add_f32_dpp v44, v45, v45 row_mirror row_mask:0xf bank_mask:0xc
    v_add_f32_dpp v46, v47, v47 row_mirror row_mask:0xf bank_mask:0xc
    v_add_f32_dpp v48, v49, v49 row_mirror row_mask:0xf bank_mask:0xc
    v_add_f32_dpp v50, v51, v51 row_mirror row_mask:0xf bank_mask:0xc
    v_add_f32_dpp v52, v53, v53 row_mirror row_mask:0xf bank_mask:0xc
    s_waitcnt vmcnt(7)
    s_xor_b32 s68, s69, 0xa4a00
    buffer_load_dwordx4 v[96:99], v1, s[4:7], s68 offen nt
    v_add_f32_dpp v38, v38, v38 row_half_mirror row_mask:0xf bank_mask:0x5
    v_add_f32_dpp v42, v42, v42 row_half_mirror row_mask:0xf bank_mask:0x5
    v_add_f32_dpp v46, v46, v46 row_half_mirror row_mask:0xf bank_mask:0x5
    v_add_f32_dpp v50, v50, v50 row_half_mirror row_mask:0xf bank_mask:0x5
    v_add_f32_dpp v38, v40, v40 row_half_mirror row_mask:0xf bank_mask:0xa
    v_add_f32_dpp v42, v44, v44 row_half_mirror row_mask:0xf bank_mask:0xa
    v_add_f32_dpp v46, v48, v48 row_half_mirror row_mask:0xf bank_mask:0xa
    v_add_f32_dpp v50, v52, v52 row_half_mirror row_mask:0xf bank_mask:0xa
    v_add_f32_dpp v38, v38, v38 quad_perm:[1,0,3,2] row_mask:0xf bank_mask:0xf
    v_add_f32_dpp v42, v42, v42 quad_perm:[1,0,3,2] row_mask:0xf bank_mask:0xf
    v_add_f32_dpp v46, v46, v46 quad_perm:[1,0,3,2] row_mask:0xf bank_mask:0xf
    v_add_f32_dpp v50, v50, v50 quad_perm:[1,0,3,2] row_mask:0xf bank_mask:0xf
    v_add_f32_dpp v38, v38, v38 quad_perm:[2,3,0,1] row_mask:0xf bank_mask:0xf
    v_add_f32_dpp v42, v42, v42 quad_perm:[2,3,0,1] row_mask:0xf bank_mask:0xf
    v_add_f32_dpp v46, v46, v46 quad_perm:[2,3,0,1] row_mask:0xf bank_mask:0xf
    v_add_f32_dpp v50, v50, v50 quad_perm:[2,3,0,1] row_mask:0xf bank_mask:0xf
    s_mov_b32 vcc_lo, 0xaaaaaaaa
    s_mov_b32 vcc_hi, 0xaaaaaaaa
    v_cndmask_b32 v38, v38, v42, vcc
    v_cndmask_b32 v46, v46, v50, vcc
    s_mov_b32 vcc_lo, 0xcccccccc
    s_mov_b32 vcc_hi, 0xcccccccc
    v_cndmask_b32 v28, v38, v46, vcc
    v_dot2_f32_bf16 v38, v72, v14, 0
    v_dot2_f32_bf16 v38, v73, v15, v38
    v_dot2_f32_bf16 v38, v74, v16, v38
    v_dot2_f32_bf16 v38, v75, v17, v38
    s_waitcnt vmcnt(7)
    buffer_load_dwordx4 v[100:103], v1, s[4:7], s68 offen offset:256 nt
    s_mov_b32 s71, 50176
    buffer_load_dwordx4 a[60:63], v6, s[16:19], s71 offen
    v_dot2_f32_bf16 v38, v76, v18, v38
    v_dot2_f32_bf16 v38, v77, v19, v38
    v_dot2_f32_bf16 v38, v78, v20, v38
    v_dot2_f32_bf16 v38, v79, v21, v38
    s_waitcnt vmcnt(7)
    s_xor_b32 s68, s69, 0xac000
    buffer_load_dwordx4 v[104:107], v1, s[4:7], s68 offen nt
    v_dot2_f32_bf16 v39, v80, v14, 0
    v_dot2_f32_bf16 v39, v81, v15, v39
    v_dot2_f32_bf16 v39, v82, v16, v39
    v_dot2_f32_bf16 v39, v83, v17, v39
    s_waitcnt vmcnt(7)
    buffer_load_dwordx4 v[108:111], v1, s[4:7], s68 offen offset:256 nt
    v_dot2_f32_bf16 v39, v84, v18, v39
    v_dot2_f32_bf16 v39, v85, v19, v39
    v_dot2_f32_bf16 v39, v86, v20, v39
    v_dot2_f32_bf16 v39, v87, v21, v39
    s_waitcnt vmcnt(7)
    s_xor_b32 s68, s69, 0xac800
    buffer_load_dwordx4 v[112:115], v1, s[4:7], s68 offen nt
    s_mov_b32 s71, 57344
    buffer_load_dwordx4 a[64:67], v4, s[16:19], s71 offen
    v_dot2_f32_bf16 v40, v88, v14, 0
    v_dot2_f32_bf16 v40, v89, v15, v40
    v_dot2_f32_bf16 v40, v90, v16, v40
    v_dot2_f32_bf16 v40, v91, v17, v40
    s_waitcnt vmcnt(7)
    buffer_load_dwordx4 v[116:119], v1, s[4:7], s68 offen offset:256 nt
    v_dot2_f32_bf16 v40, v92, v18, v40
    v_dot2_f32_bf16 v40, v93, v19, v40
    v_dot2_f32_bf16 v40, v94, v20, v40
    v_dot2_f32_bf16 v40, v95, v21, v40
    s_waitcnt vmcnt(7)
    s_xor_b32 s68, s69, 0xac200
    buffer_load_dwordx4 v[120:123], v1, s[4:7], s68 offen nt
    v_dot2_f32_bf16 v41, v96, v14, 0
    v_dot2_f32_bf16 v41, v97, v15, v41
    v_dot2_f32_bf16 v41, v98, v16, v41
    v_dot2_f32_bf16 v41, v99, v17, v41
    s_waitcnt vmcnt(7)
    buffer_load_dwordx4 v[124:127], v1, s[4:7], s68 offen offset:256 nt
    s_mov_b32 s71, 57344
    buffer_load_dwordx4 a[72:75], v6, s[16:19], s71 offen
    v_dot2_f32_bf16 v41, v100, v18, v41
    v_dot2_f32_bf16 v41, v101, v19, v41
    v_dot2_f32_bf16 v41, v102, v20, v41
    v_dot2_f32_bf16 v41, v103, v21, v41
    s_waitcnt vmcnt(7)
    s_xor_b32 s68, s69, 0xaca00
    buffer_load_dwordx4 v[128:131], v1, s[4:7], s68 offen nt
    v_dot2_f32_bf16 v42, v104, v14, 0
    v_dot2_f32_bf16 v42, v105, v15, v42
    v_dot2_f32_bf16 v42, v106, v16, v42
    v_dot2_f32_bf16 v42, v107, v17, v42
    s_waitcnt vmcnt(7)
    buffer_load_dwordx4 v[132:135], v1, s[4:7], s68 offen offset:256 nt
    v_dot2_f32_bf16 v42, v108, v18, v42
    v_dot2_f32_bf16 v42, v109, v19, v42
    v_dot2_f32_bf16 v42, v110, v20, v42
    v_dot2_f32_bf16 v42, v111, v21, v42
    s_waitcnt vmcnt(7)
    s_xor_b32 s68, s69, 0xe4000
    buffer_load_dwordx4 v[72:75], v1, s[4:7], s68 offen nt
    s_mov_b32 s71, 64512
    buffer_load_dwordx4 a[68:71], v4, s[16:19], s71 offen
    v_dot2_f32_bf16 v43, v112, v14, 0
    v_dot2_f32_bf16 v43, v113, v15, v43
    v_dot2_f32_bf16 v43, v114, v16, v43
    v_dot2_f32_bf16 v43, v115, v17, v43
    s_waitcnt vmcnt(7)
    buffer_load_dwordx4 v[76:79], v1, s[4:7], s68 offen offset:256 nt
    v_dot2_f32_bf16 v43, v116, v18, v43
    v_dot2_f32_bf16 v43, v117, v19, v43
    v_dot2_f32_bf16 v43, v118, v20, v43
    v_dot2_f32_bf16 v43, v119, v21, v43
    s_waitcnt vmcnt(7)
    s_xor_b32 s68, s69, 0xe4800
    buffer_load_dwordx4 v[80:83], v1, s[4:7], s68 offen nt
    v_dot2_f32_bf16 v44, v120, v14, 0
    v_dot2_f32_bf16 v44, v121, v15, v44
    v_dot2_f32_bf16 v44, v122, v16, v44
    v_dot2_f32_bf16 v44, v123, v17, v44
    s_waitcnt vmcnt(7)
    buffer_load_dwordx4 v[84:87], v1, s[4:7], s68 offen offset:256 nt
    s_mov_b32 s71, 64512
    buffer_load_dwordx4 a[76:79], v6, s[16:19], s71 offen
    v_dot2_f32_bf16 v44, v124, v18, v44
    v_dot2_f32_bf16 v44, v125, v19, v44
    v_dot2_f32_bf16 v44, v126, v20, v44
    v_dot2_f32_bf16 v44, v127, v21, v44
    s_waitcnt vmcnt(7)
    s_xor_b32 s68, s69, 0xe4200
    buffer_load_dwordx4 v[88:91], v1, s[4:7], s68 offen nt
    v_dot2_f32_bf16 v45, v128, v14, 0
    v_dot2_f32_bf16 v45, v129, v15, v45
    v_dot2_f32_bf16 v45, v130, v16, v45
    v_dot2_f32_bf16 v45, v131, v17, v45
    s_waitcnt vmcnt(7)
    buffer_load_dwordx4 v[92:95], v1, s[4:7], s68 offen offset:256 nt
    v_dot2_f32_bf16 v45, v132, v18, v45
    v_dot2_f32_bf16 v45, v133, v19, v45
    v_dot2_f32_bf16 v45, v134, v20, v45
    v_dot2_f32_bf16 v45, v135, v21, v45
    s_waitcnt vmcnt(7)
    s_xor_b32 s68, s69, 0xe4a00
    buffer_load_dwordx4 v[96:99], v1, s[4:7], s68 offen nt
    s_mov_b32 s71, 71680
    buffer_load_dwordx4 a[80:83], v4, s[16:19], s71 offen
    v_dot2_f32_bf16 v46, v72, v14, 0
    v_dot2_f32_bf16 v46, v73, v15, v46
    v_dot2_f32_bf16 v46, v74, v16, v46
    v_dot2_f32_bf16 v46, v75, v17, v46
    s_waitcnt vmcnt(7)
    buffer_load_dwordx4 v[100:103], v1, s[4:7], s68 offen offset:256 nt
    v_dot2_f32_bf16 v46, v76, v18, v46
    v_dot2_f32_bf16 v46, v77, v19, v46
    v_dot2_f32_bf16 v46, v78, v20, v46
    v_dot2_f32_bf16 v46, v79, v21, v46
    s_waitcnt vmcnt(7)
    s_xor_b32 s68, s69, 0xec000
    buffer_load_dwordx4 v[104:107], v1, s[4:7], s68 offen nt
    v_dot2_f32_bf16 v47, v80, v14, 0
    v_dot2_f32_bf16 v47, v81, v15, v47
    v_dot2_f32_bf16 v47, v82, v16, v47
    v_dot2_f32_bf16 v47, v83, v17, v47
    s_waitcnt vmcnt(7)
    buffer_load_dwordx4 v[108:111], v1, s[4:7], s68 offen offset:256 nt
    s_mov_b32 s71, 71680
    buffer_load_dwordx4 a[88:91], v6, s[16:19], s71 offen
    v_dot2_f32_bf16 v47, v84, v18, v47
    v_dot2_f32_bf16 v47, v85, v19, v47
    v_dot2_f32_bf16 v47, v86, v20, v47
    v_dot2_f32_bf16 v47, v87, v21, v47
    s_waitcnt vmcnt(7)
    s_xor_b32 s68, s69, 0xec800
    buffer_load_dwordx4 v[112:115], v1, s[4:7], s68 offen nt
    v_dot2_f32_bf16 v48, v88, v14, 0
    v_dot2_f32_bf16 v48, v89, v15, v48
    v_dot2_f32_bf16 v48, v90, v16, v48
    v_dot2_f32_bf16 v48, v91, v17, v48
    s_waitcnt vmcnt(7)
    buffer_load_dwordx4 v[116:119], v1, s[4:7], s68 offen offset:256 nt
    v_dot2_f32_bf16 v48, v92, v18, v48
    v_dot2_f32_bf16 v48, v93, v19, v48
    v_dot2_f32_bf16 v48, v94, v20, v48
    v_dot2_f32_bf16 v48, v95, v21, v48
    s_waitcnt vmcnt(7)
    s_xor_b32 s68, s69, 0xec200
    buffer_load_dwordx4 v[120:123], v1, s[4:7], s68 offen nt
    s_mov_b32 s71, 78848
    buffer_load_dwordx4 a[84:87], v4, s[16:19], s71 offen
    v_dot2_f32_bf16 v49, v96, v14, 0
    v_dot2_f32_bf16 v49, v97, v15, v49
    v_dot2_f32_bf16 v49, v98, v16, v49
    v_dot2_f32_bf16 v49, v99, v17, v49
    s_waitcnt vmcnt(7)
    buffer_load_dwordx4 v[124:127], v1, s[4:7], s68 offen offset:256 nt
    v_dot2_f32_bf16 v49, v100, v18, v49
    v_dot2_f32_bf16 v49, v101, v19, v49
    v_dot2_f32_bf16 v49, v102, v20, v49
    v_dot2_f32_bf16 v49, v103, v21, v49
    s_waitcnt vmcnt(7)
    s_xor_b32 s68, s69, 0xeca00
    buffer_load_dwordx4 v[128:131], v1, s[4:7], s68 offen nt
    v_dot2_f32_bf16 v50, v104, v14, 0
    v_dot2_f32_bf16 v50, v105, v15, v50
    v_dot2_f32_bf16 v50, v106, v16, v50
    v_dot2_f32_bf16 v50, v107, v17, v50
    s_waitcnt vmcnt(7)
    buffer_load_dwordx4 v[132:135], v1, s[4:7], s68 offen offset:256 nt
    s_mov_b32 s71, 78848
    buffer_load_dwordx4 a[92:95], v6, s[16:19], s71 offen
    v_dot2_f32_bf16 v50, v108, v18, v50
    v_dot2_f32_bf16 v50, v109, v19, v50
    v_dot2_f32_bf16 v50, v110, v20, v50
    v_dot2_f32_bf16 v50, v111, v21, v50
    s_waitcnt vmcnt(7)
    v_dot2_f32_bf16 v51, v112, v14, 0
    v_dot2_f32_bf16 v51, v113, v15, v51
    v_dot2_f32_bf16 v51, v114, v16, v51
    v_dot2_f32_bf16 v51, v115, v17, v51
    s_waitcnt vmcnt(6)
    s_xor_b32 s68, s69, 0x0
    buffer_load_dwordx4 v[72:75], v1, s[8:11], s68 offen nt
    v_dot2_f32_bf16 v51, v116, v18, v51
    v_dot2_f32_bf16 v51, v117, v19, v51
    v_dot2_f32_bf16 v51, v118, v20, v51
    v_dot2_f32_bf16 v51, v119, v21, v51
    s_waitcnt vmcnt(6)
    buffer_load_dwordx4 v[76:79], v1, s[8:11], s68 offen offset:256 nt
    v_dot2_f32_bf16 v52, v120, v14, 0
    v_dot2_f32_bf16 v52, v121, v15, v52
    v_dot2_f32_bf16 v52, v122, v16, v52
    v_dot2_f32_bf16 v52, v123, v17, v52
    s_waitcnt vmcnt(5)
    s_xor_b32 s68, s69, 0x800
    buffer_load_dwordx4 v[80:83], v1, s[8:11], s68 offen nt
    s_mov_b32 s71, 86016
    buffer_load_dwordx4 a[96:99], v4, s[16:19], s71 offen
    v_dot2_f32_bf16 v52, v124, v18, v52
    v_dot2_f32_bf16 v52, v125, v19, v52
    v_dot2_f32_bf16 v52, v126, v20, v52
    v_dot2_f32_bf16 v52, v127, v21, v52
    s_waitcnt vmcnt(6)
    buffer_load_dwordx4 v[84:87], v1, s[8:11], s68 offen offset:256 nt
    v_dot2_f32_bf16 v53, v128, v14, 0
    v_dot2_f32_bf16 v53, v129, v15, v53
    v_dot2_f32_bf16 v53, v130, v16, v53
    v_dot2_f32_bf16 v53, v131, v17, v53
    s_waitcnt vmcnt(6)
    s_xor_b32 s68, s69, 0x200
    buffer_load_dwordx4 v[88:91], v1, s[8:11], s68 offen nt
    v_dot2_f32_bf16 v53, v132, v18, v53
    v_dot2_f32_bf16 v53, v133, v19, v53
    v_dot2_f32_bf16 v53, v134, v20, v53
    v_dot2_f32_bf16 v53, v135, v21, v53
    s_nop 2
    v_add_f32_dpp v38, v38, v38 row_mirror row_mask:0xf bank_mask:0x3
    v_add_f32_dpp v40, v40, v40 row_mirror row_mask:0xf bank_mask:0x3
    v_add_f32_dpp v42, v42, v42 row_mirror row_mask:0xf bank_mask:0x3
    v_add_f32_dpp v44, v44, v44 row_mirror row_mask:0xf bank_mask:0x3
    v_add_f32_dpp v46, v46, v46 row_mirror row_mask:0xf bank_mask:0x3
    v_add_f32_dpp v48, v48, v48 row_mirror row_mask:0xf bank_mask:0x3
    v_add_f32_dpp v50, v50, v50 row_mirror row_mask:0xf bank_mask:0x3
    v_add_f32_dpp v52, v52, v52 row_mirror row_mask:0xf bank_mask:0x3
    v_add_f32_dpp v38, v39, v39 row_mirror row_mask:0xf bank_mask:0xc
    v_add_f32_dpp v40, v41, v41 row_mirror row_mask:0xf bank_mask:0xc
    v_add_f32_dpp v42, v43, v43 row_mirror row_mask:0xf bank_mask:0xc
    v_add_f32_dpp v44, v45, v45 row_mirror row_mask:0xf bank_mask:0xc
    v_add_f32_dpp v46, v47, v47 row_mirror row_mask:0xf bank_mask:0xc
    v_add_f32_dpp v48, v49, v49 row_mirror row_mask:0xf bank_mask:0xc
    v_add_f32_dpp v50, v51, v51 row_mirror row_mask:0xf bank_mask:0xc
    v_add_f32_dpp v52, v53, v53 row_mirror row_mask:0xf bank_mask:0xc
    s_waitcnt vmcnt(5)
    buffer_load_dwordx4 v[92:95], v1, s[8:11], s68 offen offset:256 nt
    s_mov_b32 s71, 86016
    buffer_load_dwordx4 a[104:107], v6, s[16:19], s71 offen
    v_add_f32_dpp v38, v38, v38 row_half_mirror row_mask:0xf bank_mask:0x5
    v_add_f32_dpp v42, v42, v42 row_half_mirror row_mask:0xf bank_mask:0x5
    v_add_f32_dpp v46, v46, v46 row_half_mirror row_mask:0xf bank_mask:0x5
    v_add_f32_dpp v50, v50, v50 row_half_mirror row_mask:0xf bank_mask:0x5
    v_add_f32_dpp v38, v40, v40 row_half_mirror row_mask:0xf bank_mask:0xa
    v_add_f32_dpp v42, v44, v44 row_half_mirror row_mask:0xf bank_mask:0xa
    v_add_f32_dpp v46, v48, v48 row_half_mirror row_mask:0xf bank_mask:0xa
    v_add_f32_dpp v50, v52, v52 row_half_mirror row_mask:0xf bank_mask:0xa
    v_add_f32_dpp v38, v38, v38 quad_perm:[1,0,3,2] row_mask:0xf bank_mask:0xf
    v_add_f32_dpp v42, v42, v42 quad_perm:[1,0,3,2] row_mask:0xf bank_mask:0xf
    v_add_f32_dpp v46, v46, v46 quad_perm:[1,0,3,2] row_mask:0xf bank_mask:0xf
    v_add_f32_dpp v50, v50, v50 quad_perm:[1,0,3,2] row_mask:0xf bank_mask:0xf
    v_add_f32_dpp v38, v38, v38 quad_perm:[2,3,0,1] row_mask:0xf bank_mask:0xf
    v_add_f32_dpp v42, v42, v42 quad_perm:[2,3,0,1] row_mask:0xf bank_mask:0xf
    v_add_f32_dpp v46, v46, v46 quad_perm:[2,3,0,1] row_mask:0xf bank_mask:0xf
    v_add_f32_dpp v50, v50, v50 quad_perm:[2,3,0,1] row_mask:0xf bank_mask:0xf
    s_mov_b32 vcc_lo, 0xaaaaaaaa
    s_mov_b32 vcc_hi, 0xaaaaaaaa
    v_cndmask_b32 v38, v38, v42, vcc
    v_cndmask_b32 v46, v46, v50, vcc
    s_mov_b32 vcc_lo, 0xcccccccc
    s_mov_b32 vcc_hi, 0xcccccccc
    v_cndmask_b32 v29, v38, v46, vcc
    v_cvt_pk_bf16_f32 v22, v22, v22
    v_and_b32 v22, s76, v22
    v_cvt_pk_bf16_f32 v23, v23, v23
    v_and_b32 v23, s76, v23
    v_cvt_pk_bf16_f32 v24, v24, v24
    v_and_b32 v24, s76, v24
    v_cvt_pk_bf16_f32 v25, v25, v25
    v_and_b32 v25, s76, v25
    v_cvt_pk_bf16_f32 v26, v26, v26
    v_and_b32 v26, s76, v26
    v_cvt_pk_bf16_f32 v27, v27, v27
    v_and_b32 v27, s76, v27
    v_cvt_pk_bf16_f32 v28, v28, v28
    v_and_b32 v28, s76, v28
    v_cvt_pk_bf16_f32 v29, v29, v29
    v_and_b32 v29, s76, v29
    v_max3_f32 v38, v22, v23, v24
    v_max3_f32 v38, v38, v25, v26
    v_max3_f32 v38, v38, v27, v28
    v_max_f32 v38, v38, v29
    s_nop 1
    v_max_f32_dpp v38, v38, v38 row_ror:8 row_mask:0xf bank_mask:0xf
    s_nop 1
    v_max_f32_dpp v38, v38, v38 row_ror:4 row_mask:0xf bank_mask:0xf
    s_nop 1
    v_max_f32_dpp v38, v38, v38 row_ror:2 row_mask:0xf bank_mask:0xf
    s_nop 1
    v_max_f32_dpp v38, v38, v38 row_ror:1 row_mask:0xf bank_mask:0xf
    v_mov_b32 v2, v38
    s_nop 1
    v_permlane16_swap_b32 v2, v38
    s_nop 1
    v_max_f32 v38, v38, v2
    v_mov_b32 v2, v38
    s_nop 1
    v_permlane32_swap_b32 v2, v38
    s_nop 1
    v_max_f32 v38, v38, v2
    s_waitcnt vmcnt(6)
    s_xor_b32 s68, s69, 0xa00
    buffer_load_dwordx4 v[96:99], v1, s[8:11], s68 offen nt
    v_sub_f32 v22, v22, v38
    v_sub_f32 v23, v23, v38
    v_sub_f32 v24, v24, v38
    v_sub_f32 v25, v25, v38
    v_sub_f32 v26, v26, v38
    v_sub_f32 v27, v27, v38
    v_sub_f32 v28, v28, v38
    v_sub_f32 v29, v29, v38
    v_mul_f32 v22, s75, v22
    v_mul_f32 v23, s75, v23
    v_mul_f32 v24, s75, v24
    v_mul_f32 v25, s75, v25
    v_mul_f32 v26, s75, v26
    v_mul_f32 v27, s75, v27
    v_mul_f32 v28, s75, v28
    v_mul_f32 v29, s75, v29
    v_exp_f32 v22, v22
    v_exp_f32 v23, v23
    v_exp_f32 v24, v24
    v_exp_f32 v25, v25
    v_exp_f32 v26, v26
    v_exp_f32 v27, v27
    v_exp_f32 v28, v28
    v_exp_f32 v29, v29
    v_add_f32 v39, v22, v23
    v_add_f32 v39, v39, v24
    v_add_f32 v39, v39, v25
    v_add_f32 v39, v39, v26
    v_add_f32 v39, v39, v27
    v_add_f32 v39, v39, v28
    v_add_f32 v39, v39, v29
    v_cvt_pk_bf16_f32 v2, v22, v22
    v_and_b32 v3, s76, v2
    v_sub_f32 v3, v22, v3
    v_cvt_pk_bf16_f32 v30, v3, v3
    v_mov_b32 v22, v2
    v_cvt_pk_bf16_f32 v2, v23, v23
    v_and_b32 v3, s76, v2
    v_sub_f32 v3, v23, v3
    v_cvt_pk_bf16_f32 v31, v3, v3
    v_mov_b32 v23, v2
    v_cvt_pk_bf16_f32 v2, v24, v24
    v_and_b32 v3, s76, v2
    v_sub_f32 v3, v24, v3
    v_cvt_pk_bf16_f32 v32, v3, v3
    v_mov_b32 v24, v2
    v_cvt_pk_bf16_f32 v2, v25, v25
    v_and_b32 v3, s76, v2
    v_sub_f32 v3, v25, v3
    v_cvt_pk_bf16_f32 v33, v3, v3
    v_mov_b32 v25, v2
    v_cvt_pk_bf16_f32 v2, v26, v26
    v_and_b32 v3, s76, v2
    v_sub_f32 v3, v26, v3
    v_cvt_pk_bf16_f32 v34, v3, v3
    v_mov_b32 v26, v2
    v_cvt_pk_bf16_f32 v2, v27, v27
    v_and_b32 v3, s76, v2
    v_sub_f32 v3, v27, v3
    v_cvt_pk_bf16_f32 v35, v3, v3
    v_mov_b32 v27, v2
    v_cvt_pk_bf16_f32 v2, v28, v28
    v_and_b32 v3, s76, v2
    v_sub_f32 v3, v28, v3
    v_cvt_pk_bf16_f32 v36, v3, v3
    v_mov_b32 v28, v2
    v_cvt_pk_bf16_f32 v2, v29, v29
    v_and_b32 v3, s76, v2
    v_sub_f32 v3, v29, v3
    v_cvt_pk_bf16_f32 v37, v3, v3
    v_mov_b32 v29, v2
    s_waitcnt vmcnt(6)
    buffer_load_dwordx4 v[100:103], v1, s[8:11], s68 offen offset:256 nt
    s_nop 1
    v_add_f32_dpp v39, v39, v39 row_ror:8 row_mask:0xf bank_mask:0xf
    s_nop 1
    v_add_f32_dpp v39, v39, v39 row_ror:4 row_mask:0xf bank_mask:0xf
    s_nop 1
    v_add_f32_dpp v39, v39, v39 row_ror:2 row_mask:0xf bank_mask:0xf
    s_nop 1
    v_add_f32_dpp v39, v39, v39 row_ror:1 row_mask:0xf bank_mask:0xf
    v_mov_b32 v2, v39
    s_nop 1
    v_permlane16_swap_b32 v2, v39
    s_nop 1
    v_add_f32 v39, v39, v2
    v_mov_b32 v2, v39
    s_nop 1
    v_permlane32_swap_b32 v2, v39
    s_nop 1
    v_add_f32 v39, v39, v2
    s_lshl_b32 s71, s62, 3
    v_mov_b32 v2, s71
    ds_write_b64 v2, v[38:39] offset:5120
    s_and_b32 s71, s74, 0xff
    v_mov_b32 v43, s71
    v_mov_b32 v54, 0
    v_mov_b32 v55, 0
    v_mov_b32 v56, 0
    v_mov_b32 v57, 0
    v_mov_b32 v58, 0
    v_mov_b32 v59, 0
    v_mov_b32 v60, 0
    v_mov_b32 v61, 0
    v_and_b32_dpp v62, v22, v10 row_newbcast:0 row_mask:0xf bank_mask:0x3
    v_and_b32_dpp v63, v22, v11 row_newbcast:0 row_mask:0xf bank_mask:0x3
    v_and_b32_dpp v64, v22, v12 row_newbcast:0 row_mask:0xf bank_mask:0x3
    v_and_b32_dpp v65, v22, v13 row_newbcast:0 row_mask:0xf bank_mask:0x3
    v_and_b32_dpp v62, v30, v10 row_newbcast:0 row_mask:0xf bank_mask:0xc
    v_and_b32_dpp v63, v30, v11 row_newbcast:0 row_mask:0xf bank_mask:0xc
    v_and_b32_dpp v64, v30, v12 row_newbcast:0 row_mask:0xf bank_mask:0xc
    v_and_b32_dpp v65, v30, v13 row_newbcast:0 row_mask:0xf bank_mask:0xc
    s_nop 0
    s_nop 0
    v_mfma_f32_16x16x32_bf16 v[54:57], v[62:65], v[72:75], v[54:57]
    v_mfma_f32_16x16x32_bf16 v[58:61], v[62:65], v[76:79], v[58:61]
    v_and_b32_dpp v66, v22, v10 row_newbcast:8 row_mask:0xf bank_mask:0x3
    v_and_b32_dpp v67, v22, v11 row_newbcast:8 row_mask:0xf bank_mask:0x3
    v_and_b32_dpp v68, v22, v12 row_newbcast:8 row_mask:0xf bank_mask:0x3
    v_and_b32_dpp v69, v22, v13 row_newbcast:8 row_mask:0xf bank_mask:0x3
    v_and_b32_dpp v66, v30, v10 row_newbcast:8 row_mask:0xf bank_mask:0xc
    v_and_b32_dpp v67, v30, v11 row_newbcast:8 row_mask:0xf bank_mask:0xc
    v_and_b32_dpp v68, v30, v12 row_newbcast:8 row_mask:0xf bank_mask:0xc
    v_and_b32_dpp v69, v30, v13 row_newbcast:8 row_mask:0xf bank_mask:0xc
    s_nop 0
    s_nop 0
    v_mfma_f32_16x16x32_bf16 v[54:57], v[66:69], v[80:83], v[54:57]
    s_waitcnt vmcnt(5)
    s_xor_b32 s68, s69, 0x8000
    buffer_load_dwordx4 v[104:107], v1, s[8:11], s68 offen nt
    s_mov_b32 s71, 93184
    buffer_load_dwordx4 a[100:103], v4, s[16:19], s71 offen
    v_mfma_f32_16x16x32_bf16 v[58:61], v[66:69], v[84:87], v[58:61]
    s_waitcnt vmcnt(6)
    buffer_load_dwordx4 v[108:111], v1, s[8:11], s68 offen offset:256 nt
    v_and_b32_dpp v62, v22, v10 row_newbcast:4 row_mask:0xf bank_mask:0x3
    v_and_b32_dpp v63, v22, v11 row_newbcast:4 row_mask:0xf bank_mask:0x3
    v_and_b32_dpp v64, v22, v12 row_newbcast:4 row_mask:0xf bank_mask:0x3
    v_and_b32_dpp v65, v22, v13 row_newbcast:4 row_mask:0xf bank_mask:0x3
    v_and_b32_dpp v62, v30, v10 row_newbcast:4 row_mask:0xf bank_mask:0xc
    v_and_b32_dpp v63, v30, v11 row_newbcast:4 row_mask:0xf bank_mask:0xc
    v_and_b32_dpp v64, v30, v12 row_newbcast:4 row_mask:0xf bank_mask:0xc
    v_and_b32_dpp v65, v30, v13 row_newbcast:4 row_mask:0xf bank_mask:0xc
    s_nop 0
    s_nop 0
    v_mfma_f32_16x16x32_bf16 v[54:57], v[62:65], v[88:91], v[54:57]
    s_waitcnt vmcnt(6)
    s_xor_b32 s68, s69, 0x8800
    buffer_load_dwordx4 v[112:115], v1, s[8:11], s68 offen nt
    v_mfma_f32_16x16x32_bf16 v[58:61], v[62:65], v[92:95], v[58:61]
    s_waitcnt vmcnt(5)
    buffer_load_dwordx4 v[116:119], v1, s[8:11], s68 offen offset:256 nt
    s_mov_b32 s71, 93184
    buffer_load_dwordx4 a[108:111], v6, s[16:19], s71 offen
    v_and_b32_dpp v66, v22, v10 row_newbcast:12 row_mask:0xf bank_mask:0x3
    v_and_b32_dpp v67, v22, v11 row_newbcast:12 row_mask:0xf bank_mask:0x3
    v_and_b32_dpp v68, v22, v12 row_newbcast:12 row_mask:0xf bank_mask:0x3
    v_and_b32_dpp v69, v22, v13 row_newbcast:12 row_mask:0xf bank_mask:0x3
    v_and_b32_dpp v66, v30, v10 row_newbcast:12 row_mask:0xf bank_mask:0xc
    v_and_b32_dpp v67, v30, v11 row_newbcast:12 row_mask:0xf bank_mask:0xc
    v_and_b32_dpp v68, v30, v12 row_newbcast:12 row_mask:0xf bank_mask:0xc
    v_and_b32_dpp v69, v30, v13 row_newbcast:12 row_mask:0xf bank_mask:0xc
    s_nop 0
    s_nop 0
    v_mfma_f32_16x16x32_bf16 v[54:57], v[66:69], v[96:99], v[54:57]
    s_waitcnt vmcnt(6)
    s_xor_b32 s68, s69, 0x8200
    buffer_load_dwordx4 v[120:123], v1, s[8:11], s68 offen nt
    v_mfma_f32_16x16x32_bf16 v[58:61], v[66:69], v[100:103], v[58:61]
    s_waitcnt vmcnt(6)
    buffer_load_dwordx4 v[124:127], v1, s[8:11], s68 offen offset:256 nt
    v_and_b32_dpp v62, v22, v10 row_newbcast:1 row_mask:0xf bank_mask:0x3
    v_and_b32_dpp v63, v22, v11 row_newbcast:1 row_mask:0xf bank_mask:0x3
    v_and_b32_dpp v64, v22, v12 row_newbcast:1 row_mask:0xf bank_mask:0x3
    v_and_b32_dpp v65, v22, v13 row_newbcast:1 row_mask:0xf bank_mask:0x3
    v_and_b32_dpp v62, v30, v10 row_newbcast:1 row_mask:0xf bank_mask:0xc
    v_and_b32_dpp v63, v30, v11 row_newbcast:1 row_mask:0xf bank_mask:0xc
    v_and_b32_dpp v64, v30, v12 row_newbcast:1 row_mask:0xf bank_mask:0xc
    v_and_b32_dpp v65, v30, v13 row_newbcast:1 row_mask:0xf bank_mask:0xc
    s_nop 0
    s_nop 0
    v_mfma_f32_16x16x32_bf16 v[54:57], v[62:65], v[104:107], v[54:57]
    s_waitcnt vmcnt(5)
    s_xor_b32 s68, s69, 0x8a00
    buffer_load_dwordx4 v[128:131], v1, s[8:11], s68 offen nt
    s_mov_b32 s71, 100352
    buffer_load_dwordx4 a[112:115], v4, s[16:19], s71 offen
    v_mfma_f32_16x16x32_bf16 v[58:61], v[62:65], v[108:111], v[58:61]
    s_waitcnt vmcnt(6)
    buffer_load_dwordx4 v[132:135], v1, s[8:11], s68 offen offset:256 nt
    v_and_b32_dpp v66, v22, v10 row_newbcast:9 row_mask:0xf bank_mask:0x3
    v_and_b32_dpp v67, v22, v11 row_newbcast:9 row_mask:0xf bank_mask:0x3
    v_and_b32_dpp v68, v22, v12 row_newbcast:9 row_mask:0xf bank_mask:0x3
    v_and_b32_dpp v69, v22, v13 row_newbcast:9 row_mask:0xf bank_mask:0x3
    v_and_b32_dpp v66, v30, v10 row_newbcast:9 row_mask:0xf bank_mask:0xc
    v_and_b32_dpp v67, v30, v11 row_newbcast:9 row_mask:0xf bank_mask:0xc
    v_and_b32_dpp v68, v30, v12 row_newbcast:9 row_mask:0xf bank_mask:0xc
    v_and_b32_dpp v69, v30, v13 row_newbcast:9 row_mask:0xf bank_mask:0xc
    s_nop 0
    s_nop 0
    v_mfma_f32_16x16x32_bf16 v[54:57], v[66:69], v[112:115], v[54:57]
    s_waitcnt vmcnt(6)
    s_xor_b32 s68, s69, 0x40000
    buffer_load_dwordx4 v[72:75], v1, s[8:11], s68 offen nt
    v_mfma_f32_16x16x32_bf16 v[58:61], v[66:69], v[116:119], v[58:61]
    s_waitcnt vmcnt(5)
    buffer_load_dwordx4 v[76:79], v1, s[8:11], s68 offen offset:256 nt
    s_mov_b32 s71, 100352
    buffer_load_dwordx4 a[120:123], v6, s[16:19], s71 offen
    v_and_b32_dpp v62, v22, v10 row_newbcast:5 row_mask:0xf bank_mask:0x3
    v_and_b32_dpp v63, v22, v11 row_newbcast:5 row_mask:0xf bank_mask:0x3
    v_and_b32_dpp v64, v22, v12 row_newbcast:5 row_mask:0xf bank_mask:0x3
    v_and_b32_dpp v65, v22, v13 row_newbcast:5 row_mask:0xf bank_mask:0x3
    v_and_b32_dpp v62, v30, v10 row_newbcast:5 row_mask:0xf bank_mask:0xc
    v_and_b32_dpp v63, v30, v11 row_newbcast:5 row_mask:0xf bank_mask:0xc
    v_and_b32_dpp v64, v30, v12 row_newbcast:5 row_mask:0xf bank_mask:0xc
    v_and_b32_dpp v65, v30, v13 row_newbcast:5 row_mask:0xf bank_mask:0xc
    s_nop 0
    s_nop 0
    v_mfma_f32_16x16x32_bf16 v[54:57], v[62:65], v[120:123], v[54:57]
    s_waitcnt vmcnt(6)
    s_xor_b32 s68, s69, 0x40800
    buffer_load_dwordx4 v[80:83], v1, s[8:11], s68 offen nt
    v_mfma_f32_16x16x32_bf16 v[58:61], v[62:65], v[124:127], v[58:61]
    s_waitcnt vmcnt(6)
    buffer_load_dwordx4 v[84:87], v1, s[8:11], s68 offen offset:256 nt
    v_and_b32_dpp v66, v22, v10 row_newbcast:13 row_mask:0xf bank_mask:0x3
    v_and_b32_dpp v67, v22, v11 row_newbcast:13 row_mask:0xf bank_mask:0x3
    v_and_b32_dpp v68, v22, v12 row_newbcast:13 row_mask:0xf bank_mask:0x3
    v_and_b32_dpp v69, v22, v13 row_newbcast:13 row_mask:0xf bank_mask:0x3
    v_and_b32_dpp v66, v30, v10 row_newbcast:13 row_mask:0xf bank_mask:0xc
    v_and_b32_dpp v67, v30, v11 row_newbcast:13 row_mask:0xf bank_mask:0xc
    v_and_b32_dpp v68, v30, v12 row_newbcast:13 row_mask:0xf bank_mask:0xc
    v_and_b32_dpp v69, v30, v13 row_newbcast:13 row_mask:0xf bank_mask:0xc
    s_nop 0
    s_nop 0
    v_mfma_f32_16x16x32_bf16 v[54:57], v[66:69], v[128:131], v[54:57]
    s_waitcnt vmcnt(5)
    s_xor_b32 s68, s69, 0x40200
    buffer_load_dwordx4 v[88:91], v1, s[8:11], s68 offen nt
    s_mov_b32 s71, 107520
    buffer_load_dwordx4 a[116:119], v4, s[16:19], s71 offen
    v_mfma_f32_16x16x32_bf16 v[58:61], v[66:69], v[132:135], v[58:61]
    s_waitcnt vmcnt(6)
    buffer_load_dwordx4 v[92:95], v1, s[8:11], s68 offen offset:256 nt
    v_mov_b32 v44, 0
    s_waitcnt lgkmcnt(0)
    s_barrier
    ds_read_b128 v[14:17], v44 offset:5120
    ds_read_b128 v[18:21], v44 offset:5136
    s_waitcnt lgkmcnt(0)
    v_max3_f32 v40, v14, v16, v18
    v_max_f32 v40, v40, v20
    v_sub_f32 v38, v14, v40
    v_sub_f32 v39, v16, v40
    v_sub_f32 v50, v18, v40
    v_sub_f32 v51, v20, v40
    v_mul_f32 v38, s75, v38
    v_mul_f32 v39, s75, v39
    v_mul_f32 v50, s75, v50
    v_mul_f32 v51, s75, v51
    v_exp_f32 v38, v38
    v_exp_f32 v39, v39
    v_exp_f32 v50, v50
    v_exp_f32 v51, v51
    v_mul_f32 v41, v38, v15
    v_fmac_f32 v41, v39, v17
    v_fmac_f32 v41, v50, v19
    v_fmac_f32 v41, v51, v21
    v_and_b32 v41, s77, v41
    s_cmp_lg_u32 s62, 0
    s_cbranch_scc1 L_nohdr
    v_or_b32 v14, v40, v43
    v_or_b32 v15, v41, v43
    v_mov_b32 v16, s74
    v_mov_b32 v17, s74
    s_lshl_b32 s71, s63, 7
    s_add_u32 s71, s71, 32768
    s_mov_b64 exec, 1
    buffer_store_dwordx4 v[14:17], v44, s[32:35], s71 offen sc1
    s_mov_b64 exec, -1
L_nohdr:
    v_and_b32_dpp v62, v22, v10 row_newbcast:2 row_mask:0xf bank_mask:0x3
    v_and_b32_dpp v63, v22, v11 row_newbcast:2 row_mask:0xf bank_mask:0x3
    v_and_b32_dpp v64, v22, v12 row_newbcast:2 row_mask:0xf bank_mask:0x3
    v_and_b32_dpp v65, v22, v13 row_newbcast:2 row_mask:0xf bank_mask:0x3
    v_and_b32_dpp v62, v30, v10 row_newbcast:2 row_mask:0xf bank_mask:0xc
    v_and_b32_dpp v63, v30, v11 row_newbcast:2 row_mask:0xf bank_mask:0xc
    v_and_b32_dpp v64, v30, v12 row_newbcast:2 row_mask:0xf bank_mask:0xc
    v_and_b32_dpp v65, v30, v13 row_newbcast:2 row_mask:0xf bank_mask:0xc
    s_nop 0
    s_nop 0
    v_mfma_f32_16x16x32_bf16 v[54:57], v[62:65], v[72:75], v[54:57]
    s_waitcnt vmcnt(6)
    s_xor_b32 s68, s69, 0x40a00
    buffer_load_dwordx4 v[96:99], v1, s[8:11], s68 offen nt
    v_mfma_f32_16x16x32_bf16 v[58:61], v[62:65], v[76:79], v[58:61]
    s_waitcnt vmcnt(5)
    buffer_load_dwordx4 v[100:103], v1, s[8:11], s68 offen offset:256 nt
    s_mov_b32 s71, 107520
    buffer_load_dwordx4 a[124:127], v6, s[16:19], s71 offen
    v_and_b32_dpp v66, v22, v10 row_newbcast:10 row_mask:0xf bank_mask:0x3
    v_and_b32_dpp v67, v22, v11 row_newbcast:10 row_mask:0xf bank_mask:0x3
    v_and_b32_dpp v68, v22, v12 row_newbcast:10 row_mask:0xf bank_mask:0x3
    v_and_b32_dpp v69, v22, v13 row_newbcast:10 row_mask:0xf bank_mask:0x3
    v_and_b32_dpp v66, v30, v10 row_newbcast:10 row_mask:0xf bank_mask:0xc
    v_and_b32_dpp v67, v30, v11 row_newbcast:10 row_mask:0xf bank_mask:0xc
    v_and_b32_dpp v68, v30, v12 row_newbcast:10 row_mask:0xf bank_mask:0xc
    v_and_b32_dpp v69, v30, v13 row_newbcast:10 row_mask:0xf bank_mask:0xc
    s_nop 0
    s_nop 0
    v_mfma_f32_16x16x32_bf16 v[54:57], v[66:69], v[80:83], v[54:57]
    s_waitcnt vmcnt(6)
    s_xor_b32 s68, s69, 0x48000
    buffer_load_dwordx4 v[104:107], v1, s[8:11], s68 offen nt
    v_mfma_f32_16x16x32_bf16 v[58:61], v[66:69], v[84:87], v[58:61]
    s_waitcnt vmcnt(6)
    buffer_load_dwordx4 v[108:111], v1, s[8:11], s68 offen offset:256 nt
    v_and_b32_dpp v62, v22, v10 row_newbcast:6 row_mask:0xf bank_mask:0x3
    v_and_b32_dpp v63, v22, v11 row_newbcast:6 row_mask:0xf bank_mask:0x3
    v_and_b32_dpp v64, v22, v12 row_newbcast:6 row_mask:0xf bank_mask:0x3
    v_and_b32_dpp v65, v22, v13 row_newbcast:6 row_mask:0xf bank_mask:0x3
    v_and_b32_dpp v62, v30, v10 row_newbcast:6 row_mask:0xf bank_mask:0xc
    v_and_b32_dpp v63, v30, v11 row_newbcast:6 row_mask:0xf bank_mask:0xc
    v_and_b32_dpp v64, v30, v12 row_newbcast:6 row_mask:0xf bank_mask:0xc
    v_and_b32_dpp v65, v30, v13 row_newbcast:6 row_mask:0xf bank_mask:0xc
    s_nop 0
    s_nop 0
    v_mfma_f32_16x16x32_bf16 v[54:57], v[62:65], v[88:91], v[54:57]
    s_waitcnt vmcnt(5)
    s_xor_b32 s68, s69, 0x48800
    buffer_load_dwordx4 v[112:115], v1, s[8:11], s68 offen nt
    s_mov_b32 s71, 114688
    buffer_load_dwordx4 a[128:131], v4, s[16:19], s71 offen
    v_mfma_f32_16x16x32_bf16 v[58:61], v[62:65], v[92:95], v[58:61]
    s_waitcnt vmcnt(6)
    buffer_load_dwordx4 v[116:119], v1, s[8:11], s68 offen offset:256 nt
    v_and_b32_dpp v66, v22, v10 row_newbcast:14 row_mask:0xf bank_mask:0x3
    v_and_b32_dpp v67, v22, v11 row_newbcast:14 row_mask:0xf bank_mask:0x3
    v_and_b32_dpp v68, v22, v12 row_newbcast:14 row_mask:0xf bank_mask:0x3
    v_and_b32_dpp v69, v22, v13 row_newbcast:14 row_mask:0xf bank_mask:0x3
    v_and_b32_dpp v66, v30, v10 row_newbcast:14 row_mask:0xf bank_mask:0xc
    v_and_b32_dpp v67, v30, v11 row_newbcast:14 row_mask:0xf bank_mask:0xc
    v_and_b32_dpp v68, v30, v12 row_newbcast:14 row_mask:0xf bank_mask:0xc
    v_and_b32_dpp v69, v30, v13 row_newbcast:14 row_mask:0xf bank_mask:0xc
    s_nop 0
    s_nop 0
    v_mfma_f32_16x16x32_bf16 v[54:57], v[66:69], v[96:99], v[54:57]
    s_waitcnt vmcnt(6)
    s_xor_b32 s68, s69, 0x48200
    buffer_load_dwordx4 v[120:123], v1, s[8:11], s68 offen nt
    v_mfma_f32_16x16x32_bf16 v[58:61], v[66:69], v[100:103], v[58:61]
    s_waitcnt vmcnt(5)
    buffer_load_dwordx4 v[124:127], v1, s[8:11], s68 offen offset:256 nt
    s_mov_b32 s71, 114688
    buffer_load_dwordx4 a[136:139], v6, s[16:19], s71 offen
    v_and_b32_dpp v62, v22, v10 row_newbcast:3 row_mask:0xf bank_mask:0x3
    v_and_b32_dpp v63, v22, v11 row_newbcast:3 row_mask:0xf bank_mask:0x3
    v_and_b32_dpp v64, v22, v12 row_newbcast:3 row_mask:0xf bank_mask:0x3
    v_and_b32_dpp v65, v22, v13 row_newbcast:3 row_mask:0xf bank_mask:0x3
    v_and_b32_dpp v62, v30, v10 row_newbcast:3 row_mask:0xf bank_mask:0xc
    v_and_b32_dpp v63, v30, v11 row_newbcast:3 row_mask:0xf bank_mask:0xc
    v_and_b32_dpp v64, v30, v12 row_newbcast:3 row_mask:0xf bank_mask:0xc
    v_and_b32_dpp v65, v30, v13 row_newbcast:3 row_mask:0xf bank_mask:0xc
    s_nop 0
    s_nop 0
    v_mfma_f32_16x16x32_bf16 v[54:57], v[62:65], v[104:107], v[54:57]
    s_waitcnt vmcnt(6)
    s_xor_b32 s68, s69, 0x48a00
    buffer_load_dwordx4 v[128:131], v1, s[8:11], s68 offen nt
    v_mfma_f32_16x16x32_bf16 v[58:61], v[62:65], v[108:111], v[58:61]
    s_waitcnt vmcnt(6)
    buffer_load_dwordx4 v[132:135], v1, s[8:11], s68 offen offset:256 nt
    v_and_b32_dpp v66, v22, v10 row_newbcast:11 row_mask:0xf bank_mask:0x3
    v_and_b32_dpp v67, v22, v11 row_newbcast:11 row_mask:0xf bank_mask:0x3
    v_and_b32_dpp v68, v22, v12 row_newbcast:11 row_mask:0xf bank_mask:0x3
    v_and_b32_dpp v69, v22, v13 row_newbcast:11 row_mask:0xf bank_mask:0x3
    v_and_b32_dpp v66, v30, v10 row_newbcast:11 row_mask:0xf bank_mask:0xc
    v_and_b32_dpp v67, v30, v11 row_newbcast:11 row_mask:0xf bank_mask:0xc
    v_and_b32_dpp v68, v30, v12 row_newbcast:11 row_mask:0xf bank_mask:0xc
    v_and_b32_dpp v69, v30, v13 row_newbcast:11 row_mask:0xf bank_mask:0xc
    s_nop 0
    s_nop 0
    v_mfma_f32_16x16x32_bf16 v[54:57], v[66:69], v[112:115], v[54:57]
    s_waitcnt vmcnt(5)
    s_xor_b32 s68, s69, 0x4000
    buffer_load_dwordx4 v[72:75], v1, s[8:11], s68 offen nt
    s_mov_b32 s71, 121856
    buffer_load_dwordx4 a[132:135], v4, s[16:19], s71 offen
    v_mfma_f32_16x16x32_bf16 v[58:61], v[66:69], v[116:119], v[58:61]
    s_waitcnt vmcnt(6)
    buffer_load_dwordx4 v[76:79], v1, s[8:11], s68 offen offset:256 nt
    v_and_b32_dpp v62, v22, v10 row_newbcast:7 row_mask:0xf bank_mask:0x3
    v_and_b32_dpp v63, v22, v11 row_newbcast:7 row_mask:0xf bank_mask:0x3
    v_and_b32_dpp v64, v22, v12 row_newbcast:7 row_mask:0xf bank_mask:0x3
    v_and_b32_dpp v65, v22, v13 row_newbcast:7 row_mask:0xf bank_mask:0x3
    v_and_b32_dpp v62, v30, v10 row_newbcast:7 row_mask:0xf bank_mask:0xc
    v_and_b32_dpp v63, v30, v11 row_newbcast:7 row_mask:0xf bank_mask:0xc
    v_and_b32_dpp v64, v30, v12 row_newbcast:7 row_mask:0xf bank_mask:0xc
    v_and_b32_dpp v65, v30, v13 row_newbcast:7 row_mask:0xf bank_mask:0xc
    s_nop 0
    s_nop 0
    v_mfma_f32_16x16x32_bf16 v[54:57], v[62:65], v[120:123], v[54:57]
    s_waitcnt vmcnt(6)
    s_xor_b32 s68, s69, 0x4800
    buffer_load_dwordx4 v[80:83], v1, s[8:11], s68 offen nt
    v_mfma_f32_16x16x32_bf16 v[58:61], v[62:65], v[124:127], v[58:61]
    s_waitcnt vmcnt(5)
    buffer_load_dwordx4 v[84:87], v1, s[8:11], s68 offen offset:256 nt
    s_mov_b32 s71, 121856
    buffer_load_dwordx4 a[140:143], v6, s[16:19], s71 offen
    v_and_b32_dpp v66, v22, v10 row_newbcast:15 row_mask:0xf bank_mask:0x3
    v_and_b32_dpp v67, v22, v11 row_newbcast:15 row_mask:0xf bank_mask:0x3
    v_and_b32_dpp v68, v22, v12 row_newbcast:15 row_mask:0xf bank_mask:0x3
    v_and_b32_dpp v69, v22, v13 row_newbcast:15 row_mask:0xf bank_mask:0x3
    v_and_b32_dpp v66, v30, v10 row_newbcast:15 row_mask:0xf bank_mask:0xc
    v_and_b32_dpp v67, v30, v11 row_newbcast:15 row_mask:0xf bank_mask:0xc
    v_and_b32_dpp v68, v30, v12 row_newbcast:15 row_mask:0xf bank_mask:0xc
    v_and_b32_dpp v69, v30, v13 row_newbcast:15 row_mask:0xf bank_mask:0xc
    s_nop 0
    s_nop 0
    v_mfma_f32_16x16x32_bf16 v[54:57], v[66:69], v[128:131], v[54:57]
    s_waitcnt vmcnt(6)
    s_xor_b32 s68, s69, 0x4200
    buffer_load_dwordx4 v[88:91], v1, s[8:11], s68 offen nt
    v_mfma_f32_16x16x32_bf16 v[58:61], v[66:69], v[132:135], v[58:61]
    s_waitcnt vmcnt(6)
    buffer_load_dwordx4 v[92:95], v1, s[8:11], s68 offen offset:256 nt
    v_and_b32_dpp v62, v23, v10 row_newbcast:0 row_mask:0xf bank_mask:0x3
    v_and_b32_dpp v63, v23, v11 row_newbcast:0 row_mask:0xf bank_mask:0x3
    v_and_b32_dpp v64, v23, v12 row_newbcast:0 row_mask:0xf bank_mask:0x3
    v_and_b32_dpp v65, v23, v13 row_newbcast:0 row_mask:0xf bank_mask:0x3
    v_and_b32_dpp v62, v31, v10 row_newbcast:0 row_mask:0xf bank_mask:0xc
    v_and_b32_dpp v63, v31, v11 row_newbcast:0 row_mask:0xf bank_mask:0xc
    v_and_b32_dpp v64, v31, v12 row_newbcast:0 row_mask:0xf bank_mask:0xc
    v_and_b32_dpp v65, v31, v13 row_newbcast:0 row_mask:0xf bank_mask:0xc
    s_nop 0
    s_nop 0
    v_mfma_f32_16x16x32_bf16 v[54:57], v[62:65], v[72:75], v[54:57]
    s_waitcnt vmcnt(5)
    s_xor_b32 s68, s69, 0x4a00
    buffer_load_dwordx4 v[96:99], v1, s[8:11], s68 offen nt
    s_mov_b32 s71, 129024
    buffer_load_dwordx4 a[144:147], v4, s[16:19], s71 offen
    v_mfma_f32_16x16x32_bf16 v[58:61], v[62:65], v[76:79], v[58:61]
    s_waitcnt vmcnt(6)
    buffer_load_dwordx4 v[100:103], v1, s[8:11], s68 offen offset:256 nt
    v_and_b32_dpp v66, v23, v10 row_newbcast:8 row_mask:0xf bank_mask:0x3
    v_and_b32_dpp v67, v23, v11 row_newbcast:8 row_mask:0xf bank_mask:0x3
    v_and_b32_dpp v68, v23, v12 row_newbcast:8 row_mask:0xf bank_mask:0x3
    v_and_b32_dpp v69, v23, v13 row_newbcast:8 row_mask:0xf bank_mask:0x3
    v_and_b32_dpp v66, v31, v10 row_newbcast:8 row_mask:0xf bank_mask:0xc
    v_and_b32_dpp v67, v31, v11 row_newbcast:8 row_mask:0xf bank_mask:0xc
    v_and_b32_dpp v68, v31, v12 row_newbcast:8 row_mask:0xf bank_mask:0xc
    v_and_b32_dpp v69, v31, v13 row_newbcast:8 row_mask:0xf bank_mask:0xc
    s_nop 0
    s_nop 0
    v_mfma_f32_16x16x32_bf16 v[54:57], v[66:69], v[80:83], v[54:57]
    s_waitcnt vmcnt(6)
    s_xor_b32 s68, s69, 0xc000
    buffer_load_dwordx4 v[104:107], v1, s[8:11], s68 offen nt
    v_mfma_f32_16x16x32_bf16 v[58:61], v[66:69], v[84:87], v[58:61]
    s_waitcnt vmcnt(5)
    buffer_load_dwordx4 v[108:111], v1, s[8:11], s68 offen offset:256 nt
    s_mov_b32 s71, 129024
    buffer_load_dwordx4 a[152:155], v6, s[16:19], s71 offen
    v_and_b32_dpp v62, v23, v10 row_newbcast:4 row_mask:0xf bank_mask:0x3
    v_and_b32_dpp v63, v23, v11 row_newbcast:4 row_mask:0xf bank_mask:0x3
    v_and_b32_dpp v64, v23, v12 row_newbcast:4 row_mask:0xf bank_mask:0x3
    v_and_b32_dpp v65, v23, v13 row_newbcast:4 row_mask:0xf bank_mask:0x3
    v_and_b32_dpp v62, v31, v10 row_newbcast:4 row_mask:0xf bank_mask:0xc
    v_and_b32_dpp v63, v31, v11 row_newbcast:4 row_mask:0xf bank_mask:0xc
    v_and_b32_dpp v64, v31, v12 row_newbcast:4 row_mask:0xf bank_mask:0xc
    v_and_b32_dpp v65, v31, v13 row_newbcast:4 row_mask:0xf bank_mask:0xc
    s_nop 0
    s_nop 0
    v_mfma_f32_16x16x32_bf16 v[54:57], v[62:65], v[88:91], v[54:57]
    s_waitcnt vmcnt(6)
    s_xor_b32 s68, s69, 0xc800
    buffer_load_dwordx4 v[112:115], v1, s[8:11], s68 offen nt
    v_mfma_f32_16x16x32_bf16 v[58:61], v[62:65], v[92:95], v[58:61]
    s_waitcnt vmcnt(6)
    buffer_load_dwordx4 v[116:119], v1, s[8:11], s68 offen offset:256 nt
    v_and_b32_dpp v66, v23, v10 row_newbcast:12 row_mask:0xf bank_mask:0x3
    v_and_b32_dpp v67, v23, v11 row_newbcast:12 row_mask:0xf bank_mask:0x3
    v_and_b32_dpp v68, v23, v12 row_newbcast:12 row_mask:0xf bank_mask:0x3
    v_and_b32_dpp v69, v23, v13 row_newbcast:12 row_mask:0xf bank_mask:0x3
    v_and_b32_dpp v66, v31, v10 row_newbcast:12 row_mask:0xf bank_mask:0xc
    v_and_b32_dpp v67, v31, v11 row_newbcast:12 row_mask:0xf bank_mask:0xc
    v_and_b32_dpp v68, v31, v12 row_newbcast:12 row_mask:0xf bank_mask:0xc
    v_and_b32_dpp v69, v31, v13 row_newbcast:12 row_mask:0xf bank_mask:0xc
    s_nop 0
    s_nop 0
    v_mfma_f32_16x16x32_bf16 v[54:57], v[66:69], v[96:99], v[54:57]
    s_waitcnt vmcnt(5)
    s_xor_b32 s68, s69, 0xc200
    buffer_load_dwordx4 v[120:123], v1, s[8:11], s68 offen nt
    s_mov_b32 s71, 136192
    buffer_load_dwordx4 a[148:151], v4, s[16:19], s71 offen
    v_mfma_f32_16x16x32_bf16 v[58:61], v[66:69], v[100:103], v[58:61]
    s_waitcnt vmcnt(6)
    buffer_load_dwordx4 v[124:127], v1, s[8:11], s68 offen offset:256 nt
    v_and_b32_dpp v62, v23, v10 row_newbcast:1 row_mask:0xf bank_mask:0x3
    v_and_b32_dpp v63, v23, v11 row_newbcast:1 row_mask:0xf bank_mask:0x3
    v_and_b32_dpp v64, v23, v12 row_newbcast:1 row_mask:0xf bank_mask:0x3
    v_and_b32_dpp v65, v23, v13 row_newbcast:1 row_mask:0xf bank_mask:0x3
    v_and_b32_dpp v62, v31, v10 row_newbcast:1 row_mask:0xf bank_mask:0xc
    v_and_b32_dpp v63, v31, v11 row_newbcast:1 row_mask:0xf bank_mask:0xc
    v_and_b32_dpp v64, v31, v12 row_newbcast:1 row_mask:0xf bank_mask:0xc
    v_and_b32_dpp v65, v31, v13 row_newbcast:1 row_mask:0xf bank_mask:0xc
    s_nop 0
    s_nop 0
    v_mfma_f32_16x16x32_bf16 v[54:57], v[62:65], v[104:107], v[54:57]
    s_waitcnt vmcnt(6)
    s_xor_b32 s68, s69, 0xca00
    buffer_load_dwordx4 v[128:131], v1, s[8:11], s68 offen nt
    v_mfma_f32_16x16x32_bf16 v[58:61], v[62:65], v[108:111], v[58:61]
    s_waitcnt vmcnt(5)
    buffer_load_dwordx4 v[132:135], v1, s[8:11], s68 offen offset:256 nt
    s_mov_b32 s71, 136192
    buffer_load_dwordx4 a[156:159], v6, s[16:19], s71 offen
    v_and_b32_dpp v66, v23, v10 row_newbcast:9 row_mask:0xf bank_mask:0x3
    v_and_b32_dpp v67, v23, v11 row_newbcast:9 row_mask:0xf bank_mask:0x3
    v_and_b32_dpp v68, v23, v12 row_newbcast:9 row_mask:0xf bank_mask:0x3
    v_and_b32_dpp v69, v23, v13 row_newbcast:9 row_mask:0xf bank_mask:0x3
    v_and_b32_dpp v66, v31, v10 row_newbcast:9 row_mask:0xf bank_mask:0xc
    v_and_b32_dpp v67, v31, v11 row_newbcast:9 row_mask:0xf bank_mask:0xc
    v_and_b32_dpp v68, v31, v12 row_newbcast:9 row_mask:0xf bank_mask:0xc
    v_and_b32_dpp v69, v31, v13 row_newbcast:9 row_mask:0xf bank_mask:0xc
    s_nop 0
    s_nop 0
    v_mfma_f32_16x16x32_bf16 v[54:57], v[66:69], v[112:115], v[54:57]
    s_waitcnt vmcnt(6)
    s_xor_b32 s68, s69, 0x44000
    buffer_load_dwordx4 v[72:75], v1, s[8:11], s68 offen nt
    v_mfma_f32_16x16x32_bf16 v[58:61], v[66:69], v[116:119], v[58:61]
    s_waitcnt vmcnt(6)
    buffer_load_dwordx4 v[76:79], v1, s[8:11], s68 offen offset:256 nt
    v_and_b32_dpp v62, v23, v10 row_newbcast:5 row_mask:0xf bank_mask:0x3
    v_and_b32_dpp v63, v23, v11 row_newbcast:5 row_mask:0xf bank_mask:0x3
    v_and_b32_dpp v64, v23, v12 row_newbcast:5 row_mask:0xf bank_mask:0x3
    v_and_b32_dpp v65, v23, v13 row_newbcast:5 row_mask:0xf bank_mask:0x3
    v_and_b32_dpp v62, v31, v10 row_newbcast:5 row_mask:0xf bank_mask:0xc
    v_and_b32_dpp v63, v31, v11 row_newbcast:5 row_mask:0xf bank_mask:0xc
    v_and_b32_dpp v64, v31, v12 row_newbcast:5 row_mask:0xf bank_mask:0xc
    v_and_b32_dpp v65, v31, v13 row_newbcast:5 row_mask:0xf bank_mask:0xc
    s_nop 0
    s_nop 0
    v_mfma_f32_16x16x32_bf16 v[54:57], v[62:65], v[120:123], v[54:57]
    s_waitcnt vmcnt(5)
    s_xor_b32 s68, s69, 0x44800
    buffer_load_dwordx4 v[80:83], v1, s[8:11], s68 offen nt
    s_mov_b32 s71, 143360
    buffer_load_dwordx4 a[160:163], v4, s[16:19], s71 offen
    v_mfma_f32_16x16x32_bf16 v[58:61], v[62:65], v[124:127], v[58:61]
    s_waitcnt vmcnt(6)
    buffer_load_dwordx4 v[84:87], v1, s[8:11], s68 offen offset:256 nt
    v_and_b32_dpp v66, v23, v10 row_newbcast:13 row_mask:0xf bank_mask:0x3
    v_and_b32_dpp v67, v23, v11 row_newbcast:13 row_mask:0xf bank_mask:0x3
    v_and_b32_dpp v68, v23, v12 row_newbcast:13 row_mask:0xf bank_mask:0x3
    v_and_b32_dpp v69, v23, v13 row_newbcast:13 row_mask:0xf bank_mask:0x3
    v_and_b32_dpp v66, v31, v10 row_newbcast:13 row_mask:0xf bank_mask:0xc
    v_and_b32_dpp v67, v31, v11 row_newbcast:13 row_mask:0xf bank_mask:0xc
    v_and_b32_dpp v68, v31, v12 row_newbcast:13 row_mask:0xf bank_mask:0xc
    v_and_b32_dpp v69, v31, v13 row_newbcast:13 row_mask:0xf bank_mask:0xc
    s_nop 0
    s_nop 0
    v_mfma_f32_16x16x32_bf16 v[54:57], v[66:69], v[128:131], v[54:57]
    s_waitcnt vmcnt(6)
    s_xor_b32 s68, s69, 0x44200
    buffer_load_dwordx4 v[88:91], v1, s[8:11], s68 offen nt
    v_mfma_f32_16x16x32_bf16 v[58:61], v[66:69], v[132:135], v[58:61]
    s_waitcnt vmcnt(5)
    buffer_load_dwordx4 v[92:95], v1, s[8:11], s68 offen offset:256 nt
    s_mov_b32 s71, 143360
    buffer_load_dwordx4 a[168:171], v6, s[16:19], s71 offen
    v_and_b32_dpp v62, v23, v10 row_newbcast:2 row_mask:0xf bank_mask:0x3
    v_and_b32_dpp v63, v23, v11 row_newbcast:2 row_mask:0xf bank_mask:0x3
    v_and_b32_dpp v64, v23, v12 row_newbcast:2 row_mask:0xf bank_mask:0x3
    v_and_b32_dpp v65, v23, v13 row_newbcast:2 row_mask:0xf bank_mask:0x3
    v_and_b32_dpp v62, v31, v10 row_newbcast:2 row_mask:0xf bank_mask:0xc
    v_and_b32_dpp v63, v31, v11 row_newbcast:2 row_mask:0xf bank_mask:0xc
    v_and_b32_dpp v64, v31, v12 row_newbcast:2 row_mask:0xf bank_mask:0xc
    v_and_b32_dpp v65, v31, v13 row_newbcast:2 row_mask:0xf bank_mask:0xc
    s_nop 0
    s_nop 0
    v_mfma_f32_16x16x32_bf16 v[54:57], v[62:65], v[72:75], v[54:57]
    s_waitcnt vmcnt(6)
    s_xor_b32 s68, s69, 0x44a00
    buffer_load_dwordx4 v[96:99], v1, s[8:11], s68 offen nt
    v_mfma_f32_16x16x32_bf16 v[58:61], v[62:65], v[76:79], v[58:61]
    s_waitcnt vmcnt(6)
    buffer_load_dwordx4 v[100:103], v1, s[8:11], s68 offen offset:256 nt
    v_and_b32_dpp v66, v23, v10 row_newbcast:10 row_mask:0xf bank_mask:0x3
    v_and_b32_dpp v67, v23, v11 row_newbcast:10 row_mask:0xf bank_mask:0x3
    v_and_b32_dpp v68, v23, v12 row_newbcast:10 row_mask:0xf bank_mask:0x3
    v_and_b32_dpp v69, v23, v13 row_newbcast:10 row_mask:0xf bank_mask:0x3
    v_and_b32_dpp v66, v31, v10 row_newbcast:10 row_mask:0xf bank_mask:0xc
    v_and_b32_dpp v67, v31, v11 row_newbcast:10 row_mask:0xf bank_mask:0xc
    v_and_b32_dpp v68, v31, v12 row_newbcast:10 row_mask:0xf bank_mask:0xc
    v_and_b32_dpp v69, v31, v13 row_newbcast:10 row_mask:0xf bank_mask:0xc
    s_nop 0
    s_nop 0
    v_mfma_f32_16x16x32_bf16 v[54:57], v[66:69], v[80:83], v[54:57]
    s_waitcnt vmcnt(5)
    s_xor_b32 s68, s69, 0x4c000
    buffer_load_dwordx4 v[104:107], v1, s[8:11], s68 offen nt
    s_mov_b32 s71, 150528
    buffer_load_dwordx4 a[164:167], v4, s[16:19], s71 offen
    v_mfma_f32_16x16x32_bf16 v[58:61], v[66:69], v[84:87], v[58:61]
    s_waitcnt vmcnt(6)
    buffer_load_dwordx4 v[108:111], v1, s[8:11], s68 offen offset:256 nt
    v_and_b32_dpp v62, v23, v10 row_newbcast:6 row_mask:0xf bank_mask:0x3
    v_and_b32_dpp v63, v23, v11 row_newbcast:6 row_mask:0xf bank_mask:0x3
    v_and_b32_dpp v64, v23, v12 row_newbcast:6 row_mask:0xf bank_mask:0x3
    v_and_b32_dpp v65, v23, v13 row_newbcast:6 row_mask:0xf bank_mask:0x3
    v_and_b32_dpp v62, v31, v10 row_newbcast:6 row_mask:0xf bank_mask:0xc
    v_and_b32_dpp v63, v31, v11 row_newbcast:6 row_mask:0xf bank_mask:0xc
    v_and_b32_dpp v64, v31, v12 row_newbcast:6 row_mask:0xf bank_mask:0xc
    v_and_b32_dpp v65, v31, v13 row_newbcast:6 row_mask:0xf bank_mask:0xc
    s_nop 0
    s_nop 0
    v_mfma_f32_16x16x32_bf16 v[54:57], v[62:65], v[88:91], v[54:57]
    s_waitcnt vmcnt(6)
    s_xor_b32 s68, s69, 0x4c800
    buffer_load_dwordx4 v[112:115], v1, s[8:11], s68 offen nt
    v_mfma_f32_16x16x32_bf16 v[58:61], v[62:65], v[92:95], v[58:61]
    s_waitcnt vmcnt(5)
    buffer_load_dwordx4 v[116:119], v1, s[8:11], s68 offen offset:256 nt
    s_mov_b32 s71, 150528
    buffer_load_dwordx4 a[172:175], v6, s[16:19], s71 offen
    v_and_b32_dpp v66, v23, v10 row_newbcast:14 row_mask:0xf bank_mask:0x3
    v_and_b32_dpp v67, v23, v11 row_newbcast:14 row_mask:0xf bank_mask:0x3
    v_and_b32_dpp v68, v23, v12 row_newbcast:14 row_mask:0xf bank_mask:0x3
    v_and_b32_dpp v69, v23, v13 row_newbcast:14 row_mask:0xf bank_mask:0x3
    v_and_b32_dpp v66, v31, v10 row_newbcast:14 row_mask:0xf bank_mask:0xc
    v_and_b32_dpp v67, v31, v11 row_newbcast:14 row_mask:0xf bank_mask:0xc
    v_and_b32_dpp v68, v31, v12 row_newbcast:14 row_mask:0xf bank_mask:0xc
    v_and_b32_dpp v69, v31, v13 row_newbcast:14 row_mask:0xf bank_mask:0xc
    s_nop 0
    s_nop 0
    v_mfma_f32_16x16x32_bf16 v[54:57], v[66:69], v[96:99], v[54:57]
    s_waitcnt vmcnt(6)
    s_xor_b32 s68, s69, 0x4c200
    buffer_load_dwordx4 v[120:123], v1, s[8:11], s68 offen nt
    v_mfma_f32_16x16x32_bf16 v[58:61], v[66:69], v[100:103], v[58:61]
    s_xor_b32 s71, s63, 1
    s_lshl_b32 s71, s71, 7
    s_add_u32 s71, s71, 32768
    v_mov_b32 v14, 0
    buffer_load_dwordx4 v[44:47], v14, s[32:35], s71 offen sc1
    s_waitcnt vmcnt(7)
    buffer_load_dwordx4 v[124:127], v1, s[8:11], s68 offen offset:256 nt
    v_and_b32_dpp v62, v23, v10 row_newbcast:3 row_mask:0xf bank_mask:0x3
    v_and_b32_dpp v63, v23, v11 row_newbcast:3 row_mask:0xf bank_mask:0x3
    v_and_b32_dpp v64, v23, v12 row_newbcast:3 row_mask:0xf bank_mask:0x3
    v_and_b32_dpp v65, v23, v13 row_newbcast:3 row_mask:0xf bank_mask:0x3
    v_and_b32_dpp v62, v31, v10 row_newbcast:3 row_mask:0xf bank_mask:0xc
    v_and_b32_dpp v63, v31, v11 row_newbcast:3 row_mask:0xf bank_mask:0xc
    v_and_b32_dpp v64, v31, v12 row_newbcast:3 row_mask:0xf bank_mask:0xc
    v_and_b32_dpp v65, v31, v13 row_newbcast:3 row_mask:0xf bank_mask:0xc
    s_nop 0
    s_nop 0
    v_mfma_f32_16x16x32_bf16 v[54:57], v[62:65], v[104:107], v[54:57]
    s_waitcnt vmcnt(6)
    s_xor_b32 s68, s69, 0x4ca00
    buffer_load_dwordx4 v[128:131], v1, s[8:11], s68 offen nt
    s_mov_b32 s71, 157696
    buffer_load_dwordx4 a[176:179], v4, s[16:19], s71 offen
    v_mfma_f32_16x16x32_bf16 v[58:61], v[62:65], v[108:111], v[58:61]
    s_waitcnt vmcnt(7)
    buffer_load_dwordx4 v[132:135], v1, s[8:11], s68 offen offset:256 nt
    v_and_b32_dpp v66, v23, v10 row_newbcast:11 row_mask:0xf bank_mask:0x3
    v_and_b32_dpp v67, v23, v11 row_newbcast:11 row_mask:0xf bank_mask:0x3
    v_and_b32_dpp v68, v23, v12 row_newbcast:11 row_mask:0xf bank_mask:0x3
    v_and_b32_dpp v69, v23, v13 row_newbcast:11 row_mask:0xf bank_mask:0x3
    v_and_b32_dpp v66, v31, v10 row_newbcast:11 row_mask:0xf bank_mask:0xc
    v_and_b32_dpp v67, v31, v11 row_newbcast:11 row_mask:0xf bank_mask:0xc
    v_and_b32_dpp v68, v31, v12 row_newbcast:11 row_mask:0xf bank_mask:0xc
    v_and_b32_dpp v69, v31, v13 row_newbcast:11 row_mask:0xf bank_mask:0xc
    s_nop 0
    s_nop 0
    v_mfma_f32_16x16x32_bf16 v[54:57], v[66:69], v[112:115], v[54:57]
    s_waitcnt vmcnt(7)
    s_xor_b32 s68, s69, 0x20000
    buffer_load_dwordx4 v[72:75], v1, s[8:11], s68 offen nt
    v_mfma_f32_16x16x32_bf16 v[58:61], v[66:69], v[116:119], v[58:61]
    s_waitcnt vmcnt(6)
    buffer_load_dwordx4 v[76:79], v1, s[8:11], s68 offen offset:256 nt
    s_mov_b32 s71, 157696
    buffer_load_dwordx4 a[184:187], v6, s[16:19], s71 offen
    v_and_b32_dpp v62, v23, v10 row_newbcast:7 row_mask:0xf bank_mask:0x3
    v_and_b32_dpp v63, v23, v11 row_newbcast:7 row_mask:0xf bank_mask:0x3
    v_and_b32_dpp v64, v23, v12 row_newbcast:7 row_mask:0xf bank_mask:0x3
    v_and_b32_dpp v65, v23, v13 row_newbcast:7 row_mask:0xf bank_mask:0x3
    v_and_b32_dpp v62, v31, v10 row_newbcast:7 row_mask:0xf bank_mask:0xc
    v_and_b32_dpp v63, v31, v11 row_newbcast:7 row_mask:0xf bank_mask:0xc
    v_and_b32_dpp v64, v31, v12 row_newbcast:7 row_mask:0xf bank_mask:0xc
    v_and_b32_dpp v65, v31, v13 row_newbcast:7 row_mask:0xf bank_mask:0xc
    s_nop 0
    s_nop 0
    v_mfma_f32_16x16x32_bf16 v[54:57], v[62:65], v[120:123], v[54:57]
    s_waitcnt vmcnt(6)
    s_xor_b32 s68, s69, 0x20800
    buffer_load_dwordx4 v[80:83], v1, s[8:11], s68 offen nt
    v_mfma_f32_16x16x32_bf16 v[58:61], v[62:65], v[124:127], v[58:61]
    s_waitcnt vmcnt(6)
    buffer_load_dwordx4 v[84:87], v1, s[8:11], s68 offen offset:256 nt
    v_and_b32_dpp v66, v23, v10 row_newbcast:15 row_mask:0xf bank_mask:0x3
    v_and_b32_dpp v67, v23, v11 row_newbcast:15 row_mask:0xf bank_mask:0x3
    v_and_b32_dpp v68, v23, v12 row_newbcast:15 row_mask:0xf bank_mask:0x3
    v_and_b32_dpp v69, v23, v13 row_newbcast:15 row_mask:0xf bank_mask:0x3
    v_and_b32_dpp v66, v31, v10 row_newbcast:15 row_mask:0xf bank_mask:0xc
    v_and_b32_dpp v67, v31, v11 row_newbcast:15 row_mask:0xf bank_mask:0xc
    v_and_b32_dpp v68, v31, v12 row_newbcast:15 row_mask:0xf bank_mask:0xc
    v_and_b32_dpp v69, v31, v13 row_newbcast:15 row_mask:0xf bank_mask:0xc
    s_nop 0
    s_nop 0
    v_mfma_f32_16x16x32_bf16 v[54:57], v[66:69], v[128:131], v[54:57]
    s_waitcnt vmcnt(5)
    s_xor_b32 s68, s69, 0x20200
    buffer_load_dwordx4 v[88:91], v1, s[8:11], s68 offen nt
    s_mov_b32 s71, 164864
    buffer_load_dwordx4 a[180:183], v4, s[16:19], s71 offen
    v_mfma_f32_16x16x32_bf16 v[58:61], v[66:69], v[132:135], v[58:61]
    s_waitcnt vmcnt(6)
    buffer_load_dwordx4 v[92:95], v1, s[8:11], s68 offen offset:256 nt
    v_and_b32_dpp v62, v24, v10 row_newbcast:0 row_mask:0xf bank_mask:0x3
    v_and_b32_dpp v63, v24, v11 row_newbcast:0 row_mask:0xf bank_mask:0x3
    v_and_b32_dpp v64, v24, v12 row_newbcast:0 row_mask:0xf bank_mask:0x3
    v_and_b32_dpp v65, v24, v13 row_newbcast:0 row_mask:0xf bank_mask:0x3
    v_and_b32_dpp v62, v32, v10 row_newbcast:0 row_mask:0xf bank_mask:0xc
    v_and_b32_dpp v63, v32, v11 row_newbcast:0 row_mask:0xf bank_mask:0xc
    v_and_b32_dpp v64, v32, v12 row_newbcast:0 row_mask:0xf bank_mask:0xc
    v_and_b32_dpp v65, v32, v13 row_newbcast:0 row_mask:0xf bank_mask:0xc
    s_nop 0
    s_nop 0
    v_mfma_f32_16x16x32_bf16 v[54:57], v[62:65], v[72:75], v[54:57]
    s_waitcnt vmcnt(6)
    s_xor_b32 s68, s69, 0x20a00
    buffer_load_dwordx4 v[96:99], v1, s[8:11], s68 offen nt
    v_mfma_f32_16x16x32_bf16 v[58:61], v[62:65], v[76:79], v[58:61]
    s_waitcnt vmcnt(5)
    buffer_load_dwordx4 v[100:103], v1, s[8:11], s68 offen offset:256 nt
    s_mov_b32 s71, 164864
    buffer_load_dwordx4 a[188:191], v6, s[16:19], s71 offen
    v_and_b32_dpp v66, v24, v10 row_newbcast:8 row_mask:0xf bank_mask:0x3
    v_and_b32_dpp v67, v24, v11 row_newbcast:8 row_mask:0xf bank_mask:0x3
    v_and_b32_dpp v68, v24, v12 row_newbcast:8 row_mask:0xf bank_mask:0x3
    v_and_b32_dpp v69, v24, v13 row_newbcast:8 row_mask:0xf bank_mask:0x3
    v_and_b32_dpp v66, v32, v10 row_newbcast:8 row_mask:0xf bank_mask:0xc
    v_and_b32_dpp v67, v32, v11 row_newbcast:8 row_mask:0xf bank_mask:0xc
    v_and_b32_dpp v68, v32, v12 row_newbcast:8 row_mask:0xf bank_mask:0xc
    v_and_b32_dpp v69, v32, v13 row_newbcast:8 row_mask:0xf bank_mask:0xc
    s_nop 0
    s_nop 0
    v_mfma_f32_16x16x32_bf16 v[54:57], v[66:69], v[80:83], v[54:57]
    s_waitcnt vmcnt(6)
    s_xor_b32 s68, s69, 0x28000
    buffer_load_dwordx4 v[104:107], v1, s[8:11], s68 offen nt
    v_mfma_f32_16x16x32_bf16 v[58:61], v[66:69], v[84:87], v[58:61]
    s_waitcnt vmcnt(6)
    buffer_load_dwordx4 v[108:111], v1, s[8:11], s68 offen offset:256 nt
    v_and_b32_dpp v62, v24, v10 row_newbcast:4 row_mask:0xf bank_mask:0x3
    v_and_b32_dpp v63, v24, v11 row_newbcast:4 row_mask:0xf bank_mask:0x3
    v_and_b32_dpp v64, v24, v12 row_newbcast:4 row_mask:0xf bank_mask:0x3
    v_and_b32_dpp v65, v24, v13 row_newbcast:4 row_mask:0xf bank_mask:0x3
    v_and_b32_dpp v62, v32, v10 row_newbcast:4 row_mask:0xf bank_mask:0xc
    v_and_b32_dpp v63, v32, v11 row_newbcast:4 row_mask:0xf bank_mask:0xc
    v_and_b32_dpp v64, v32, v12 row_newbcast:4 row_mask:0xf bank_mask:0xc
    v_and_b32_dpp v65, v32, v13 row_newbcast:4 row_mask:0xf bank_mask:0xc
    s_nop 0
    s_nop 0
    v_mfma_f32_16x16x32_bf16 v[54:57], v[62:65], v[88:91], v[54:57]
    s_waitcnt vmcnt(5)
    s_xor_b32 s68, s69, 0x28800
    buffer_load_dwordx4 v[112:115], v1, s[8:11], s68 offen nt
    s_mov_b32 s71, 172032
    buffer_load_dwordx4 a[192:195], v4, s[16:19], s71 offen
    v_mfma_f32_16x16x32_bf16 v[58:61], v[62:65], v[92:95], v[58:61]
    s_waitcnt vmcnt(6)
    buffer_load_dwordx4 v[116:119], v1, s[8:11], s68 offen offset:256 nt
    v_and_b32_dpp v66, v24, v10 row_newbcast:12 row_mask:0xf bank_mask:0x3
    v_and_b32_dpp v67, v24, v11 row_newbcast:12 row_mask:0xf bank_mask:0x3
    v_and_b32_dpp v68, v24, v12 row_newbcast:12 row_mask:0xf bank_mask:0x3
    v_and_b32_dpp v69, v24, v13 row_newbcast:12 row_mask:0xf bank_mask:0x3
    v_and_b32_dpp v66, v32, v10 row_newbcast:12 row_mask:0xf bank_mask:0xc
    v_and_b32_dpp v67, v32, v11 row_newbcast:12 row_mask:0xf bank_mask:0xc
    v_and_b32_dpp v68, v32, v12 row_newbcast:12 row_mask:0xf bank_mask:0xc
    v_and_b32_dpp v69, v32, v13 row_newbcast:12 row_mask:0xf bank_mask:0xc
    s_nop 0
    s_nop 0
    v_mfma_f32_16x16x32_bf16 v[54:57], v[66:69], v[96:99], v[54:57]
    s_waitcnt vmcnt(6)
    s_xor_b32 s68, s69, 0x28200
    buffer_load_dwordx4 v[120:123], v1, s[8:11], s68 offen nt
    v_mfma_f32_16x16x32_bf16 v[58:61], v[66:69], v[100:103], v[58:61]
    s_waitcnt vmcnt(5)
    buffer_load_dwordx4 v[124:127], v1, s[8:11], s68 offen offset:256 nt
    s_mov_b32 s71, 172032
    buffer_load_dwordx4 a[200:203], v6, s[16:19], s71 offen
    v_and_b32_dpp v62, v24, v10 row_newbcast:1 row_mask:0xf bank_mask:0x3
    v_and_b32_dpp v63, v24, v11 row_newbcast:1 row_mask:0xf bank_mask:0x3
    v_and_b32_dpp v64, v24, v12 row_newbcast:1 row_mask:0xf bank_mask:0x3
    v_and_b32_dpp v65, v24, v13 row_newbcast:1 row_mask:0xf bank_mask:0x3
    v_and_b32_dpp v62, v32, v10 row_newbcast:1 row_mask:0xf bank_mask:0xc
    v_and_b32_dpp v63, v32, v11 row_newbcast:1 row_mask:0xf bank_mask:0xc
    v_and_b32_dpp v64, v32, v12 row_newbcast:1 row_mask:0xf bank_mask:0xc
    v_and_b32_dpp v65, v32, v13 row_newbcast:1 row_mask:0xf bank_mask:0xc
    s_nop 0
    s_nop 0
    v_mfma_f32_16x16x32_bf16 v[54:57], v[62:65], v[104:107], v[54:57]
    s_waitcnt vmcnt(6)
    s_xor_b32 s68, s69, 0x28a00
    buffer_load_dwordx4 v[128:131], v1, s[8:11], s68 offen nt
    v_mfma_f32_16x16x32_bf16 v[58:61], v[62:65], v[108:111], v[58:61]
    s_waitcnt vmcnt(6)
    buffer_load_dwordx4 v[132:135], v1, s[8:11], s68 offen offset:256 nt
    v_and_b32_dpp v66, v24, v10 row_newbcast:9 row_mask:0xf bank_mask:0x3
    v_and_b32_dpp v67, v24, v11 row_newbcast:9 row_mask:0xf bank_mask:0x3
    v_and_b32_dpp v68, v24, v12 row_newbcast:9 row_mask:0xf bank_mask:0x3
    v_and_b32_dpp v69, v24, v13 row_newbcast:9 row_mask:0xf bank_mask:0x3
    v_and_b32_dpp v66, v32, v10 row_newbcast:9 row_mask:0xf bank_mask:0xc
    v_and_b32_dpp v67, v32, v11 row_newbcast:9 row_mask:0xf bank_mask:0xc
    v_and_b32_dpp v68, v32, v12 row_newbcast:9 row_mask:0xf bank_mask:0xc
    v_and_b32_dpp v69, v32, v13 row_newbcast:9 row_mask:0xf bank_mask:0xc
    s_nop 0
    s_nop 0
    v_mfma_f32_16x16x32_bf16 v[54:57], v[66:69], v[112:115], v[54:57]
    s_waitcnt vmcnt(5)
    s_xor_b32 s68, s69, 0x60000
    buffer_load_dwordx4 v[72:75], v1, s[8:11], s68 offen nt
    s_mov_b32 s71, 179200
    buffer_load_dwordx4 a[196:199], v4, s[16:19], s71 offen
    v_mfma_f32_16x16x32_bf16 v[58:61], v[66:69], v[116:119], v[58:61]
    s_waitcnt vmcnt(6)
    buffer_load_dwordx4 v[76:79], v1, s[8:11], s68 offen offset:256 nt
    v_and_b32_dpp v62, v24, v10 row_newbcast:5 row_mask:0xf bank_mask:0x3
    v_and_b32_dpp v63, v24, v11 row_newbcast:5 row_mask:0xf bank_mask:0x3
    v_and_b32_dpp v64, v24, v12 row_newbcast:5 row_mask:0xf bank_mask:0x3
    v_and_b32_dpp v65, v24, v13 row_newbcast:5 row_mask:0xf bank_mask:0x3
    v_and_b32_dpp v62, v32, v10 row_newbcast:5 row_mask:0xf bank_mask:0xc
    v_and_b32_dpp v63, v32, v11 row_newbcast:5 row_mask:0xf bank_mask:0xc
    v_and_b32_dpp v64, v32, v12 row_newbcast:5 row_mask:0xf bank_mask:0xc
    v_and_b32_dpp v65, v32, v13 row_newbcast:5 row_mask:0xf bank_mask:0xc
    s_nop 0
    s_nop 0
    v_mfma_f32_16x16x32_bf16 v[54:57], v[62:65], v[120:123], v[54:57]
    s_waitcnt vmcnt(6)
    s_xor_b32 s68, s69, 0x60800
    buffer_load_dwordx4 v[80:83], v1, s[8:11], s68 offen nt
    v_mfma_f32_16x16x32_bf16 v[58:61], v[62:65], v[124:127], v[58:61]
    s_waitcnt vmcnt(5)
    buffer_load_dwordx4 v[84:87], v1, s[8:11], s68 offen offset:256 nt
    s_mov_b32 s71, 179200
    buffer_load_dwordx4 a[204:207], v6, s[16:19], s71 offen
    v_and_b32_dpp v66, v24, v10 row_newbcast:13 row_mask:0xf bank_mask:0x3
    v_and_b32_dpp v67, v24, v11 row_newbcast:13 row_mask:0xf bank_mask:0x3
    v_and_b32_dpp v68, v24, v12 row_newbcast:13 row_mask:0xf bank_mask:0x3
    v_and_b32_dpp v69, v24, v13 row_newbcast:13 row_mask:0xf bank_mask:0x3
    v_and_b32_dpp v66, v32, v10 row_newbcast:13 row_mask:0xf bank_mask:0xc
    v_and_b32_dpp v67, v32, v11 row_newbcast:13 row_mask:0xf bank_mask:0xc
    v_and_b32_dpp v68, v32, v12 row_newbcast:13 row_mask:0xf bank_mask:0xc
    v_and_b32_dpp v69, v32, v13 row_newbcast:13 row_mask:0xf bank_mask:0xc
    s_nop 0
    s_nop 0
    v_mfma_f32_16x16x32_bf16 v[54:57], v[66:69], v[128:131], v[54:57]
    s_waitcnt vmcnt(6)
    s_xor_b32 s68, s69, 0x60200
    buffer_load_dwordx4 v[88:91], v1, s[8:11], s68 offen nt
    v_mfma_f32_16x16x32_bf16 v[58:61], v[66:69], v[132:135], v[58:61]
    s_waitcnt vmcnt(6)
    buffer_load_dwordx4 v[92:95], v1, s[8:11], s68 offen offset:256 nt
    v_and_b32_dpp v62, v24, v10 row_newbcast:2 row_mask:0xf bank_mask:0x3
    v_and_b32_dpp v63, v24, v11 row_newbcast:2 row_mask:0xf bank_mask:0x3
    v_and_b32_dpp v64, v24, v12 row_newbcast:2 row_mask:0xf bank_mask:0x3
    v_and_b32_dpp v65, v24, v13 row_newbcast:2 row_mask:0xf bank_mask:0x3
    v_and_b32_dpp v62, v32, v10 row_newbcast:2 row_mask:0xf bank_mask:0xc
    v_and_b32_dpp v63, v32, v11 row_newbcast:2 row_mask:0xf bank_mask:0xc
    v_and_b32_dpp v64, v32, v12 row_newbcast:2 row_mask:0xf bank_mask:0xc
    v_and_b32_dpp v65, v32, v13 row_newbcast:2 row_mask:0xf bank_mask:0xc
    s_nop 0
    s_nop 0
    v_mfma_f32_16x16x32_bf16 v[54:57], v[62:65], v[72:75], v[54:57]
    s_waitcnt vmcnt(5)
    s_xor_b32 s68, s69, 0x60a00
    buffer_load_dwordx4 v[96:99], v1, s[8:11], s68 offen nt
    s_mov_b32 s71, 186368
    buffer_load_dwordx4 a[208:211], v4, s[16:19], s71 offen
    v_mfma_f32_16x16x32_bf16 v[58:61], v[62:65], v[76:79], v[58:61]
    s_waitcnt vmcnt(6)
    buffer_load_dwordx4 v[100:103], v1, s[8:11], s68 offen offset:256 nt
    v_and_b32_dpp v66, v24, v10 row_newbcast:10 row_mask:0xf bank_mask:0x3
    v_and_b32_dpp v67, v24, v11 row_newbcast:10 row_mask:0xf bank_mask:0x3
    v_and_b32_dpp v68, v24, v12 row_newbcast:10 row_mask:0xf bank_mask:0x3
    v_and_b32_dpp v69, v24, v13 row_newbcast:10 row_mask:0xf bank_mask:0x3
    v_and_b32_dpp v66, v32, v10 row_newbcast:10 row_mask:0xf bank_mask:0xc
    v_and_b32_dpp v67, v32, v11 row_newbcast:10 row_mask:0xf bank_mask:0xc
    v_and_b32_dpp v68, v32, v12 row_newbcast:10 row_mask:0xf bank_mask:0xc
    v_and_b32_dpp v69, v32, v13 row_newbcast:10 row_mask:0xf bank_mask:0xc
    s_nop 0
    s_nop 0
    v_mfma_f32_16x16x32_bf16 v[54:57], v[66:69], v[80:83], v[54:57]
    s_waitcnt vmcnt(6)
    s_xor_b32 s68, s69, 0x68000
    buffer_load_dwordx4 v[104:107], v1, s[8:11], s68 offen nt
    v_mfma_f32_16x16x32_bf16 v[58:61], v[66:69], v[84:87], v[58:61]
    s_mov_b32 s90, 0
L_xchk:
    v_xor_b32 v15, v44, v43
    v_bitop3_b32 v15, v15, v45, v43 bitop3:0xf6
    v_and_b32 v15, 0xff, v15
    v_xor_b32 v16, s74, v46
    v_xor_b32 v17, s74, v47
    v_or3_b32 v15, v15, v16, v17
    v_cmp_ne_u32 vcc, 0, v15
    s_cbranch_vccz L_xok
    s_add_u32 s90, s90, 1
    s_cmp_ge_u32 s90, 0x40000
    s_cbranch_scc1 L_xok
    s_xor_b32 s71, s63, 1
    s_lshl_b32 s71, s71, 7
    s_add_u32 s71, s71, 32768
    v_mov_b32 v14, 0
    buffer_load_dwordx4 v[44:47], v14, s[32:35], s71 offen sc1
    s_waitcnt vmcnt(0)
    s_branch L_xchk
L_xok:
    v_and_b32 v44, s77, v44
    v_and_b32 v45, s77, v45
    v_max_f32 v15, v44, v40
    v_sub_f32 v44, v44, v15
    v_sub_f32 v40, v40, v15
    v_mul_f32 v44, s75, v44
    v_mul_f32 v40, s75, v40
    v_exp_f32 v44, v44
    v_exp_f32 v40, v40
    s_nop 0
    v_mul_f32 v44, v44, v45
    v_mul_f32 v41, v40, v41
    v_add_f32 v41, v41, v44
    v_rcp_f32 v41, v41
    s_nop 0
    v_mul_f32 v40, v40, v41
    v_mul_f32 v38, v38, v40
    v_mul_f32 v39, v39, v40
    v_mul_f32 v50, v50, v40
    v_mul_f32 v51, v51, v40
    s_waitcnt vmcnt(5)
    buffer_load_dwordx4 v[108:111], v1, s[8:11], s68 offen offset:256 nt
    s_mov_b32 s71, 186368
    buffer_load_dwordx4 a[216:219], v6, s[16:19], s71 offen
    v_and_b32_dpp v62, v24, v10 row_newbcast:6 row_mask:0xf bank_mask:0x3
    v_and_b32_dpp v63, v24, v11 row_newbcast:6 row_mask:0xf bank_mask:0x3
    v_and_b32_dpp v64, v24, v12 row_newbcast:6 row_mask:0xf bank_mask:0x3
    v_and_b32_dpp v65, v24, v13 row_newbcast:6 row_mask:0xf bank_mask:0x3
    v_and_b32_dpp v62, v32, v10 row_newbcast:6 row_mask:0xf bank_mask:0xc
    v_and_b32_dpp v63, v32, v11 row_newbcast:6 row_mask:0xf bank_mask:0xc
    v_and_b32_dpp v64, v32, v12 row_newbcast:6 row_mask:0xf bank_mask:0xc
    v_and_b32_dpp v65, v32, v13 row_newbcast:6 row_mask:0xf bank_mask:0xc
    s_nop 0
    s_nop 0
    v_mfma_f32_16x16x32_bf16 v[54:57], v[62:65], v[88:91], v[54:57]
    s_waitcnt vmcnt(6)
    s_xor_b32 s68, s69, 0x68800
    buffer_load_dwordx4 v[112:115], v1, s[8:11], s68 offen nt
    v_mfma_f32_16x16x32_bf16 v[58:61], v[62:65], v[92:95], v[58:61]
    s_waitcnt vmcnt(6)
    buffer_load_dwordx4 v[116:119], v1, s[8:11], s68 offen offset:256 nt
    v_and_b32_dpp v66, v24, v10 row_newbcast:14 row_mask:0xf bank_mask:0x3
    v_and_b32_dpp v67, v24, v11 row_newbcast:14 row_mask:0xf bank_mask:0x3
    v_and_b32_dpp v68, v24, v12 row_newbcast:14 row_mask:0xf bank_mask:0x3
    v_and_b32_dpp v69, v24, v13 row_newbcast:14 row_mask:0xf bank_mask:0x3
    v_and_b32_dpp v66, v32, v10 row_newbcast:14 row_mask:0xf bank_mask:0xc
    v_and_b32_dpp v67, v32, v11 row_newbcast:14 row_mask:0xf bank_mask:0xc
    v_and_b32_dpp v68, v32, v12 row_newbcast:14 row_mask:0xf bank_mask:0xc
    v_and_b32_dpp v69, v32, v13 row_newbcast:14 row_mask:0xf bank_mask:0xc
    s_nop 0
    s_nop 0
    v_mfma_f32_16x16x32_bf16 v[54:57], v[66:69], v[96:99], v[54:57]
    s_waitcnt vmcnt(5)
    s_xor_b32 s68, s69, 0x68200
    buffer_load_dwordx4 v[120:123], v1, s[8:11], s68 offen nt
    s_mov_b32 s71, 193536
    buffer_load_dwordx4 a[212:215], v4, s[16:19], s71 offen
    v_mfma_f32_16x16x32_bf16 v[58:61], v[66:69], v[100:103], v[58:61]
    s_waitcnt vmcnt(6)
    buffer_load_dwordx4 v[124:127], v1, s[8:11], s68 offen offset:256 nt
    v_and_b32_dpp v62, v24, v10 row_newbcast:3 row_mask:0xf bank_mask:0x3
    v_and_b32_dpp v63, v24, v11 row_newbcast:3 row_mask:0xf bank_mask:0x3
    v_and_b32_dpp v64, v24, v12 row_newbcast:3 row_mask:0xf bank_mask:0x3
    v_and_b32_dpp v65, v24, v13 row_newbcast:3 row_mask:0xf bank_mask:0x3
    v_and_b32_dpp v62, v32, v10 row_newbcast:3 row_mask:0xf bank_mask:0xc
    v_and_b32_dpp v63, v32, v11 row_newbcast:3 row_mask:0xf bank_mask:0xc
    v_and_b32_dpp v64, v32, v12 row_newbcast:3 row_mask:0xf bank_mask:0xc
    v_and_b32_dpp v65, v32, v13 row_newbcast:3 row_mask:0xf bank_mask:0xc
    s_nop 0
    s_nop 0
    v_mfma_f32_16x16x32_bf16 v[54:57], v[62:65], v[104:107], v[54:57]
    s_waitcnt vmcnt(6)
    s_xor_b32 s68, s69, 0x68a00
    buffer_load_dwordx4 v[128:131], v1, s[8:11], s68 offen nt
    v_mfma_f32_16x16x32_bf16 v[58:61], v[62:65], v[108:111], v[58:61]
    s_waitcnt vmcnt(5)
    buffer_load_dwordx4 v[132:135], v1, s[8:11], s68 offen offset:256 nt
    s_mov_b32 s71, 193536
    buffer_load_dwordx4 a[220:223], v6, s[16:19], s71 offen
    v_and_b32_dpp v66, v24, v10 row_newbcast:11 row_mask:0xf bank_mask:0x3
    v_and_b32_dpp v67, v24, v11 row_newbcast:11 row_mask:0xf bank_mask:0x3
    v_and_b32_dpp v68, v24, v12 row_newbcast:11 row_mask:0xf bank_mask:0x3
    v_and_b32_dpp v69, v24, v13 row_newbcast:11 row_mask:0xf bank_mask:0x3
    v_and_b32_dpp v66, v32, v10 row_newbcast:11 row_mask:0xf bank_mask:0xc
    v_and_b32_dpp v67, v32, v11 row_newbcast:11 row_mask:0xf bank_mask:0xc
    v_and_b32_dpp v68, v32, v12 row_newbcast:11 row_mask:0xf bank_mask:0xc
    v_and_b32_dpp v69, v32, v13 row_newbcast:11 row_mask:0xf bank_mask:0xc
    s_nop 0
    s_nop 0
    v_mfma_f32_16x16x32_bf16 v[54:57], v[66:69], v[112:115], v[54:57]
    s_waitcnt vmcnt(6)
    s_xor_b32 s68, s69, 0x24000
    buffer_load_dwordx4 v[72:75], v1, s[8:11], s68 offen nt
    v_mfma_f32_16x16x32_bf16 v[58:61], v[66:69], v[116:119], v[58:61]
    s_waitcnt vmcnt(6)
    buffer_load_dwordx4 v[76:79], v1, s[8:11], s68 offen offset:256 nt
    v_and_b32_dpp v62, v24, v10 row_newbcast:7 row_mask:0xf bank_mask:0x3
    v_and_b32_dpp v63, v24, v11 row_newbcast:7 row_mask:0xf bank_mask:0x3
    v_and_b32_dpp v64, v24, v12 row_newbcast:7 row_mask:0xf bank_mask:0x3
    v_and_b32_dpp v65, v24, v13 row_newbcast:7 row_mask:0xf bank_mask:0x3
    v_and_b32_dpp v62, v32, v10 row_newbcast:7 row_mask:0xf bank_mask:0xc
    v_and_b32_dpp v63, v32, v11 row_newbcast:7 row_mask:0xf bank_mask:0xc
    v_and_b32_dpp v64, v32, v12 row_newbcast:7 row_mask:0xf bank_mask:0xc
    v_and_b32_dpp v65, v32, v13 row_newbcast:7 row_mask:0xf bank_mask:0xc
    s_nop 0
    s_nop 0
    v_mfma_f32_16x16x32_bf16 v[54:57], v[62:65], v[120:123], v[54:57]
    s_waitcnt vmcnt(5)
    s_xor_b32 s68, s69, 0x24800
    buffer_load_dwordx4 v[80:83], v1, s[8:11], s68 offen nt
    s_mov_b32 s71, 200704
    buffer_load_dwordx4 a[224:227], v4, s[16:19], s71 offen
    v_mfma_f32_16x16x32_bf16 v[58:61], v[62:65], v[124:127], v[58:61]
    s_waitcnt vmcnt(6)
    buffer_load_dwordx4 v[84:87], v1, s[8:11], s68 offen offset:256 nt
    v_and_b32_dpp v66, v24, v10 row_newbcast:15 row_mask:0xf bank_mask:0x3
    v_and_b32_dpp v67, v24, v11 row_newbcast:15 row_mask:0xf bank_mask:0x3
    v_and_b32_dpp v68, v24, v12 row_newbcast:15 row_mask:0xf bank_mask:0x3
    v_and_b32_dpp v69, v24, v13 row_newbcast:15 row_mask:0xf bank_mask:0x3
    v_and_b32_dpp v66, v32, v10 row_newbcast:15 row_mask:0xf bank_mask:0xc
    v_and_b32_dpp v67, v32, v11 row_newbcast:15 row_mask:0xf bank_mask:0xc
    v_and_b32_dpp v68, v32, v12 row_newbcast:15 row_mask:0xf bank_mask:0xc
    v_and_b32_dpp v69, v32, v13 row_newbcast:15 row_mask:0xf bank_mask:0xc
    s_nop 0
    s_nop 0
    v_mfma_f32_16x16x32_bf16 v[54:57], v[66:69], v[128:131], v[54:57]
    s_waitcnt vmcnt(6)
    s_xor_b32 s68, s69, 0x24200
    buffer_load_dwordx4 v[88:91], v1, s[8:11], s68 offen nt
    v_mfma_f32_16x16x32_bf16 v[58:61], v[66:69], v[132:135], v[58:61]
    s_waitcnt vmcnt(5)
    buffer_load_dwordx4 v[92:95], v1, s[8:11], s68 offen offset:256 nt
    s_mov_b32 s71, 200704
    buffer_load_dwordx4 a[232:235], v6, s[16:19], s71 offen
    v_and_b32_dpp v62, v25, v10 row_newbcast:0 row_mask:0xf bank_mask:0x3
    v_and_b32_dpp v63, v25, v11 row_newbcast:0 row_mask:0xf bank_mask:0x3
    v_and_b32_dpp v64, v25, v12 row_newbcast:0 row_mask:0xf bank_mask:0x3
    v_and_b32_dpp v65, v25, v13 row_newbcast:0 row_mask:0xf bank_mask:0x3
    v_and_b32_dpp v62, v33, v10 row_newbcast:0 row_mask:0xf bank_mask:0xc
    v_and_b32_dpp v63, v33, v11 row_newbcast:0 row_mask:0xf bank_mask:0xc
    v_and_b32_dpp v64, v33, v12 row_newbcast:0 row_mask:0xf bank_mask:0xc
    v_and_b32_dpp v65, v33, v13 row_newbcast:0 row_mask:0xf bank_mask:0xc
    s_nop 0
    s_nop 0
    v_mfma_f32_16x16x32_bf16 v[54:57], v[62:65], v[72:75], v[54:57]
    s_waitcnt vmcnt(6)
    s_xor_b32 s68, s69, 0x24a00
    buffer_load_dwordx4 v[96:99], v1, s[8:11], s68 offen nt
    v_mfma_f32_16x16x32_bf16 v[58:61], v[62:65], v[76:79], v[58:61]
    s_waitcnt vmcnt(6)
    buffer_load_dwordx4 v[100:103], v1, s[8:11], s68 offen offset:256 nt
    v_and_b32_dpp v66, v25, v10 row_newbcast:8 row_mask:0xf bank_mask:0x3
    v_and_b32_dpp v67, v25, v11 row_newbcast:8 row_mask:0xf bank_mask:0x3
    v_and_b32_dpp v68, v25, v12 row_newbcast:8 row_mask:0xf bank_mask:0x3
    v_and_b32_dpp v69, v25, v13 row_newbcast:8 row_mask:0xf bank_mask:0x3
    v_and_b32_dpp v66, v33, v10 row_newbcast:8 row_mask:0xf bank_mask:0xc
    v_and_b32_dpp v67, v33, v11 row_newbcast:8 row_mask:0xf bank_mask:0xc
    v_and_b32_dpp v68, v33, v12 row_newbcast:8 row_mask:0xf bank_mask:0xc
    v_and_b32_dpp v69, v33, v13 row_newbcast:8 row_mask:0xf bank_mask:0xc
    s_nop 0
    s_nop 0
    v_mfma_f32_16x16x32_bf16 v[54:57], v[66:69], v[80:83], v[54:57]
    s_waitcnt vmcnt(5)
    s_xor_b32 s68, s69, 0x2c000
    buffer_load_dwordx4 v[104:107], v1, s[8:11], s68 offen nt
    s_mov_b32 s71, 207872
    buffer_load_dwordx4 a[228:231], v4, s[16:19], s71 offen
    v_mfma_f32_16x16x32_bf16 v[58:61], v[66:69], v[84:87], v[58:61]
    s_movk_i32 s81, 0x7fff
    s_movk_i32 s80, 0x7fff
    s_cmp_lg_u32 s62, 0
    s_cbranch_scc1 L_nork10
    s_lshl_b32 s71, s65, 12
    s_add_u32 s71, s71, 589824
    s_mov_b32 s82, 1
    s_atomic_add s82, s[60:61], s71 glc
L_nork10:
    s_waitcnt vmcnt(6)
    buffer_load_dwordx4 v[108:111], v1, s[8:11], s68 offen offset:256 nt
    v_and_b32_dpp v62, v25, v10 row_newbcast:4 row_mask:0xf bank_mask:0x3
    v_and_b32_dpp v63, v25, v11 row_newbcast:4 row_mask:0xf bank_mask:0x3
    v_and_b32_dpp v64, v25, v12 row_newbcast:4 row_mask:0xf bank_mask:0x3
    v_and_b32_dpp v65, v25, v13 row_newbcast:4 row_mask:0xf bank_mask:0x3
    v_and_b32_dpp v62, v33, v10 row_newbcast:4 row_mask:0xf bank_mask:0xc
    v_and_b32_dpp v63, v33, v11 row_newbcast:4 row_mask:0xf bank_mask:0xc
    v_and_b32_dpp v64, v33, v12 row_newbcast:4 row_mask:0xf bank_mask:0xc
    v_and_b32_dpp v65, v33, v13 row_newbcast:4 row_mask:0xf bank_mask:0xc
    s_nop 0
    s_nop 0
    v_mfma_f32_16x16x32_bf16 v[54:57], v[62:65], v[88:91], v[54:57]
    s_waitcnt vmcnt(6)
    s_xor_b32 s68, s69, 0x2c800
    buffer_load_dwordx4 v[112:115], v1, s[8:11], s68 offen nt
    v_mfma_f32_16x16x32_bf16 v[58:61], v[62:65], v[92:95], v[58:61]
    s_waitcnt vmcnt(5)
    buffer_load_dwordx4 v[116:119], v1, s[8:11], s68 offen offset:256 nt
    s_mov_b32 s71, 207872
    buffer_load_dwordx4 a[236:239], v6, s[16:19], s71 offen
    v_and_b32_dpp v66, v25, v10 row_newbcast:12 row_mask:0xf bank_mask:0x3
    v_and_b32_dpp v67, v25, v11 row_newbcast:12 row_mask:0xf bank_mask:0x3
    v_and_b32_dpp v68, v25, v12 row_newbcast:12 row_mask:0xf bank_mask:0x3
    v_and_b32_dpp v69, v25, v13 row_newbcast:12 row_mask:0xf bank_mask:0x3
    v_and_b32_dpp v66, v33, v10 row_newbcast:12 row_mask:0xf bank_mask:0xc
    v_and_b32_dpp v67, v33, v11 row_newbcast:12 row_mask:0xf bank_mask:0xc
    v_and_b32_dpp v68, v33, v12 row_newbcast:12 row_mask:0xf bank_mask:0xc
    v_and_b32_dpp v69, v33, v13 row_newbcast:12 row_mask:0xf bank_mask:0xc
    s_nop 0
    s_nop 0
    v_mfma_f32_16x16x32_bf16 v[54:57], v[66:69], v[96:99], v[54:57]
    s_waitcnt vmcnt(6)
    s_xor_b32 s68, s69, 0x2c200
    buffer_load_dwordx4 v[120:123], v1, s[8:11], s68 offen nt
    v_mfma_f32_16x16x32_bf16 v[58:61], v[66:69], v[100:103], v[58:61]
    s_waitcnt vmcnt(6)
    buffer_load_dwordx4 v[124:127], v1, s[8:11], s68 offen offset:256 nt
    v_and_b32_dpp v62, v25, v10 row_newbcast:1 row_mask:0xf bank_mask:0x3
    v_and_b32_dpp v63, v25, v11 row_newbcast:1 row_mask:0xf bank_mask:0x3
    v_and_b32_dpp v64, v25, v12 row_newbcast:1 row_mask:0xf bank_mask:0x3
    v_and_b32_dpp v65, v25, v13 row_newbcast:1 row_mask:0xf bank_mask:0x3
    v_and_b32_dpp v62, v33, v10 row_newbcast:1 row_mask:0xf bank_mask:0xc
    v_and_b32_dpp v63, v33, v11 row_newbcast:1 row_mask:0xf bank_mask:0xc
    v_and_b32_dpp v64, v33, v12 row_newbcast:1 row_mask:0xf bank_mask:0xc
    v_and_b32_dpp v65, v33, v13 row_newbcast:1 row_mask:0xf bank_mask:0xc
    s_nop 0
    s_nop 0
    v_mfma_f32_16x16x32_bf16 v[54:57], v[62:65], v[104:107], v[54:57]
    s_waitcnt vmcnt(5)
    s_xor_b32 s68, s69, 0x2ca00
    buffer_load_dwordx4 v[128:131], v1, s[8:11], s68 offen nt
    s_mov_b32 s71, 215040
    buffer_load_dwordx4 a[240:243], v4, s[16:19], s71 offen
    v_mfma_f32_16x16x32_bf16 v[58:61], v[62:65], v[108:111], v[58:61]
    s_waitcnt vmcnt(6)
    buffer_load_dwordx4 v[132:135], v1, s[8:11], s68 offen offset:256 nt
    v_and_b32_dpp v66, v25, v10 row_newbcast:9 row_mask:0xf bank_mask:0x3
    v_and_b32_dpp v67, v25, v11 row_newbcast:9 row_mask:0xf bank_mask:0x3
    v_and_b32_dpp v68, v25, v12 row_newbcast:9 row_mask:0xf bank_mask:0x3
    v_and_b32_dpp v69, v25, v13 row_newbcast:9 row_mask:0xf bank_mask:0x3
    v_and_b32_dpp v66, v33, v10 row_newbcast:9 row_mask:0xf bank_mask:0xc
    v_and_b32_dpp v67, v33, v11 row_newbcast:9 row_mask:0xf bank_mask:0xc
    v_and_b32_dpp v68, v33, v12 row_newbcast:9 row_mask:0xf bank_mask:0xc
    v_and_b32_dpp v69, v33, v13 row_newbcast:9 row_mask:0xf bank_mask:0xc
    s_nop 0
    s_nop 0
    v_mfma_f32_16x16x32_bf16 v[54:57], v[66:69], v[112:115], v[54:57]
    s_waitcnt vmcnt(6)
    s_xor_b32 s68, s69, 0x64000
    buffer_load_dwordx4 v[72:75], v1, s[8:11], s68 offen nt
    v_mfma_f32_16x16x32_bf16 v[58:61], v[66:69], v[116:119], v[58:61]
    s_waitcnt vmcnt(5)
    buffer_load_dwordx4 v[76:79], v1, s[8:11], s68 offen offset:256 nt
    s_mov_b32 s71, 215040
    buffer_load_dwordx4 a[248:251], v6, s[16:19], s71 offen
    v_and_b32_dpp v62, v25, v10 row_newbcast:5 row_mask:0xf bank_mask:0x3
    v_and_b32_dpp v63, v25, v11 row_newbcast:5 row_mask:0xf bank_mask:0x3
    v_and_b32_dpp v64, v25, v12 row_newbcast:5 row_mask:0xf bank_mask:0x3
    v_and_b32_dpp v65, v25, v13 row_newbcast:5 row_mask:0xf bank_mask:0x3
    v_and_b32_dpp v62, v33, v10 row_newbcast:5 row_mask:0xf bank_mask:0xc
    v_and_b32_dpp v63, v33, v11 row_newbcast:5 row_mask:0xf bank_mask:0xc
    v_and_b32_dpp v64, v33, v12 row_newbcast:5 row_mask:0xf bank_mask:0xc
    v_and_b32_dpp v65, v33, v13 row_newbcast:5 row_mask:0xf bank_mask:0xc
    s_nop 0
    s_nop 0
    v_mfma_f32_16x16x32_bf16 v[54:57], v[62:65], v[120:123], v[54:57]
    s_waitcnt vmcnt(6)
    s_xor_b32 s68, s69, 0x64800
    buffer_load_dwordx4 v[80:83], v1, s[8:11], s68 offen nt
    v_mfma_f32_16x16x32_bf16 v[58:61], v[62:65], v[124:127], v[58:61]
    s_waitcnt vmcnt(6)
    buffer_load_dwordx4 v[84:87], v1, s[8:11], s68 offen offset:256 nt
    v_and_b32_dpp v66, v25, v10 row_newbcast:13 row_mask:0xf bank_mask:0x3
    v_and_b32_dpp v67, v25, v11 row_newbcast:13 row_mask:0xf bank_mask:0x3
    v_and_b32_dpp v68, v25, v12 row_newbcast:13 row_mask:0xf bank_mask:0x3
    v_and_b32_dpp v69, v25, v13 row_newbcast:13 row_mask:0xf bank_mask:0x3
    v_and_b32_dpp v66, v33, v10 row_newbcast:13 row_mask:0xf bank_mask:0xc
    v_and_b32_dpp v67, v33, v11 row_newbcast:13 row_mask:0xf bank_mask:0xc
    v_and_b32_dpp v68, v33, v12 row_newbcast:13 row_mask:0xf bank_mask:0xc
    v_and_b32_dpp v69, v33, v13 row_newbcast:13 row_mask:0xf bank_mask:0xc
    s_nop 0
    s_nop 0
    v_mfma_f32_16x16x32_bf16 v[54:57], v[66:69], v[128:131], v[54:57]
    s_waitcnt vmcnt(5)
    s_xor_b32 s68, s69, 0x64200
    buffer_load_dwordx4 v[88:91], v1, s[8:11], s68 offen nt
    s_mov_b32 s71, 222208
    buffer_load_dwordx4 a[244:247], v4, s[16:19], s71 offen
    v_mfma_f32_16x16x32_bf16 v[58:61], v[66:69], v[132:135], v[58:61]
    s_waitcnt vmcnt(6)
    buffer_load_dwordx4 v[92:95], v1, s[8:11], s68 offen offset:256 nt
    v_and_b32_dpp v62, v25, v10 row_newbcast:2 row_mask:0xf bank_mask:0x3
    v_and_b32_dpp v63, v25, v11 row_newbcast:2 row_mask:0xf bank_mask:0x3
    v_and_b32_dpp v64, v25, v12 row_newbcast:2 row_mask:0xf bank_mask:0x3
    v_and_b32_dpp v65, v25, v13 row_newbcast:2 row_mask:0xf bank_mask:0x3
    v_and_b32_dpp v62, v33, v10 row_newbcast:2 row_mask:0xf bank_mask:0xc
    v_and_b32_dpp v63, v33, v11 row_newbcast:2 row_mask:0xf bank_mask:0xc
    v_and_b32_dpp v64, v33, v12 row_newbcast:2 row_mask:0xf bank_mask:0xc
    v_and_b32_dpp v65, v33, v13 row_newbcast:2 row_mask:0xf bank_mask:0xc
    s_nop 0
    s_nop 0
    v_mfma_f32_16x16x32_bf16 v[54:57], v[62:65], v[72:75], v[54:57]
    s_waitcnt vmcnt(6)
    s_xor_b32 s68, s69, 0x64a00
    buffer_load_dwordx4 v[96:99], v1, s[8:11], s68 offen nt
    v_mfma_f32_16x16x32_bf16 v[58:61], v[62:65], v[76:79], v[58:61]
    s_waitcnt vmcnt(5)
    buffer_load_dwordx4 v[100:103], v1, s[8:11], s68 offen offset:256 nt
    s_mov_b32 s71, 222208
    buffer_load_dwordx4 a[252:255], v6, s[16:19], s71 offen
    v_and_b32_dpp v66, v25, v10 row_newbcast:10 row_mask:0xf bank_mask:0x3
    v_and_b32_dpp v67, v25, v11 row_newbcast:10 row_mask:0xf bank_mask:0x3
    v_and_b32_dpp v68, v25, v12 row_newbcast:10 row_mask:0xf bank_mask:0x3
    v_and_b32_dpp v69, v25, v13 row_newbcast:10 row_mask:0xf bank_mask:0x3
    v_and_b32_dpp v66, v33, v10 row_newbcast:10 row_mask:0xf bank_mask:0xc
    v_and_b32_dpp v67, v33, v11 row_newbcast:10 row_mask:0xf bank_mask:0xc
    v_and_b32_dpp v68, v33, v12 row_newbcast:10 row_mask:0xf bank_mask:0xc
    v_and_b32_dpp v69, v33, v13 row_newbcast:10 row_mask:0xf bank_mask:0xc
    s_nop 0
    s_nop 0
    v_mfma_f32_16x16x32_bf16 v[54:57], v[66:69], v[80:83], v[54:57]
    s_waitcnt vmcnt(6)
    s_xor_b32 s68, s69, 0x6c000
    buffer_load_dwordx4 v[104:107], v1, s[8:11], s68 offen nt
    v_mfma_f32_16x16x32_bf16 v[58:61], v[66:69], v[84:87], v[58:61]
    s_waitcnt vmcnt(6)
    buffer_load_dwordx4 v[108:111], v1, s[8:11], s68 offen offset:256 nt
    v_and_b32_dpp v62, v25, v10 row_newbcast:6 row_mask:0xf bank_mask:0x3
    v_and_b32_dpp v63, v25, v11 row_newbcast:6 row_mask:0xf bank_mask:0x3
    v_and_b32_dpp v64, v25, v12 row_newbcast:6 row_mask:0xf bank_mask:0x3
    v_and_b32_dpp v65, v25, v13 row_newbcast:6 row_mask:0xf bank_mask:0x3
    v_and_b32_dpp v62, v33, v10 row_newbcast:6 row_mask:0xf bank_mask:0xc
    v_and_b32_dpp v63, v33, v11 row_newbcast:6 row_mask:0xf bank_mask:0xc
    v_and_b32_dpp v64, v33, v12 row_newbcast:6 row_mask:0xf bank_mask:0xc
    v_and_b32_dpp v65, v33, v13 row_newbcast:6 row_mask:0xf bank_mask:0xc
    s_nop 0
    s_nop 0
    v_mfma_f32_16x16x32_bf16 v[54:57], v[62:65], v[88:91], v[54:57]
    s_waitcnt vmcnt(5)
    s_xor_b32 s68, s69, 0x6c800
    buffer_load_dwordx4 v[112:115], v1, s[8:11], s68 offen nt
    v_mfma_f32_16x16x32_bf16 v[58:61], v[62:65], v[92:95], v[58:61]
    s_waitcnt vmcnt(5)
    buffer_load_dwordx4 v[116:119], v1, s[8:11], s68 offen offset:256 nt
    v_and_b32_dpp v66, v25, v10 row_newbcast:14 row_mask:0xf bank_mask:0x3
    v_and_b32_dpp v67, v25, v11 row_newbcast:14 row_mask:0xf bank_mask:0x3
    v_and_b32_dpp v68, v25, v12 row_newbcast:14 row_mask:0xf bank_mask:0x3
    v_and_b32_dpp v69, v25, v13 row_newbcast:14 row_mask:0xf bank_mask:0x3
    v_and_b32_dpp v66, v33, v10 row_newbcast:14 row_mask:0xf bank_mask:0xc
    v_and_b32_dpp v67, v33, v11 row_newbcast:14 row_mask:0xf bank_mask:0xc
    v_and_b32_dpp v68, v33, v12 row_newbcast:14 row_mask:0xf bank_mask:0xc
    v_and_b32_dpp v69, v33, v13 row_newbcast:14 row_mask:0xf bank_mask:0xc
    s_nop 0
    s_nop 0
    v_mfma_f32_16x16x32_bf16 v[54:57], v[66:69], v[96:99], v[54:57]
    s_waitcnt vmcnt(5)
    s_xor_b32 s68, s69, 0x6c200
    buffer_load_dwordx4 v[120:123], v1, s[8:11], s68 offen nt
    v_mfma_f32_16x16x32_bf16 v[58:61], v[66:69], v[100:103], v[58:61]
    s_waitcnt vmcnt(4)
    buffer_load_dwordx4 v[124:127], v1, s[8:11], s68 offen offset:256 nt
    v_and_b32_dpp v62, v25, v10 row_newbcast:3 row_mask:0xf bank_mask:0x3
    v_and_b32_dpp v63, v25, v11 row_newbcast:3 row_mask:0xf bank_mask:0x3
    v_and_b32_dpp v64, v25, v12 row_newbcast:3 row_mask:0xf bank_mask:0x3
    v_and_b32_dpp v65, v25, v13 row_newbcast:3 row_mask:0xf bank_mask:0x3
    v_and_b32_dpp v62, v33, v10 row_newbcast:3 row_mask:0xf bank_mask:0xc
    v_and_b32_dpp v63, v33, v11 row_newbcast:3 row_mask:0xf bank_mask:0xc
    v_and_b32_dpp v64, v33, v12 row_newbcast:3 row_mask:0xf bank_mask:0xc
    v_and_b32_dpp v65, v33, v13 row_newbcast:3 row_mask:0xf bank_mask:0xc
    s_nop 0
    s_nop 0
    v_mfma_f32_16x16x32_bf16 v[54:57], v[62:65], v[104:107], v[54:57]
    s_waitcnt vmcnt(4)
    s_xor_b32 s68, s69, 0x6ca00
    buffer_load_dwordx4 v[128:131], v1, s[8:11], s68 offen nt
    v_mfma_f32_16x16x32_bf16 v[58:61], v[62:65], v[108:111], v[58:61]
    s_waitcnt vmcnt(4)
    buffer_load_dwordx4 v[132:135], v1, s[8:11], s68 offen offset:256 nt
    v_and_b32_dpp v66, v25, v10 row_newbcast:11 row_mask:0xf bank_mask:0x3
    v_and_b32_dpp v67, v25, v11 row_newbcast:11 row_mask:0xf bank_mask:0x3
    v_and_b32_dpp v68, v25, v12 row_newbcast:11 row_mask:0xf bank_mask:0x3
    v_and_b32_dpp v69, v25, v13 row_newbcast:11 row_mask:0xf bank_mask:0x3
    v_and_b32_dpp v66, v33, v10 row_newbcast:11 row_mask:0xf bank_mask:0xc
    v_and_b32_dpp v67, v33, v11 row_newbcast:11 row_mask:0xf bank_mask:0xc
    v_and_b32_dpp v68, v33, v12 row_newbcast:11 row_mask:0xf bank_mask:0xc
    v_and_b32_dpp v69, v33, v13 row_newbcast:11 row_mask:0xf bank_mask:0xc
    s_nop 0
    s_nop 0
    v_mfma_f32_16x16x32_bf16 v[54:57], v[66:69], v[112:115], v[54:57]
    s_waitcnt vmcnt(4)
    s_xor_b32 s68, s69, 0x80000
    buffer_load_dwordx4 v[72:75], v1, s[8:11], s68 offen nt
    v_mfma_f32_16x16x32_bf16 v[58:61], v[66:69], v[116:119], v[58:61]
    s_cmp_lg_u32 s62, 0
    s_cbranch_scc1 L_nork20
    s_waitcnt lgkmcnt(0)
    v_mov_b32 v2, 0
    v_mov_b32 v3, s82
    ds_write_b32 v2, v3 offset:5184
L_nork20:
    s_waitcnt vmcnt(4)
    buffer_load_dwordx4 v[76:79], v1, s[8:11], s68 offen offset:256 nt
    v_and_b32_dpp v62, v25, v10 row_newbcast:7 row_mask:0xf bank_mask:0x3
    v_and_b32_dpp v63, v25, v11 row_newbcast:7 row_mask:0xf bank_mask:0x3
    v_and_b32_dpp v64, v25, v12 row_newbcast:7 row_mask:0xf bank_mask:0x3
    v_and_b32_dpp v65, v25, v13 row_newbcast:7 row_mask:0xf bank_mask:0x3
    v_and_b32_dpp v62, v33, v10 row_newbcast:7 row_mask:0xf bank_mask:0xc
    v_and_b32_dpp v63, v33, v11 row_newbcast:7 row_mask:0xf bank_mask:0xc
    v_and_b32_dpp v64, v33, v12 row_newbcast:7 row_mask:0xf bank_mask:0xc
    v_and_b32_dpp v65, v33, v13 row_newbcast:7 row_mask:0xf bank_mask:0xc
    s_nop 0
    s_nop 0
    v_mfma_f32_16x16x32_bf16 v[54:57], v[62:65], v[120:123], v[54:57]
    s_waitcnt vmcnt(4)
    s_xor_b32 s68, s69, 0x80800
    buffer_load_dwordx4 v[80:83], v1, s[8:11], s68 offen nt
    v_mfma_f32_16x16x32_bf16 v[58:61], v[62:65], v[124:127], v[58:61]
    s_waitcnt vmcnt(4)
    buffer_load_dwordx4 v[84:87], v1, s[8:11], s68 offen offset:256 nt
    v_and_b32_dpp v66, v25, v10 row_newbcast:15 row_mask:0xf bank_mask:0x3
    v_and_b32_dpp v67, v25, v11 row_newbcast:15 row_mask:0xf bank_mask:0x3
    v_and_b32_dpp v68, v25, v12 row_newbcast:15 row_mask:0xf bank_mask:0x3
    v_and_b32_dpp v69, v25, v13 row_newbcast:15 row_mask:0xf bank_mask:0x3
    v_and_b32_dpp v66, v33, v10 row_newbcast:15 row_mask:0xf bank_mask:0xc
    v_and_b32_dpp v67, v33, v11 row_newbcast:15 row_mask:0xf bank_mask:0xc
    v_and_b32_dpp v68, v33, v12 row_newbcast:15 row_mask:0xf bank_mask:0xc
    v_and_b32_dpp v69, v33, v13 row_newbcast:15 row_mask:0xf bank_mask:0xc
    s_nop 0
    s_nop 0
    v_mfma_f32_16x16x32_bf16 v[54:57], v[66:69], v[128:131], v[54:57]
    s_waitcnt vmcnt(4)
    s_xor_b32 s68, s69, 0x80200
    buffer_load_dwordx4 v[88:91], v1, s[8:11], s68 offen nt
    v_mfma_f32_16x16x32_bf16 v[58:61], v[66:69], v[132:135], v[58:61]
    s_waitcnt vmcnt(4)
    buffer_load_dwordx4 v[92:95], v1, s[8:11], s68 offen offset:256 nt
    v_and_b32_dpp v62, v26, v10 row_newbcast:0 row_mask:0xf bank_mask:0x3
    v_and_b32_dpp v63, v26, v11 row_newbcast:0 row_mask:0xf bank_mask:0x3
    v_and_b32_dpp v64, v26, v12 row_newbcast:0 row_mask:0xf bank_mask:0x3
    v_and_b32_dpp v65, v26, v13 row_newbcast:0 row_mask:0xf bank_mask:0x3
    v_and_b32_dpp v62, v34, v10 row_newbcast:0 row_mask:0xf bank_mask:0xc
    v_and_b32_dpp v63, v34, v11 row_newbcast:0 row_mask:0xf bank_mask:0xc
    v_and_b32_dpp v64, v34, v12 row_newbcast:0 row_mask:0xf bank_mask:0xc
    v_and_b32_dpp v65, v34, v13 row_newbcast:0 row_mask:0xf bank_mask:0xc
    s_nop 0
    s_nop 0
    v_mfma_f32_16x16x32_bf16 v[54:57], v[62:65], v[72:75], v[54:57]
    s_waitcnt vmcnt(4)
    s_xor_b32 s68, s69, 0x80a00
    buffer_load_dwordx4 v[96:99], v1, s[8:11], s68 offen nt
    v_mfma_f32_16x16x32_bf16 v[58:61], v[62:65], v[76:79], v[58:61]
    s_waitcnt vmcnt(4)
    buffer_load_dwordx4 v[100:103], v1, s[8:11], s68 offen offset:256 nt
    v_and_b32_dpp v66, v26, v10 row_newbcast:8 row_mask:0xf bank_mask:0x3
    v_and_b32_dpp v67, v26, v11 row_newbcast:8 row_mask:0xf bank_mask:0x3
    v_and_b32_dpp v68, v26, v12 row_newbcast:8 row_mask:0xf bank_mask:0x3
    v_and_b32_dpp v69, v26, v13 row_newbcast:8 row_mask:0xf bank_mask:0x3
    v_and_b32_dpp v66, v34, v10 row_newbcast:8 row_mask:0xf bank_mask:0xc
    v_and_b32_dpp v67, v34, v11 row_newbcast:8 row_mask:0xf bank_mask:0xc
    v_and_b32_dpp v68, v34, v12 row_newbcast:8 row_mask:0xf bank_mask:0xc
    v_and_b32_dpp v69, v34, v13 row_newbcast:8 row_mask:0xf bank_mask:0xc
    s_nop 0
    s_nop 0
    v_mfma_f32_16x16x32_bf16 v[54:57], v[66:69], v[80:83], v[54:57]
    s_waitcnt vmcnt(4)
    s_xor_b32 s68, s69, 0x88000
    buffer_load_dwordx4 v[104:107], v1, s[8:11], s68 offen nt
    v_mfma_f32_16x16x32_bf16 v[58:61], v[66:69], v[84:87], v[58:61]
    s_waitcnt vmcnt(4)
    buffer_load_dwordx4 v[108:111], v1, s[8:11], s68 offen offset:256 nt
    v_mov_b32 v2, 0
    s_waitcnt lgkmcnt(0)
    s_barrier
    ds_read_b32 v2, v2 offset:5184
    s_waitcnt lgkmcnt(0)
    v_readfirstlane_b32 s82, v2
    s_nop 0
    s_min_u32 s82, s82, 31
    s_mov_b32 s71, 0x0
    s_cmp_ge_u32 s82, 8
    s_cselect_b32 s71, 0x21100000, s71
    s_cmp_ge_u32 s82, 16
    s_cselect_b32 s71, 0x55443322, s71
    s_cmp_ge_u32 s82, 24
    s_cselect_b32 s71, 0xda987765, s71
    s_and_b32 s72, s82, 7
    s_lshl_b32 s72, s72, 2
    s_lshr_b32 s71, s71, s72
    s_and_b32 s71, s71, 15
    s_lshl_b32 s71, s71, 3
    s_sub_u32 s81, 487, s71
    s_mov_b32 s71, 0x11223345
    s_cmp_ge_u32 s82, 8
    s_cselect_b32 s71, 0x1, s71
    s_cmp_ge_u32 s82, 16
    s_cselect_b32 s71, 0x0, s71
    s_cmp_ge_u32 s82, 24
    s_cselect_b32 s71, 0x0, s71
    s_and_b32 s72, s82, 7
    s_lshl_b32 s72, s72, 2
    s_lshr_b32 s71, s71, s72
    s_and_b32 s71, s71, 15
    s_lshl_b32 s71, s71, 3
    s_sub_u32 s80, 487, s71
    v_and_b32_dpp v62, v26, v10 row_newbcast:4 row_mask:0xf bank_mask:0x3
    v_and_b32_dpp v63, v26, v11 row_newbcast:4 row_mask:0xf bank_mask:0x3
    v_and_b32_dpp v64, v26, v12 row_newbcast:4 row_mask:0xf bank_mask:0x3
    v_and_b32_dpp v65, v26, v13 row_newbcast:4 row_mask:0xf bank_mask:0x3
    v_and_b32_dpp v62, v34, v10 row_newbcast:4 row_mask:0xf bank_mask:0xc
    v_and_b32_dpp v63, v34, v11 row_newbcast:4 row_mask:0xf bank_mask:0xc
    v_and_b32_dpp v64, v34, v12 row_newbcast:4 row_mask:0xf bank_mask:0xc
    v_and_b32_dpp v65, v34, v13 row_newbcast:4 row_mask:0xf bank_mask:0xc
    s_nop 0
    s_nop 0
    v_mfma_f32_16x16x32_bf16 v[54:57], v[62:65], v[88:91], v[54:57]
    s_waitcnt vmcnt(4)
    s_xor_b32 s68, s69, 0x88800
    buffer_load_dwordx4 v[112:115], v1, s[8:11], s68 offen nt
    v_mfma_f32_16x16x32_bf16 v[58:61], v[62:65], v[92:95], v[58:61]
    s_waitcnt vmcnt(4)
    buffer_load_dwordx4 v[116:119], v1, s[8:11], s68 offen offset:256 nt
    v_and_b32_dpp v66, v26, v10 row_newbcast:12 row_mask:0xf bank_mask:0x3
    v_and_b32_dpp v67, v26, v11 row_newbcast:12 row_mask:0xf bank_mask:0x3
    v_and_b32_dpp v68, v26, v12 row_newbcast:12 row_mask:0xf bank_mask:0x3
    v_and_b32_dpp v69, v26, v13 row_newbcast:12 row_mask:0xf bank_mask:0x3
    v_and_b32_dpp v66, v34, v10 row_newbcast:12 row_mask:0xf bank_mask:0xc
    v_and_b32_dpp v67, v34, v11 row_newbcast:12 row_mask:0xf bank_mask:0xc
    v_and_b32_dpp v68, v34, v12 row_newbcast:12 row_mask:0xf bank_mask:0xc
    v_and_b32_dpp v69, v34, v13 row_newbcast:12 row_mask:0xf bank_mask:0xc
    s_nop 0
    s_nop 0
    v_mfma_f32_16x16x32_bf16 v[54:57], v[66:69], v[96:99], v[54:57]
    s_waitcnt vmcnt(4)
    s_xor_b32 s68, s69, 0x88200
    buffer_load_dwordx4 v[120:123], v1, s[8:11], s68 offen nt
    v_mfma_f32_16x16x32_bf16 v[58:61], v[66:69], v[100:103], v[58:61]
    s_waitcnt vmcnt(4)
    buffer_load_dwordx4 v[124:127], v1, s[8:11], s68 offen offset:256 nt
    v_and_b32_dpp v62, v26, v10 row_newbcast:1 row_mask:0xf bank_mask:0x3
    v_and_b32_dpp v63, v26, v11 row_newbcast:1 row_mask:0xf bank_mask:0x3
    v_and_b32_dpp v64, v26, v12 row_newbcast:1 row_mask:0xf bank_mask:0x3
    v_and_b32_dpp v65, v26, v13 row_newbcast:1 row_mask:0xf bank_mask:0x3
    v_and_b32_dpp v62, v34, v10 row_newbcast:1 row_mask:0xf bank_mask:0xc
    v_and_b32_dpp v63, v34, v11 row_newbcast:1 row_mask:0xf bank_mask:0xc
    v_and_b32_dpp v64, v34, v12 row_newbcast:1 row_mask:0xf bank_mask:0xc
    v_and_b32_dpp v65, v34, v13 row_newbcast:1 row_mask:0xf bank_mask:0xc
    s_nop 0
    s_nop 0
    v_mfma_f32_16x16x32_bf16 v[54:57], v[62:65], v[104:107], v[54:57]
    s_cmpk_le_u32 s81, 398
    s_cbranch_scc1 L_w_1
    s_waitcnt vmcnt(4)
    s_cmpk_le_u32 s80, 398
    s_cbranch_scc0 L_w_1
    s_waitcnt vmcnt(3)
L_w_1:
    s_xor_b32 s68, s69, 0x88a00
    buffer_load_dwordx4 v[128:131], v1, s[8:11], s68 offen nt
    s_cmpk_le_u32 s81, 399
    s_cbranch_scc1 L_w_2
    s_waitcnt vmcnt(4)
    s_cmpk_le_u32 s80, 399
    s_cbranch_scc0 L_w_2
    s_waitcnt vmcnt(3)
L_w_2:
    buffer_load_dwordx4 v[132:135], v1, s[8:11], s68 offen offset:256 nt
    s_waitcnt vmcnt(6)
    s_cmpk_le_u32 s81, 400
    s_cbranch_scc1 L_w_3
    s_waitcnt vmcnt(4)
    s_cmpk_le_u32 s80, 400
    s_cbranch_scc0 L_w_3
    s_waitcnt vmcnt(3)
L_w_3:
    s_xor_b32 s68, s69, 0xc0000
    buffer_load_dwordx4 v[72:75], v1, s[8:11], s68 offen nt
    v_mfma_f32_16x16x32_bf16 v[58:61], v[62:65], v[108:111], v[58:61]
    s_waitcnt vmcnt(6)
    s_cmpk_le_u32 s81, 401
    s_cbranch_scc1 L_w_4
    s_waitcnt vmcnt(4)
    s_cmpk_le_u32 s80, 401
    s_cbranch_scc0 L_w_4
    s_waitcnt vmcnt(3)
L_w_4:
    buffer_load_dwordx4 v[76:79], v1, s[8:11], s68 offen offset:256 nt
    v_and_b32_dpp v66, v26, v10 row_newbcast:9 row_mask:0xf bank_mask:0x3
    v_and_b32_dpp v67, v26, v11 row_newbcast:9 row_mask:0xf bank_mask:0x3
    v_and_b32_dpp v68, v26, v12 row_newbcast:9 row_mask:0xf bank_mask:0x3
    v_and_b32_dpp v69, v26, v13 row_newbcast:9 row_mask:0xf bank_mask:0x3
    v_and_b32_dpp v66, v34, v10 row_newbcast:9 row_mask:0xf bank_mask:0xc
    v_and_b32_dpp v67, v34, v11 row_newbcast:9 row_mask:0xf bank_mask:0xc
    v_and_b32_dpp v68, v34, v12 row_newbcast:9 row_mask:0xf bank_mask:0xc
    v_and_b32_dpp v69, v34, v13 row_newbcast:9 row_mask:0xf bank_mask:0xc
    s_nop 0
    s_nop 0
    v_mfma_f32_16x16x32_bf16 v[54:57], v[66:69], v[112:115], v[54:57]
    s_waitcnt vmcnt(6)
    s_cmpk_le_u32 s81, 402
    s_cbranch_scc1 L_w_5
    s_waitcnt vmcnt(4)
    s_cmpk_le_u32 s80, 402
    s_cbranch_scc0 L_w_5
    s_waitcnt vmcnt(3)
L_w_5:
    s_xor_b32 s68, s69, 0xc0800
    buffer_load_dwordx4 v[80:83], v1, s[8:11], s68 offen nt
    v_mfma_f32_16x16x32_bf16 v[58:61], v[66:69], v[116:119], v[58:61]
    s_waitcnt vmcnt(6)
    s_cmpk_le_u32 s81, 403
    s_cbranch_scc1 L_w_6
    s_waitcnt vmcnt(4)
    s_cmpk_le_u32 s80, 403
    s_cbranch_scc0 L_w_6
    s_waitcnt vmcnt(3)
L_w_6:
    buffer_load_dwordx4 v[84:87], v1, s[8:11], s68 offen offset:256 nt
    v_and_b32_dpp v62, v26, v10 row_newbcast:5 row_mask:0xf bank_mask:0x3
    v_and_b32_dpp v63, v26, v11 row_newbcast:5 row_mask:0xf bank_mask:0x3
    v_and_b32_dpp v64, v26, v12 row_newbcast:5 row_mask:0xf bank_mask:0x3
    v_and_b32_dpp v65, v26, v13 row_newbcast:5 row_mask:0xf bank_mask:0x3
    v_and_b32_dpp v62, v34, v10 row_newbcast:5 row_mask:0xf bank_mask:0xc
    v_and_b32_dpp v63, v34, v11 row_newbcast:5 row_mask:0xf bank_mask:0xc
    v_and_b32_dpp v64, v34, v12 row_newbcast:5 row_mask:0xf bank_mask:0xc
    v_and_b32_dpp v65, v34, v13 row_newbcast:5 row_mask:0xf bank_mask:0xc
    s_nop 0
    s_nop 0
    v_mfma_f32_16x16x32_bf16 v[54:57], v[62:65], v[120:123], v[54:57]
    s_waitcnt vmcnt(6)
    s_cmpk_le_u32 s81, 404
    s_cbranch_scc1 L_w_7
    s_waitcnt vmcnt(4)
    s_cmpk_le_u32 s80, 404
    s_cbranch_scc0 L_w_7
    s_waitcnt vmcnt(3)
L_w_7:
    s_xor_b32 s68, s69, 0xc0200
    buffer_load_dwordx4 v[88:91], v1, s[8:11], s68 offen nt
    v_mfma_f32_16x16x32_bf16 v[58:61], v[62:65], v[124:127], v[58:61]
    s_waitcnt vmcnt(6)
    s_cmpk_le_u32 s81, 405
    s_cbranch_scc1 L_w_8
    s_waitcnt vmcnt(4)
    s_cmpk_le_u32 s80, 405
    s_cbranch_scc0 L_w_8
    s_waitcnt vmcnt(3)
L_w_8:
    buffer_load_dwordx4 v[92:95], v1, s[8:11], s68 offen offset:256 nt
    v_and_b32_dpp v66, v26, v10 row_newbcast:13 row_mask:0xf bank_mask:0x3
    v_and_b32_dpp v67, v26, v11 row_newbcast:13 row_mask:0xf bank_mask:0x3
    v_and_b32_dpp v68, v26, v12 row_newbcast:13 row_mask:0xf bank_mask:0x3
    v_and_b32_dpp v69, v26, v13 row_newbcast:13 row_mask:0xf bank_mask:0x3
    v_and_b32_dpp v66, v34, v10 row_newbcast:13 row_mask:0xf bank_mask:0xc
    v_and_b32_dpp v67, v34, v11 row_newbcast:13 row_mask:0xf bank_mask:0xc
    v_and_b32_dpp v68, v34, v12 row_newbcast:13 row_mask:0xf bank_mask:0xc
    v_and_b32_dpp v69, v34, v13 row_newbcast:13 row_mask:0xf bank_mask:0xc
    s_nop 0
    s_nop 0
    v_mfma_f32_16x16x32_bf16 v[54:57], v[66:69], v[128:131], v[54:57]
    s_waitcnt vmcnt(6)
    s_cmpk_le_u32 s81, 406
    s_cbranch_scc1 L_w_9
    s_waitcnt vmcnt(4)
    s_cmpk_le_u32 s80, 406
    s_cbranch_scc0 L_w_9
    s_waitcnt vmcnt(3)
L_w_9:
    s_xor_b32 s68, s69, 0xc0a00
    buffer_load_dwordx4 v[96:99], v1, s[8:11], s68 offen nt
    v_mfma_f32_16x16x32_bf16 v[58:61], v[66:69], v[132:135], v[58:61]
    s_waitcnt vmcnt(6)
    s_cmpk_le_u32 s81, 407
    s_cbranch_scc1 L_w_10
    s_waitcnt vmcnt(4)
    s_cmpk_le_u32 s80, 407
    s_cbranch_scc0 L_w_10
    s_waitcnt vmcnt(3)
L_w_10:
    buffer_load_dwordx4 v[100:103], v1, s[8:11], s68 offen offset:256 nt
    v_and_b32_dpp v62, v26, v10 row_newbcast:2 row_mask:0xf bank_mask:0x3
    v_and_b32_dpp v63, v26, v11 row_newbcast:2 row_mask:0xf bank_mask:0x3
    v_and_b32_dpp v64, v26, v12 row_newbcast:2 row_mask:0xf bank_mask:0x3
    v_and_b32_dpp v65, v26, v13 row_newbcast:2 row_mask:0xf bank_mask:0x3
    v_and_b32_dpp v62, v34, v10 row_newbcast:2 row_mask:0xf bank_mask:0xc
    v_and_b32_dpp v63, v34, v11 row_newbcast:2 row_mask:0xf bank_mask:0xc
    v_and_b32_dpp v64, v34, v12 row_newbcast:2 row_mask:0xf bank_mask:0xc
    v_and_b32_dpp v65, v34, v13 row_newbcast:2 row_mask:0xf bank_mask:0xc
    s_nop 0
    s_nop 0
    v_mfma_f32_16x16x32_bf16 v[54:57], v[62:65], v[72:75], v[54:57]
    s_waitcnt vmcnt(6)
    s_cmpk_le_u32 s81, 408
    s_cbranch_scc1 L_w_11
    s_waitcnt vmcnt(4)
    s_cmpk_le_u32 s80, 408
    s_cbranch_scc0 L_w_11
    s_waitcnt vmcnt(3)
L_w_11:
    s_xor_b32 s68, s69, 0xc8000
    buffer_load_dwordx4 v[104:107], v1, s[8:11], s68 offen nt
    v_mfma_f32_16x16x32_bf16 v[58:61], v[62:65], v[76:79], v[58:61]
    s_waitcnt vmcnt(6)
    s_cmpk_le_u32 s81, 409
    s_cbranch_scc1 L_w_12
    s_waitcnt vmcnt(4)
    s_cmpk_le_u32 s80, 409
    s_cbranch_scc0 L_w_12
    s_waitcnt vmcnt(3)
L_w_12:
    buffer_load_dwordx4 v[108:111], v1, s[8:11], s68 offen offset:256 nt
    v_and_b32_dpp v66, v26, v10 row_newbcast:10 row_mask:0xf bank_mask:0x3
    v_and_b32_dpp v67, v26, v11 row_newbcast:10 row_mask:0xf bank_mask:0x3
    v_and_b32_dpp v68, v26, v12 row_newbcast:10 row_mask:0xf bank_mask:0x3
    v_and_b32_dpp v69, v26, v13 row_newbcast:10 row_mask:0xf bank_mask:0x3
    v_and_b32_dpp v66, v34, v10 row_newbcast:10 row_mask:0xf bank_mask:0xc
    v_and_b32_dpp v67, v34, v11 row_newbcast:10 row_mask:0xf bank_mask:0xc
    v_and_b32_dpp v68, v34, v12 row_newbcast:10 row_mask:0xf bank_mask:0xc
    v_and_b32_dpp v69, v34, v13 row_newbcast:10 row_mask:0xf bank_mask:0xc
    s_nop 0
    s_nop 0
    v_mfma_f32_16x16x32_bf16 v[54:57], v[66:69], v[80:83], v[54:57]
    s_waitcnt vmcnt(6)
    s_cmpk_le_u32 s81, 410
    s_cbranch_scc1 L_w_13
    s_waitcnt vmcnt(4)
    s_cmpk_le_u32 s80, 410
    s_cbranch_scc0 L_w_13
    s_waitcnt vmcnt(3)
L_w_13:
    s_xor_b32 s68, s69, 0xc8800
    buffer_load_dwordx4 v[112:115], v1, s[8:11], s68 offen nt
    v_mfma_f32_16x16x32_bf16 v[58:61], v[66:69], v[84:87], v[58:61]
    s_waitcnt vmcnt(6)
    s_cmpk_le_u32 s81, 411
    s_cbranch_scc1 L_w_14
    s_waitcnt vmcnt(4)
    s_cmpk_le_u32 s80, 411
    s_cbranch_scc0 L_w_14
    s_waitcnt vmcnt(3)
L_w_14:
    buffer_load_dwordx4 v[116:119], v1, s[8:11], s68 offen offset:256 nt
    v_and_b32_dpp v62, v26, v10 row_newbcast:6 row_mask:0xf bank_mask:0x3
    v_and_b32_dpp v63, v26, v11 row_newbcast:6 row_mask:0xf bank_mask:0x3
    v_and_b32_dpp v64, v26, v12 row_newbcast:6 row_mask:0xf bank_mask:0x3
    v_and_b32_dpp v65, v26, v13 row_newbcast:6 row_mask:0xf bank_mask:0x3
    v_and_b32_dpp v62, v34, v10 row_newbcast:6 row_mask:0xf bank_mask:0xc
    v_and_b32_dpp v63, v34, v11 row_newbcast:6 row_mask:0xf bank_mask:0xc
    v_and_b32_dpp v64, v34, v12 row_newbcast:6 row_mask:0xf bank_mask:0xc
    v_and_b32_dpp v65, v34, v13 row_newbcast:6 row_mask:0xf bank_mask:0xc
    s_nop 0
    s_nop 0
    v_mfma_f32_16x16x32_bf16 v[54:57], v[62:65], v[88:91], v[54:57]
    s_waitcnt vmcnt(6)
    s_cmpk_le_u32 s81, 412
    s_cbranch_scc1 L_w_15
    s_waitcnt vmcnt(4)
    s_cmpk_le_u32 s80, 412
    s_cbranch_scc0 L_w_15
    s_waitcnt vmcnt(3)
L_w_15:
    s_xor_b32 s68, s69, 0xc8200
    buffer_load_dwordx4 v[120:123], v1, s[8:11], s68 offen nt
    v_mfma_f32_16x16x32_bf16 v[58:61], v[62:65], v[92:95], v[58:61]
    s_waitcnt vmcnt(6)
    s_cmpk_le_u32 s81, 413
    s_cbranch_scc1 L_w_16
    s_waitcnt vmcnt(4)
    s_cmpk_le_u32 s80, 413
    s_cbranch_scc0 L_w_16
    s_waitcnt vmcnt(3)
L_w_16:
    buffer_load_dwordx4 v[124:127], v1, s[8:11], s68 offen offset:256 nt
    v_and_b32_dpp v66, v26, v10 row_newbcast:14 row_mask:0xf bank_mask:0x3
    v_and_b32_dpp v67, v26, v11 row_newbcast:14 row_mask:0xf bank_mask:0x3
    v_and_b32_dpp v68, v26, v12 row_newbcast:14 row_mask:0xf bank_mask:0x3
    v_and_b32_dpp v69, v26, v13 row_newbcast:14 row_mask:0xf bank_mask:0x3
    v_and_b32_dpp v66, v34, v10 row_newbcast:14 row_mask:0xf bank_mask:0xc
    v_and_b32_dpp v67, v34, v11 row_newbcast:14 row_mask:0xf bank_mask:0xc
    v_and_b32_dpp v68, v34, v12 row_newbcast:14 row_mask:0xf bank_mask:0xc
    v_and_b32_dpp v69, v34, v13 row_newbcast:14 row_mask:0xf bank_mask:0xc
    s_nop 0
    s_nop 0
    v_mfma_f32_16x16x32_bf16 v[54:57], v[66:69], v[96:99], v[54:57]
    s_waitcnt vmcnt(6)
    s_cmpk_le_u32 s81, 414
    s_cbranch_scc1 L_w_17
    s_waitcnt vmcnt(4)
    s_cmpk_le_u32 s80, 414
    s_cbranch_scc0 L_w_17
    s_waitcnt vmcnt(3)
L_w_17:
    s_xor_b32 s68, s69, 0xc8a00
    buffer_load_dwordx4 v[128:131], v1, s[8:11], s68 offen nt
    v_mfma_f32_16x16x32_bf16 v[58:61], v[66:69], v[100:103], v[58:61]
    s_waitcnt vmcnt(6)
    s_cmpk_le_u32 s81, 415
    s_cbranch_scc1 L_w_18
    s_waitcnt vmcnt(4)
    s_cmpk_le_u32 s80, 415
    s_cbranch_scc0 L_w_18
    s_waitcnt vmcnt(3)
L_w_18:
    buffer_load_dwordx4 v[132:135], v1, s[8:11], s68 offen offset:256 nt
    v_and_b32_dpp v62, v26, v10 row_newbcast:3 row_mask:0xf bank_mask:0x3
    v_and_b32_dpp v63, v26, v11 row_newbcast:3 row_mask:0xf bank_mask:0x3
    v_and_b32_dpp v64, v26, v12 row_newbcast:3 row_mask:0xf bank_mask:0x3
    v_and_b32_dpp v65, v26, v13 row_newbcast:3 row_mask:0xf bank_mask:0x3
    v_and_b32_dpp v62, v34, v10 row_newbcast:3 row_mask:0xf bank_mask:0xc
    v_and_b32_dpp v63, v34, v11 row_newbcast:3 row_mask:0xf bank_mask:0xc
    v_and_b32_dpp v64, v34, v12 row_newbcast:3 row_mask:0xf bank_mask:0xc
    v_and_b32_dpp v65, v34, v13 row_newbcast:3 row_mask:0xf bank_mask:0xc
    s_nop 0
    s_nop 0
    v_mfma_f32_16x16x32_bf16 v[54:57], v[62:65], v[104:107], v[54:57]
    s_waitcnt vmcnt(6)
    s_cmpk_le_u32 s81, 416
    s_cbranch_scc1 L_w_19
    s_waitcnt vmcnt(4)
    s_cmpk_le_u32 s80, 416
    s_cbranch_scc0 L_w_19
    s_waitcnt vmcnt(3)
L_w_19:
    s_xor_b32 s68, s69, 0x84000
    buffer_load_dwordx4 v[72:75], v1, s[8:11], s68 offen nt
    v_mfma_f32_16x16x32_bf16 v[58:61], v[62:65], v[108:111], v[58:61]
    s_waitcnt vmcnt(6)
    s_cmpk_le_u32 s81, 417
    s_cbranch_scc1 L_w_20
    s_waitcnt vmcnt(4)
    s_cmpk_le_u32 s80, 417
    s_cbranch_scc0 L_w_20
    s_waitcnt vmcnt(3)
L_w_20:
    buffer_load_dwordx4 v[76:79], v1, s[8:11], s68 offen offset:256 nt
    v_and_b32_dpp v66, v26, v10 row_newbcast:11 row_mask:0xf bank_mask:0x3
    v_and_b32_dpp v67, v26, v11 row_newbcast:11 row_mask:0xf bank_mask:0x3
    v_and_b32_dpp v68, v26, v12 row_newbcast:11 row_mask:0xf bank_mask:0x3
    v_and_b32_dpp v69, v26, v13 row_newbcast:11 row_mask:0xf bank_mask:0x3
    v_and_b32_dpp v66, v34, v10 row_newbcast:11 row_mask:0xf bank_mask:0xc
    v_and_b32_dpp v67, v34, v11 row_newbcast:11 row_mask:0xf bank_mask:0xc
    v_and_b32_dpp v68, v34, v12 row_newbcast:11 row_mask:0xf bank_mask:0xc
    v_and_b32_dpp v69, v34, v13 row_newbcast:11 row_mask:0xf bank_mask:0xc
    s_nop 0
    s_nop 0
    v_mfma_f32_16x16x32_bf16 v[54:57], v[66:69], v[112:115], v[54:57]
    s_waitcnt vmcnt(6)
    s_cmpk_le_u32 s81, 418
    s_cbranch_scc1 L_w_21
    s_waitcnt vmcnt(4)
    s_cmpk_le_u32 s80, 418
    s_cbranch_scc0 L_w_21
    s_waitcnt vmcnt(3)
L_w_21:
    s_xor_b32 s68, s69, 0x84800
    buffer_load_dwordx4 v[80:83], v1, s[8:11], s68 offen nt
    v_mfma_f32_16x16x32_bf16 v[58:61], v[66:69], v[116:119], v[58:61]
    s_waitcnt vmcnt(6)
    s_cmpk_le_u32 s81, 419
    s_cbranch_scc1 L_w_22
    s_waitcnt vmcnt(4)
    s_cmpk_le_u32 s80, 419
    s_cbranch_scc0 L_w_22
    s_waitcnt vmcnt(3)
L_w_22:
    buffer_load_dwordx4 v[84:87], v1, s[8:11], s68 offen offset:256 nt
    v_and_b32_dpp v62, v26, v10 row_newbcast:7 row_mask:0xf bank_mask:0x3
    v_and_b32_dpp v63, v26, v11 row_newbcast:7 row_mask:0xf bank_mask:0x3
    v_and_b32_dpp v64, v26, v12 row_newbcast:7 row_mask:0xf bank_mask:0x3
    v_and_b32_dpp v65, v26, v13 row_newbcast:7 row_mask:0xf bank_mask:0x3
    v_and_b32_dpp v62, v34, v10 row_newbcast:7 row_mask:0xf bank_mask:0xc
    v_and_b32_dpp v63, v34, v11 row_newbcast:7 row_mask:0xf bank_mask:0xc
    v_and_b32_dpp v64, v34, v12 row_newbcast:7 row_mask:0xf bank_mask:0xc
    v_and_b32_dpp v65, v34, v13 row_newbcast:7 row_mask:0xf bank_mask:0xc
    s_nop 0
    s_nop 0
    v_mfma_f32_16x16x32_bf16 v[54:57], v[62:65], v[120:123], v[54:57]
    s_waitcnt vmcnt(6)
    s_cmpk_le_u32 s81, 420
    s_cbranch_scc1 L_w_23
    s_waitcnt vmcnt(4)
    s_cmpk_le_u32 s80, 420
    s_cbranch_scc0 L_w_23
    s_waitcnt vmcnt(3)
L_w_23:
    s_xor_b32 s68, s69, 0x84200
    buffer_load_dwordx4 v[88:91], v1, s[8:11], s68 offen nt
    v_mfma_f32_16x16x32_bf16 v[58:61], v[62:65], v[124:127], v[58:61]
    s_waitcnt vmcnt(6)
    s_cmpk_le_u32 s81, 421
    s_cbranch_scc1 L_w_24
    s_waitcnt vmcnt(4)
    s_cmpk_le_u32 s80, 421
    s_cbranch_scc0 L_w_24
    s_waitcnt vmcnt(3)
L_w_24:
    buffer_load_dwordx4 v[92:95], v1, s[8:11], s68 offen offset:256 nt
    v_and_b32_dpp v66, v26, v10 row_newbcast:15 row_mask:0xf bank_mask:0x3
    v_and_b32_dpp v67, v26, v11 row_newbcast:15 row_mask:0xf bank_mask:0x3
    v_and_b32_dpp v68, v26, v12 row_newbcast:15 row_mask:0xf bank_mask:0x3
    v_and_b32_dpp v69, v26, v13 row_newbcast:15 row_mask:0xf bank_mask:0x3
    v_and_b32_dpp v66, v34, v10 row_newbcast:15 row_mask:0xf bank_mask:0xc
    v_and_b32_dpp v67, v34, v11 row_newbcast:15 row_mask:0xf bank_mask:0xc
    v_and_b32_dpp v68, v34, v12 row_newbcast:15 row_mask:0xf bank_mask:0xc
    v_and_b32_dpp v69, v34, v13 row_newbcast:15 row_mask:0xf bank_mask:0xc
    s_nop 0
    s_nop 0
    v_mfma_f32_16x16x32_bf16 v[54:57], v[66:69], v[128:131], v[54:57]
    s_waitcnt vmcnt(6)
    s_cmpk_le_u32 s81, 422
    s_cbranch_scc1 L_w_25
    s_waitcnt vmcnt(4)
    s_cmpk_le_u32 s80, 422
    s_cbranch_scc0 L_w_25
    s_waitcnt vmcnt(3)
L_w_25:
    s_xor_b32 s68, s69, 0x84a00
    buffer_load_dwordx4 v[96:99], v1, s[8:11], s68 offen nt
    v_mfma_f32_16x16x32_bf16 v[58:61], v[66:69], v[132:135], v[58:61]
    s_waitcnt vmcnt(6)
    s_cmpk_le_u32 s81, 423
    s_cbranch_scc1 L_w_26
    s_waitcnt vmcnt(4)
    s_cmpk_le_u32 s80, 423
    s_cbranch_scc0 L_w_26
    s_waitcnt vmcnt(3)
L_w_26:
    buffer_load_dwordx4 v[100:103], v1, s[8:11], s68 offen offset:256 nt
    v_and_b32_dpp v62, v27, v10 row_newbcast:0 row_mask:0xf bank_mask:0x3
    v_and_b32_dpp v63, v27, v11 row_newbcast:0 row_mask:0xf bank_mask:0x3
    v_and_b32_dpp v64, v27, v12 row_newbcast:0 row_mask:0xf bank_mask:0x3
    v_and_b32_dpp v65, v27, v13 row_newbcast:0 row_mask:0xf bank_mask:0x3
    v_and_b32_dpp v62, v35, v10 row_newbcast:0 row_mask:0xf bank_mask:0xc
    v_and_b32_dpp v63, v35, v11 row_newbcast:0 row_mask:0xf bank_mask:0xc
    v_and_b32_dpp v64, v35, v12 row_newbcast:0 row_mask:0xf bank_mask:0xc
    v_and_b32_dpp v65, v35, v13 row_newbcast:0 row_mask:0xf bank_mask:0xc
    s_nop 0
    s_nop 0
    v_mfma_f32_16x16x32_bf16 v[54:57], v[62:65], v[72:75], v[54:57]
    s_waitcnt vmcnt(6)
    s_cmpk_le_u32 s81, 424
    s_cbranch_scc1 L_w_27
    s_waitcnt vmcnt(4)
    s_cmpk_le_u32 s80, 424
    s_cbranch_scc0 L_w_27
    s_waitcnt vmcnt(3)
L_w_27:
    s_xor_b32 s68, s69, 0x8c000
    buffer_load_dwordx4 v[104:107], v1, s[8:11], s68 offen nt
    v_mfma_f32_16x16x32_bf16 v[58:61], v[62:65], v[76:79], v[58:61]
    s_waitcnt vmcnt(6)
    s_cmpk_le_u32 s81, 425
    s_cbranch_scc1 L_w_28
    s_waitcnt vmcnt(4)
    s_cmpk_le_u32 s80, 425
    s_cbranch_scc0 L_w_28
    s_waitcnt vmcnt(3)
L_w_28:
    buffer_load_dwordx4 v[108:111], v1, s[8:11], s68 offen offset:256 nt
    v_and_b32_dpp v66, v27, v10 row_newbcast:8 row_mask:0xf bank_mask:0x3
    v_and_b32_dpp v67, v27, v11 row_newbcast:8 row_mask:0xf bank_mask:0x3
    v_and_b32_dpp v68, v27, v12 row_newbcast:8 row_mask:0xf bank_mask:0x3
    v_and_b32_dpp v69, v27, v13 row_newbcast:8 row_mask:0xf bank_mask:0x3
    v_and_b32_dpp v66, v35, v10 row_newbcast:8 row_mask:0xf bank_mask:0xc
    v_and_b32_dpp v67, v35, v11 row_newbcast:8 row_mask:0xf bank_mask:0xc
    v_and_b32_dpp v68, v35, v12 row_newbcast:8 row_mask:0xf bank_mask:0xc
    v_and_b32_dpp v69, v35, v13 row_newbcast:8 row_mask:0xf bank_mask:0xc
    s_nop 0
    s_nop 0
    v_mfma_f32_16x16x32_bf16 v[54:57], v[66:69], v[80:83], v[54:57]
    s_waitcnt vmcnt(6)
    s_cmpk_le_u32 s81, 426
    s_cbranch_scc1 L_w_29
    s_waitcnt vmcnt(4)
    s_cmpk_le_u32 s80, 426
    s_cbranch_scc0 L_w_29
    s_waitcnt vmcnt(3)
L_w_29:
    s_xor_b32 s68, s69, 0x8c800
    buffer_load_dwordx4 v[112:115], v1, s[8:11], s68 offen nt
    v_mfma_f32_16x16x32_bf16 v[58:61], v[66:69], v[84:87], v[58:61]
    s_waitcnt vmcnt(6)
    s_cmpk_le_u32 s81, 427
    s_cbranch_scc1 L_w_30
    s_waitcnt vmcnt(4)
    s_cmpk_le_u32 s80, 427
    s_cbranch_scc0 L_w_30
    s_waitcnt vmcnt(3)
L_w_30:
    buffer_load_dwordx4 v[116:119], v1, s[8:11], s68 offen offset:256 nt
    v_and_b32_dpp v62, v27, v10 row_newbcast:4 row_mask:0xf bank_mask:0x3
    v_and_b32_dpp v63, v27, v11 row_newbcast:4 row_mask:0xf bank_mask:0x3
    v_and_b32_dpp v64, v27, v12 row_newbcast:4 row_mask:0xf bank_mask:0x3
    v_and_b32_dpp v65, v27, v13 row_newbcast:4 row_mask:0xf bank_mask:0x3
    v_and_b32_dpp v62, v35, v10 row_newbcast:4 row_mask:0xf bank_mask:0xc
    v_and_b32_dpp v63, v35, v11 row_newbcast:4 row_mask:0xf bank_mask:0xc
    v_and_b32_dpp v64, v35, v12 row_newbcast:4 row_mask:0xf bank_mask:0xc
    v_and_b32_dpp v65, v35, v13 row_newbcast:4 row_mask:0xf bank_mask:0xc
    s_nop 0
    s_nop 0
    v_mfma_f32_16x16x32_bf16 v[54:57], v[62:65], v[88:91], v[54:57]
    s_waitcnt vmcnt(6)
    s_cmpk_le_u32 s81, 428
    s_cbranch_scc1 L_w_31
    s_waitcnt vmcnt(4)
    s_cmpk_le_u32 s80, 428
    s_cbranch_scc0 L_w_31
    s_waitcnt vmcnt(3)
L_w_31:
    s_xor_b32 s68, s69, 0x8c200
    buffer_load_dwordx4 v[120:123], v1, s[8:11], s68 offen nt
    v_mfma_f32_16x16x32_bf16 v[58:61], v[62:65], v[92:95], v[58:61]
    s_waitcnt vmcnt(6)
    s_cmpk_le_u32 s81, 429
    s_cbranch_scc1 L_w_32
    s_waitcnt vmcnt(4)
    s_cmpk_le_u32 s80, 429
    s_cbranch_scc0 L_w_32
    s_waitcnt vmcnt(3)
L_w_32:
    buffer_load_dwordx4 v[124:127], v1, s[8:11], s68 offen offset:256 nt
    v_and_b32_dpp v66, v27, v10 row_newbcast:12 row_mask:0xf bank_mask:0x3
    v_and_b32_dpp v67, v27, v11 row_newbcast:12 row_mask:0xf bank_mask:0x3
    v_and_b32_dpp v68, v27, v12 row_newbcast:12 row_mask:0xf bank_mask:0x3
    v_and_b32_dpp v69, v27, v13 row_newbcast:12 row_mask:0xf bank_mask:0x3
    v_and_b32_dpp v66, v35, v10 row_newbcast:12 row_mask:0xf bank_mask:0xc
    v_and_b32_dpp v67, v35, v11 row_newbcast:12 row_mask:0xf bank_mask:0xc
    v_and_b32_dpp v68, v35, v12 row_newbcast:12 row_mask:0xf bank_mask:0xc
    v_and_b32_dpp v69, v35, v13 row_newbcast:12 row_mask:0xf bank_mask:0xc
    s_nop 0
    s_nop 0
    v_mfma_f32_16x16x32_bf16 v[54:57], v[66:69], v[96:99], v[54:57]
    s_waitcnt vmcnt(6)
    s_cmpk_le_u32 s81, 430
    s_cbranch_scc1 L_w_33
    s_waitcnt vmcnt(4)
    s_cmpk_le_u32 s80, 430
    s_cbranch_scc0 L_w_33
    s_waitcnt vmcnt(3)
L_w_33:
    s_xor_b32 s68, s69, 0x8ca00
    buffer_load_dwordx4 v[128:131], v1, s[8:11], s68 offen nt
    v_mfma_f32_16x16x32_bf16 v[58:61], v[66:69], v[100:103], v[58:61]
    s_waitcnt vmcnt(6)
    s_cmpk_le_u32 s81, 431
    s_cbranch_scc1 L_w_34
    s_waitcnt vmcnt(4)
    s_cmpk_le_u32 s80, 431
    s_cbranch_scc0 L_w_34
    s_waitcnt vmcnt(3)
L_w_34:
    buffer_load_dwordx4 v[132:135], v1, s[8:11], s68 offen offset:256 nt
    v_and_b32_dpp v62, v27, v10 row_newbcast:1 row_mask:0xf bank_mask:0x3
    v_and_b32_dpp v63, v27, v11 row_newbcast:1 row_mask:0xf bank_mask:0x3
    v_and_b32_dpp v64, v27, v12 row_newbcast:1 row_mask:0xf bank_mask:0x3
    v_and_b32_dpp v65, v27, v13 row_newbcast:1 row_mask:0xf bank_mask:0x3
    v_and_b32_dpp v62, v35, v10 row_newbcast:1 row_mask:0xf bank_mask:0xc
    v_and_b32_dpp v63, v35, v11 row_newbcast:1 row_mask:0xf bank_mask:0xc
    v_and_b32_dpp v64, v35, v12 row_newbcast:1 row_mask:0xf bank_mask:0xc
    v_and_b32_dpp v65, v35, v13 row_newbcast:1 row_mask:0xf bank_mask:0xc
    s_nop 0
    s_nop 0
    v_mfma_f32_16x16x32_bf16 v[54:57], v[62:65], v[104:107], v[54:57]
    s_waitcnt vmcnt(6)
    s_cmpk_le_u32 s81, 432
    s_cbranch_scc1 L_w_35
    s_waitcnt vmcnt(4)
    s_cmpk_le_u32 s80, 432
    s_cbranch_scc0 L_w_35
    s_waitcnt vmcnt(3)
L_w_35:
    s_xor_b32 s68, s69, 0xc4000
    buffer_load_dwordx4 v[72:75], v1, s[8:11], s68 offen nt
    v_mfma_f32_16x16x32_bf16 v[58:61], v[62:65], v[108:111], v[58:61]
    s_waitcnt vmcnt(6)
    s_cmpk_le_u32 s81, 433
    s_cbranch_scc1 L_w_36
    s_waitcnt vmcnt(4)
    s_cmpk_le_u32 s80, 433
    s_cbranch_scc0 L_w_36
    s_waitcnt vmcnt(3)
L_w_36:
    buffer_load_dwordx4 v[76:79], v1, s[8:11], s68 offen offset:256 nt
    v_and_b32_dpp v66, v27, v10 row_newbcast:9 row_mask:0xf bank_mask:0x3
    v_and_b32_dpp v67, v27, v11 row_newbcast:9 row_mask:0xf bank_mask:0x3
    v_and_b32_dpp v68, v27, v12 row_newbcast:9 row_mask:0xf bank_mask:0x3
    v_and_b32_dpp v69, v27, v13 row_newbcast:9 row_mask:0xf bank_mask:0x3
    v_and_b32_dpp v66, v35, v10 row_newbcast:9 row_mask:0xf bank_mask:0xc
    v_and_b32_dpp v67, v35, v11 row_newbcast:9 row_mask:0xf bank_mask:0xc
    v_and_b32_dpp v68, v35, v12 row_newbcast:9 row_mask:0xf bank_mask:0xc
    v_and_b32_dpp v69, v35, v13 row_newbcast:9 row_mask:0xf bank_mask:0xc
    s_nop 0
    s_nop 0
    v_mfma_f32_16x16x32_bf16 v[54:57], v[66:69], v[112:115], v[54:57]
    s_waitcnt vmcnt(6)
    s_cmpk_le_u32 s81, 434
    s_cbranch_scc1 L_w_37
    s_waitcnt vmcnt(4)
    s_cmpk_le_u32 s80, 434
    s_cbranch_scc0 L_w_37
    s_waitcnt vmcnt(3)
L_w_37:
    s_xor_b32 s68, s69, 0xc4800
    buffer_load_dwordx4 v[80:83], v1, s[8:11], s68 offen nt
    v_mfma_f32_16x16x32_bf16 v[58:61], v[66:69], v[116:119], v[58:61]
    s_waitcnt vmcnt(6)
    s_cmpk_le_u32 s81, 435
    s_cbranch_scc1 L_w_38
    s_waitcnt vmcnt(4)
    s_cmpk_le_u32 s80, 435
    s_cbranch_scc0 L_w_38
    s_waitcnt vmcnt(3)
L_w_38:
    buffer_load_dwordx4 v[84:87], v1, s[8:11], s68 offen offset:256 nt
    v_and_b32_dpp v62, v27, v10 row_newbcast:5 row_mask:0xf bank_mask:0x3
    v_and_b32_dpp v63, v27, v11 row_newbcast:5 row_mask:0xf bank_mask:0x3
    v_and_b32_dpp v64, v27, v12 row_newbcast:5 row_mask:0xf bank_mask:0x3
    v_and_b32_dpp v65, v27, v13 row_newbcast:5 row_mask:0xf bank_mask:0x3
    v_and_b32_dpp v62, v35, v10 row_newbcast:5 row_mask:0xf bank_mask:0xc
    v_and_b32_dpp v63, v35, v11 row_newbcast:5 row_mask:0xf bank_mask:0xc
    v_and_b32_dpp v64, v35, v12 row_newbcast:5 row_mask:0xf bank_mask:0xc
    v_and_b32_dpp v65, v35, v13 row_newbcast:5 row_mask:0xf bank_mask:0xc
    s_nop 0
    s_nop 0
    v_mfma_f32_16x16x32_bf16 v[54:57], v[62:65], v[120:123], v[54:57]
    s_waitcnt vmcnt(6)
    s_cmpk_le_u32 s81, 436
    s_cbranch_scc1 L_w_39
    s_waitcnt vmcnt(4)
    s_cmpk_le_u32 s80, 436
    s_cbranch_scc0 L_w_39
    s_waitcnt vmcnt(3)
L_w_39:
    s_xor_b32 s68, s69, 0xc4200
    buffer_load_dwordx4 v[88:91], v1, s[8:11], s68 offen nt
    v_mfma_f32_16x16x32_bf16 v[58:61], v[62:65], v[124:127], v[58:61]
    s_waitcnt vmcnt(6)
    s_cmpk_le_u32 s81, 437
    s_cbranch_scc1 L_w_40
    s_waitcnt vmcnt(4)
    s_cmpk_le_u32 s80, 437
    s_cbranch_scc0 L_w_40
    s_waitcnt vmcnt(3)
L_w_40:
    buffer_load_dwordx4 v[92:95], v1, s[8:11], s68 offen offset:256 nt
    v_and_b32_dpp v66, v27, v10 row_newbcast:13 row_mask:0xf bank_mask:0x3
    v_and_b32_dpp v67, v27, v11 row_newbcast:13 row_mask:0xf bank_mask:0x3
    v_and_b32_dpp v68, v27, v12 row_newbcast:13 row_mask:0xf bank_mask:0x3
    v_and_b32_dpp v69, v27, v13 row_newbcast:13 row_mask:0xf bank_mask:0x3
    v_and_b32_dpp v66, v35, v10 row_newbcast:13 row_mask:0xf bank_mask:0xc
    v_and_b32_dpp v67, v35, v11 row_newbcast:13 row_mask:0xf bank_mask:0xc
    v_and_b32_dpp v68, v35, v12 row_newbcast:13 row_mask:0xf bank_mask:0xc
    v_and_b32_dpp v69, v35, v13 row_newbcast:13 row_mask:0xf bank_mask:0xc
    s_nop 0
    s_nop 0
    v_mfma_f32_16x16x32_bf16 v[54:57], v[66:69], v[128:131], v[54:57]
    s_waitcnt vmcnt(6)
    s_cmpk_le_u32 s81, 438
    s_cbranch_scc1 L_w_41
    s_waitcnt vmcnt(4)
    s_cmpk_le_u32 s80, 438
    s_cbranch_scc0 L_w_41
    s_waitcnt vmcnt(3)
L_w_41:
    s_xor_b32 s68, s69, 0xc4a00
    buffer_load_dwordx4 v[96:99], v1, s[8:11], s68 offen nt
    v_mfma_f32_16x16x32_bf16 v[58:61], v[66:69], v[132:135], v[58:61]
    s_waitcnt vmcnt(6)
    s_cmpk_le_u32 s81, 439
    s_cbranch_scc1 L_w_42
    s_waitcnt vmcnt(4)
    s_cmpk_le_u32 s80, 439
    s_cbranch_scc0 L_w_42
    s_waitcnt vmcnt(3)
L_w_42:
    buffer_load_dwordx4 v[100:103], v1, s[8:11], s68 offen offset:256 nt
    v_and_b32_dpp v62, v27, v10 row_newbcast:2 row_mask:0xf bank_mask:0x3
    v_and_b32_dpp v63, v27, v11 row_newbcast:2 row_mask:0xf bank_mask:0x3
    v_and_b32_dpp v64, v27, v12 row_newbcast:2 row_mask:0xf bank_mask:0x3
    v_and_b32_dpp v65, v27, v13 row_newbcast:2 row_mask:0xf bank_mask:0x3
    v_and_b32_dpp v62, v35, v10 row_newbcast:2 row_mask:0xf bank_mask:0xc
    v_and_b32_dpp v63, v35, v11 row_newbcast:2 row_mask:0xf bank_mask:0xc
    v_and_b32_dpp v64, v35, v12 row_newbcast:2 row_mask:0xf bank_mask:0xc
    v_and_b32_dpp v65, v35, v13 row_newbcast:2 row_mask:0xf bank_mask:0xc
    s_nop 0
    s_nop 0
    v_mfma_f32_16x16x32_bf16 v[54:57], v[62:65], v[72:75], v[54:57]
    s_waitcnt vmcnt(6)
    s_cmpk_le_u32 s81, 440
    s_cbranch_scc1 L_w_43
    s_waitcnt vmcnt(4)
    s_cmpk_le_u32 s80, 440
    s_cbranch_scc0 L_w_43
    s_waitcnt vmcnt(3)
L_w_43:
    s_xor_b32 s68, s69, 0xcc000
    buffer_load_dwordx4 v[104:107], v1, s[8:11], s68 offen nt
    v_mfma_f32_16x16x32_bf16 v[58:61], v[62:65], v[76:79], v[58:61]
    s_waitcnt vmcnt(6)
    s_cmpk_le_u32 s81, 441
    s_cbranch_scc1 L_w_44
    s_waitcnt vmcnt(4)
    s_cmpk_le_u32 s80, 441
    s_cbranch_scc0 L_w_44
    s_waitcnt vmcnt(3)
L_w_44:
    buffer_load_dwordx4 v[108:111], v1, s[8:11], s68 offen offset:256 nt
    v_and_b32_dpp v66, v27, v10 row_newbcast:10 row_mask:0xf bank_mask:0x3
    v_and_b32_dpp v67, v27, v11 row_newbcast:10 row_mask:0xf bank_mask:0x3
    v_and_b32_dpp v68, v27, v12 row_newbcast:10 row_mask:0xf bank_mask:0x3
    v_and_b32_dpp v69, v27, v13 row_newbcast:10 row_mask:0xf bank_mask:0x3
    v_and_b32_dpp v66, v35, v10 row_newbcast:10 row_mask:0xf bank_mask:0xc
    v_and_b32_dpp v67, v35, v11 row_newbcast:10 row_mask:0xf bank_mask:0xc
    v_and_b32_dpp v68, v35, v12 row_newbcast:10 row_mask:0xf bank_mask:0xc
    v_and_b32_dpp v69, v35, v13 row_newbcast:10 row_mask:0xf bank_mask:0xc
    s_nop 0
    s_nop 0
    v_mfma_f32_16x16x32_bf16 v[54:57], v[66:69], v[80:83], v[54:57]
    s_waitcnt vmcnt(6)
    s_cmpk_le_u32 s81, 442
    s_cbranch_scc1 L_w_45
    s_waitcnt vmcnt(4)
    s_cmpk_le_u32 s80, 442
    s_cbranch_scc0 L_w_45
    s_waitcnt vmcnt(3)
L_w_45:
    s_xor_b32 s68, s69, 0xcc800
    buffer_load_dwordx4 v[112:115], v1, s[8:11], s68 offen nt
    v_mfma_f32_16x16x32_bf16 v[58:61], v[66:69], v[84:87], v[58:61]
    s_waitcnt vmcnt(6)
    s_cmpk_le_u32 s81, 443
    s_cbranch_scc1 L_w_46
    s_waitcnt vmcnt(4)
    s_cmpk_le_u32 s80, 443
    s_cbranch_scc0 L_w_46
    s_waitcnt vmcnt(3)
L_w_46:
    buffer_load_dwordx4 v[116:119], v1, s[8:11], s68 offen offset:256 nt
    v_and_b32_dpp v62, v27, v10 row_newbcast:6 row_mask:0xf bank_mask:0x3
    v_and_b32_dpp v63, v27, v11 row_newbcast:6 row_mask:0xf bank_mask:0x3
    v_and_b32_dpp v64, v27, v12 row_newbcast:6 row_mask:0xf bank_mask:0x3
    v_and_b32_dpp v65, v27, v13 row_newbcast:6 row_mask:0xf bank_mask:0x3
    v_and_b32_dpp v62, v35, v10 row_newbcast:6 row_mask:0xf bank_mask:0xc
    v_and_b32_dpp v63, v35, v11 row_newbcast:6 row_mask:0xf bank_mask:0xc
    v_and_b32_dpp v64, v35, v12 row_newbcast:6 row_mask:0xf bank_mask:0xc
    v_and_b32_dpp v65, v35, v13 row_newbcast:6 row_mask:0xf bank_mask:0xc
    s_nop 0
    s_nop 0
    v_mfma_f32_16x16x32_bf16 v[54:57], v[62:65], v[88:91], v[54:57]
    s_waitcnt vmcnt(6)
    s_cmpk_le_u32 s81, 444
    s_cbranch_scc1 L_w_47
    s_waitcnt vmcnt(4)
    s_cmpk_le_u32 s80, 444
    s_cbranch_scc0 L_w_47
    s_waitcnt vmcnt(3)
L_w_47:
    s_xor_b32 s68, s69, 0xcc200
    buffer_load_dwordx4 v[120:123], v1, s[8:11], s68 offen nt
    v_mfma_f32_16x16x32_bf16 v[58:61], v[62:65], v[92:95], v[58:61]
    s_waitcnt vmcnt(6)
    s_cmpk_le_u32 s81, 445
    s_cbranch_scc1 L_w_48
    s_waitcnt vmcnt(4)
    s_cmpk_le_u32 s80, 445
    s_cbranch_scc0 L_w_48
    s_waitcnt vmcnt(3)
L_w_48:
    buffer_load_dwordx4 v[124:127], v1, s[8:11], s68 offen offset:256 nt
    v_and_b32_dpp v66, v27, v10 row_newbcast:14 row_mask:0xf bank_mask:0x3
    v_and_b32_dpp v67, v27, v11 row_newbcast:14 row_mask:0xf bank_mask:0x3
    v_and_b32_dpp v68, v27, v12 row_newbcast:14 row_mask:0xf bank_mask:0x3
    v_and_b32_dpp v69, v27, v13 row_newbcast:14 row_mask:0xf bank_mask:0x3
    v_and_b32_dpp v66, v35, v10 row_newbcast:14 row_mask:0xf bank_mask:0xc
    v_and_b32_dpp v67, v35, v11 row_newbcast:14 row_mask:0xf bank_mask:0xc
    v_and_b32_dpp v68, v35, v12 row_newbcast:14 row_mask:0xf bank_mask:0xc
    v_and_b32_dpp v69, v35, v13 row_newbcast:14 row_mask:0xf bank_mask:0xc
    s_nop 0
    s_nop 0
    v_mfma_f32_16x16x32_bf16 v[54:57], v[66:69], v[96:99], v[54:57]
    s_waitcnt vmcnt(6)
    s_cmpk_le_u32 s81, 446
    s_cbranch_scc1 L_w_49
    s_waitcnt vmcnt(4)
    s_cmpk_le_u32 s80, 446
    s_cbranch_scc0 L_w_49
    s_waitcnt vmcnt(3)
L_w_49:
    s_xor_b32 s68, s69, 0xcca00
    buffer_load_dwordx4 v[128:131], v1, s[8:11], s68 offen nt
    v_mfma_f32_16x16x32_bf16 v[58:61], v[66:69], v[100:103], v[58:61]
    s_waitcnt vmcnt(6)
    s_cmpk_le_u32 s81, 447
    s_cbranch_scc1 L_w_50
    s_waitcnt vmcnt(4)
    s_cmpk_le_u32 s80, 447
    s_cbranch_scc0 L_w_50
    s_waitcnt vmcnt(3)
L_w_50:
    buffer_load_dwordx4 v[132:135], v1, s[8:11], s68 offen offset:256 nt
    v_and_b32_dpp v62, v27, v10 row_newbcast:3 row_mask:0xf bank_mask:0x3
    v_and_b32_dpp v63, v27, v11 row_newbcast:3 row_mask:0xf bank_mask:0x3
    v_and_b32_dpp v64, v27, v12 row_newbcast:3 row_mask:0xf bank_mask:0x3
    v_and_b32_dpp v65, v27, v13 row_newbcast:3 row_mask:0xf bank_mask:0x3
    v_and_b32_dpp v62, v35, v10 row_newbcast:3 row_mask:0xf bank_mask:0xc
    v_and_b32_dpp v63, v35, v11 row_newbcast:3 row_mask:0xf bank_mask:0xc
    v_and_b32_dpp v64, v35, v12 row_newbcast:3 row_mask:0xf bank_mask:0xc
    v_and_b32_dpp v65, v35, v13 row_newbcast:3 row_mask:0xf bank_mask:0xc
    s_nop 0
    s_nop 0
    v_mfma_f32_16x16x32_bf16 v[54:57], v[62:65], v[104:107], v[54:57]
    s_waitcnt vmcnt(6)
    s_cmpk_le_u32 s81, 448
    s_cbranch_scc1 L_w_51
    s_waitcnt vmcnt(4)
    s_cmpk_le_u32 s80, 448
    s_cbranch_scc0 L_w_51
    s_waitcnt vmcnt(3)
L_w_51:
    s_xor_b32 s68, s69, 0xa0000
    buffer_load_dwordx4 v[72:75], v1, s[8:11], s68 offen nt
    v_mfma_f32_16x16x32_bf16 v[58:61], v[62:65], v[108:111], v[58:61]
    s_waitcnt vmcnt(6)
    s_cmpk_le_u32 s81, 449
    s_cbranch_scc1 L_w_52
    s_waitcnt vmcnt(4)
    s_cmpk_le_u32 s80, 449
    s_cbranch_scc0 L_w_52
    s_waitcnt vmcnt(3)
L_w_52:
    buffer_load_dwordx4 v[76:79], v1, s[8:11], s68 offen offset:256 nt
    v_and_b32_dpp v66, v27, v10 row_newbcast:11 row_mask:0xf bank_mask:0x3
    v_and_b32_dpp v67, v27, v11 row_newbcast:11 row_mask:0xf bank_mask:0x3
    v_and_b32_dpp v68, v27, v12 row_newbcast:11 row_mask:0xf bank_mask:0x3
    v_and_b32_dpp v69, v27, v13 row_newbcast:11 row_mask:0xf bank_mask:0x3
    v_and_b32_dpp v66, v35, v10 row_newbcast:11 row_mask:0xf bank_mask:0xc
    v_and_b32_dpp v67, v35, v11 row_newbcast:11 row_mask:0xf bank_mask:0xc
    v_and_b32_dpp v68, v35, v12 row_newbcast:11 row_mask:0xf bank_mask:0xc
    v_and_b32_dpp v69, v35, v13 row_newbcast:11 row_mask:0xf bank_mask:0xc
    s_nop 0
    s_nop 0
    v_mfma_f32_16x16x32_bf16 v[54:57], v[66:69], v[112:115], v[54:57]
    s_waitcnt vmcnt(6)
    s_cmpk_le_u32 s81, 450
    s_cbranch_scc1 L_w_53
    s_waitcnt vmcnt(4)
    s_cmpk_le_u32 s80, 450
    s_cbranch_scc0 L_w_53
    s_waitcnt vmcnt(3)
L_w_53:
    s_xor_b32 s68, s69, 0xa0800
    buffer_load_dwordx4 v[80:83], v1, s[8:11], s68 offen nt
    v_mfma_f32_16x16x32_bf16 v[58:61], v[66:69], v[116:119], v[58:61]
    s_waitcnt vmcnt(6)
    s_cmpk_le_u32 s81, 451
    s_cbranch_scc1 L_w_54
    s_waitcnt vmcnt(4)
    s_cmpk_le_u32 s80, 451
    s_cbranch_scc0 L_w_54
    s_waitcnt vmcnt(3)
L_w_54:
    buffer_load_dwordx4 v[84:87], v1, s[8:11], s68 offen offset:256 nt
    v_and_b32_dpp v62, v27, v10 row_newbcast:7 row_mask:0xf bank_mask:0x3
    v_and_b32_dpp v63, v27, v11 row_newbcast:7 row_mask:0xf bank_mask:0x3
    v_and_b32_dpp v64, v27, v12 row_newbcast:7 row_mask:0xf bank_mask:0x3
    v_and_b32_dpp v65, v27, v13 row_newbcast:7 row_mask:0xf bank_mask:0x3
    v_and_b32_dpp v62, v35, v10 row_newbcast:7 row_mask:0xf bank_mask:0xc
    v_and_b32_dpp v63, v35, v11 row_newbcast:7 row_mask:0xf bank_mask:0xc
    v_and_b32_dpp v64, v35, v12 row_newbcast:7 row_mask:0xf bank_mask:0xc
    v_and_b32_dpp v65, v35, v13 row_newbcast:7 row_mask:0xf bank_mask:0xc
    s_nop 0
    s_nop 0
    v_mfma_f32_16x16x32_bf16 v[54:57], v[62:65], v[120:123], v[54:57]
    s_waitcnt vmcnt(6)
    s_cmpk_le_u32 s81, 452
    s_cbranch_scc1 L_w_55
    s_waitcnt vmcnt(4)
    s_cmpk_le_u32 s80, 452
    s_cbranch_scc0 L_w_55
    s_waitcnt vmcnt(3)
L_w_55:
    s_xor_b32 s68, s69, 0xa0200
    buffer_load_dwordx4 v[88:91], v1, s[8:11], s68 offen nt
    v_mfma_f32_16x16x32_bf16 v[58:61], v[62:65], v[124:127], v[58:61]
    s_waitcnt vmcnt(6)
    s_cmpk_le_u32 s81, 453
    s_cbranch_scc1 L_w_56
    s_waitcnt vmcnt(4)
    s_cmpk_le_u32 s80, 453
    s_cbranch_scc0 L_w_56
    s_waitcnt vmcnt(3)
L_w_56:
    buffer_load_dwordx4 v[92:95], v1, s[8:11], s68 offen offset:256 nt
    v_and_b32_dpp v66, v27, v10 row_newbcast:15 row_mask:0xf bank_mask:0x3
    v_and_b32_dpp v67, v27, v11 row_newbcast:15 row_mask:0xf bank_mask:0x3
    v_and_b32_dpp v68, v27, v12 row_newbcast:15 row_mask:0xf bank_mask:0x3
    v_and_b32_dpp v69, v27, v13 row_newbcast:15 row_mask:0xf bank_mask:0x3
    v_and_b32_dpp v66, v35, v10 row_newbcast:15 row_mask:0xf bank_mask:0xc
    v_and_b32_dpp v67, v35, v11 row_newbcast:15 row_mask:0xf bank_mask:0xc
    v_and_b32_dpp v68, v35, v12 row_newbcast:15 row_mask:0xf bank_mask:0xc
    v_and_b32_dpp v69, v35, v13 row_newbcast:15 row_mask:0xf bank_mask:0xc
    s_nop 0
    s_nop 0
    v_mfma_f32_16x16x32_bf16 v[54:57], v[66:69], v[128:131], v[54:57]
    s_waitcnt vmcnt(6)
    s_cmpk_le_u32 s81, 454
    s_cbranch_scc1 L_w_57
    s_waitcnt vmcnt(4)
    s_cmpk_le_u32 s80, 454
    s_cbranch_scc0 L_w_57
    s_waitcnt vmcnt(3)
L_w_57:
    s_xor_b32 s68, s69, 0xa0a00
    buffer_load_dwordx4 v[96:99], v1, s[8:11], s68 offen nt
    v_mfma_f32_16x16x32_bf16 v[58:61], v[66:69], v[132:135], v[58:61]
    s_waitcnt vmcnt(6)
    s_cmpk_le_u32 s81, 455
    s_cbranch_scc1 L_w_58
    s_waitcnt vmcnt(4)
    s_cmpk_le_u32 s80, 455
    s_cbranch_scc0 L_w_58
    s_waitcnt vmcnt(3)
L_w_58:
    buffer_load_dwordx4 v[100:103], v1, s[8:11], s68 offen offset:256 nt
    v_and_b32_dpp v62, v28, v10 row_newbcast:0 row_mask:0xf bank_mask:0x3
    v_and_b32_dpp v63, v28, v11 row_newbcast:0 row_mask:0xf bank_mask:0x3
    v_and_b32_dpp v64, v28, v12 row_newbcast:0 row_mask:0xf bank_mask:0x3
    v_and_b32_dpp v65, v28, v13 row_newbcast:0 row_mask:0xf bank_mask:0x3
    v_and_b32_dpp v62, v36, v10 row_newbcast:0 row_mask:0xf bank_mask:0xc
    v_and_b32_dpp v63, v36, v11 row_newbcast:0 row_mask:0xf bank_mask:0xc
    v_and_b32_dpp v64, v36, v12 row_newbcast:0 row_mask:0xf bank_mask:0xc
    v_and_b32_dpp v65, v36, v13 row_newbcast:0 row_mask:0xf bank_mask:0xc
    s_nop 0
    s_nop 0
    v_mfma_f32_16x16x32_bf16 v[54:57], v[62:65], v[72:75], v[54:57]
    s_waitcnt vmcnt(6)
    s_cmpk_le_u32 s81, 456
    s_cbranch_scc1 L_w_59
    s_waitcnt vmcnt(4)
    s_cmpk_le_u32 s80, 456
    s_cbranch_scc0 L_w_59
    s_waitcnt vmcnt(3)
L_w_59:
    s_xor_b32 s68, s69, 0xa8000
    buffer_load_dwordx4 v[104:107], v1, s[8:11], s68 offen nt
    v_mfma_f32_16x16x32_bf16 v[58:61], v[62:65], v[76:79], v[58:61]
    s_waitcnt vmcnt(6)
    s_cmpk_le_u32 s81, 457
    s_cbranch_scc1 L_w_60
    s_waitcnt vmcnt(4)
    s_cmpk_le_u32 s80, 457
    s_cbranch_scc0 L_w_60
    s_waitcnt vmcnt(3)
L_w_60:
    buffer_load_dwordx4 v[108:111], v1, s[8:11], s68 offen offset:256 nt
    v_and_b32_dpp v66, v28, v10 row_newbcast:8 row_mask:0xf bank_mask:0x3
    v_and_b32_dpp v67, v28, v11 row_newbcast:8 row_mask:0xf bank_mask:0x3
    v_and_b32_dpp v68, v28, v12 row_newbcast:8 row_mask:0xf bank_mask:0x3
    v_and_b32_dpp v69, v28, v13 row_newbcast:8 row_mask:0xf bank_mask:0x3
    v_and_b32_dpp v66, v36, v10 row_newbcast:8 row_mask:0xf bank_mask:0xc
    v_and_b32_dpp v67, v36, v11 row_newbcast:8 row_mask:0xf bank_mask:0xc
    v_and_b32_dpp v68, v36, v12 row_newbcast:8 row_mask:0xf bank_mask:0xc
    v_and_b32_dpp v69, v36, v13 row_newbcast:8 row_mask:0xf bank_mask:0xc
    s_nop 0
    s_nop 0
    v_mfma_f32_16x16x32_bf16 v[54:57], v[66:69], v[80:83], v[54:57]
    s_waitcnt vmcnt(6)
    s_cmpk_le_u32 s81, 458
    s_cbranch_scc1 L_w_61
    s_waitcnt vmcnt(4)
    s_cmpk_le_u32 s80, 458
    s_cbranch_scc0 L_w_61
    s_waitcnt vmcnt(3)
L_w_61:
    s_xor_b32 s68, s69, 0xa8800
    buffer_load_dwordx4 v[112:115], v1, s[8:11], s68 offen nt
    v_mfma_f32_16x16x32_bf16 v[58:61], v[66:69], v[84:87], v[58:61]
    s_waitcnt vmcnt(6)
    s_cmpk_le_u32 s81, 459
    s_cbranch_scc1 L_w_62
    s_waitcnt vmcnt(4)
    s_cmpk_le_u32 s80, 459
    s_cbranch_scc0 L_w_62
    s_waitcnt vmcnt(3)
L_w_62:
    buffer_load_dwordx4 v[116:119], v1, s[8:11], s68 offen offset:256 nt
    v_and_b32_dpp v62, v28, v10 row_newbcast:4 row_mask:0xf bank_mask:0x3
    v_and_b32_dpp v63, v28, v11 row_newbcast:4 row_mask:0xf bank_mask:0x3
    v_and_b32_dpp v64, v28, v12 row_newbcast:4 row_mask:0xf bank_mask:0x3
    v_and_b32_dpp v65, v28, v13 row_newbcast:4 row_mask:0xf bank_mask:0x3
    v_and_b32_dpp v62, v36, v10 row_newbcast:4 row_mask:0xf bank_mask:0xc
    v_and_b32_dpp v63, v36, v11 row_newbcast:4 row_mask:0xf bank_mask:0xc
    v_and_b32_dpp v64, v36, v12 row_newbcast:4 row_mask:0xf bank_mask:0xc
    v_and_b32_dpp v65, v36, v13 row_newbcast:4 row_mask:0xf bank_mask:0xc
    s_nop 0
    s_nop 0
    v_mfma_f32_16x16x32_bf16 v[54:57], v[62:65], v[88:91], v[54:57]
    s_waitcnt vmcnt(6)
    s_cmpk_le_u32 s81, 460
    s_cbranch_scc1 L_w_63
    s_waitcnt vmcnt(4)
    s_cmpk_le_u32 s80, 460
    s_cbranch_scc0 L_w_63
    s_waitcnt vmcnt(3)
L_w_63:
    s_xor_b32 s68, s69, 0xa8200
    buffer_load_dwordx4 v[120:123], v1, s[8:11], s68 offen nt
    v_mfma_f32_16x16x32_bf16 v[58:61], v[62:65], v[92:95], v[58:61]
    s_waitcnt vmcnt(6)
    s_cmpk_le_u32 s81, 461
    s_cbranch_scc1 L_w_64
    s_waitcnt vmcnt(4)
    s_cmpk_le_u32 s80, 461
    s_cbranch_scc0 L_w_64
    s_waitcnt vmcnt(3)
L_w_64:
    buffer_load_dwordx4 v[124:127], v1, s[8:11], s68 offen offset:256 nt
    v_and_b32_dpp v66, v28, v10 row_newbcast:12 row_mask:0xf bank_mask:0x3
    v_and_b32_dpp v67, v28, v11 row_newbcast:12 row_mask:0xf bank_mask:0x3
    v_and_b32_dpp v68, v28, v12 row_newbcast:12 row_mask:0xf bank_mask:0x3
    v_and_b32_dpp v69, v28, v13 row_newbcast:12 row_mask:0xf bank_mask:0x3
    v_and_b32_dpp v66, v36, v10 row_newbcast:12 row_mask:0xf bank_mask:0xc
    v_and_b32_dpp v67, v36, v11 row_newbcast:12 row_mask:0xf bank_mask:0xc
    v_and_b32_dpp v68, v36, v12 row_newbcast:12 row_mask:0xf bank_mask:0xc
    v_and_b32_dpp v69, v36, v13 row_newbcast:12 row_mask:0xf bank_mask:0xc
    s_nop 0
    s_nop 0
    v_mfma_f32_16x16x32_bf16 v[54:57], v[66:69], v[96:99], v[54:57]
    s_waitcnt vmcnt(6)
    s_cmpk_le_u32 s81, 462
    s_cbranch_scc1 L_w_65
    s_waitcnt vmcnt(4)
    s_cmpk_le_u32 s80, 462
    s_cbranch_scc0 L_w_65
    s_waitcnt vmcnt(3)
L_w_65:
    s_xor_b32 s68, s69, 0xa8a00
    buffer_load_dwordx4 v[128:131], v1, s[8:11], s68 offen nt
    v_mfma_f32_16x16x32_bf16 v[58:61], v[66:69], v[100:103], v[58:61]
    s_waitcnt vmcnt(6)
    s_cmpk_le_u32 s81, 463
    s_cbranch_scc1 L_w_66
    s_waitcnt vmcnt(4)
    s_cmpk_le_u32 s80, 463
    s_cbranch_scc0 L_w_66
    s_waitcnt vmcnt(3)
L_w_66:
    buffer_load_dwordx4 v[132:135], v1, s[8:11], s68 offen offset:256 nt
    v_and_b32_dpp v62, v28, v10 row_newbcast:1 row_mask:0xf bank_mask:0x3
    v_and_b32_dpp v63, v28, v11 row_newbcast:1 row_mask:0xf bank_mask:0x3
    v_and_b32_dpp v64, v28, v12 row_newbcast:1 row_mask:0xf bank_mask:0x3
    v_and_b32_dpp v65, v28, v13 row_newbcast:1 row_mask:0xf bank_mask:0x3
    v_and_b32_dpp v62, v36, v10 row_newbcast:1 row_mask:0xf bank_mask:0xc
    v_and_b32_dpp v63, v36, v11 row_newbcast:1 row_mask:0xf bank_mask:0xc
    v_and_b32_dpp v64, v36, v12 row_newbcast:1 row_mask:0xf bank_mask:0xc
    v_and_b32_dpp v65, v36, v13 row_newbcast:1 row_mask:0xf bank_mask:0xc
    s_nop 0
    s_nop 0
    v_mfma_f32_16x16x32_bf16 v[54:57], v[62:65], v[104:107], v[54:57]
    s_waitcnt vmcnt(6)
    s_cmpk_le_u32 s81, 464
    s_cbranch_scc1 L_w_67
    s_waitcnt vmcnt(4)
    s_cmpk_le_u32 s80, 464
    s_cbranch_scc0 L_w_67
    s_waitcnt vmcnt(3)
L_w_67:
    s_xor_b32 s68, s69, 0xe0000
    buffer_load_dwordx4 v[72:75], v1, s[8:11], s68 offen nt
    v_mfma_f32_16x16x32_bf16 v[58:61], v[62:65], v[108:111], v[58:61]
    s_waitcnt vmcnt(6)
    s_cmpk_le_u32 s81, 465
    s_cbranch_scc1 L_w_68
    s_waitcnt vmcnt(4)
    s_cmpk_le_u32 s80, 465
    s_cbranch_scc0 L_w_68
    s_waitcnt vmcnt(3)
L_w_68:
    buffer_load_dwordx4 v[76:79], v1, s[8:11], s68 offen offset:256 nt
    v_and_b32_dpp v66, v28, v10 row_newbcast:9 row_mask:0xf bank_mask:0x3
    v_and_b32_dpp v67, v28, v11 row_newbcast:9 row_mask:0xf bank_mask:0x3
    v_and_b32_dpp v68, v28, v12 row_newbcast:9 row_mask:0xf bank_mask:0x3
    v_and_b32_dpp v69, v28, v13 row_newbcast:9 row_mask:0xf bank_mask:0x3
    v_and_b32_dpp v66, v36, v10 row_newbcast:9 row_mask:0xf bank_mask:0xc
    v_and_b32_dpp v67, v36, v11 row_newbcast:9 row_mask:0xf bank_mask:0xc
    v_and_b32_dpp v68, v36, v12 row_newbcast:9 row_mask:0xf bank_mask:0xc
    v_and_b32_dpp v69, v36, v13 row_newbcast:9 row_mask:0xf bank_mask:0xc
    s_nop 0
    s_nop 0
    v_mfma_f32_16x16x32_bf16 v[54:57], v[66:69], v[112:115], v[54:57]
    s_waitcnt vmcnt(6)
    s_cmpk_le_u32 s81, 466
    s_cbranch_scc1 L_w_69
    s_waitcnt vmcnt(4)
    s_cmpk_le_u32 s80, 466
    s_cbranch_scc0 L_w_69
    s_waitcnt vmcnt(3)
L_w_69:
    s_xor_b32 s68, s69, 0xe0800
    buffer_load_dwordx4 v[80:83], v1, s[8:11], s68 offen nt
    v_mfma_f32_16x16x32_bf16 v[58:61], v[66:69], v[116:119], v[58:61]
    s_waitcnt vmcnt(6)
    s_cmpk_le_u32 s81, 467
    s_cbranch_scc1 L_w_70
    s_waitcnt vmcnt(4)
    s_cmpk_le_u32 s80, 467
    s_cbranch_scc0 L_w_70
    s_waitcnt vmcnt(3)
L_w_70:
    buffer_load_dwordx4 v[84:87], v1, s[8:11], s68 offen offset:256 nt
    v_and_b32_dpp v62, v28, v10 row_newbcast:5 row_mask:0xf bank_mask:0x3
    v_and_b32_dpp v63, v28, v11 row_newbcast:5 row_mask:0xf bank_mask:0x3
    v_and_b32_dpp v64, v28, v12 row_newbcast:5 row_mask:0xf bank_mask:0x3
    v_and_b32_dpp v65, v28, v13 row_newbcast:5 row_mask:0xf bank_mask:0x3
    v_and_b32_dpp v62, v36, v10 row_newbcast:5 row_mask:0xf bank_mask:0xc
    v_and_b32_dpp v63, v36, v11 row_newbcast:5 row_mask:0xf bank_mask:0xc
    v_and_b32_dpp v64, v36, v12 row_newbcast:5 row_mask:0xf bank_mask:0xc
    v_and_b32_dpp v65, v36, v13 row_newbcast:5 row_mask:0xf bank_mask:0xc
    s_nop 0
    s_nop 0
    v_mfma_f32_16x16x32_bf16 v[54:57], v[62:65], v[120:123], v[54:57]
    s_waitcnt vmcnt(6)
    s_cmpk_le_u32 s81, 468
    s_cbranch_scc1 L_w_71
    s_waitcnt vmcnt(4)
    s_cmpk_le_u32 s80, 468
    s_cbranch_scc0 L_w_71
    s_waitcnt vmcnt(3)
L_w_71:
    s_xor_b32 s68, s69, 0xe0200
    buffer_load_dwordx4 v[88:91], v1, s[8:11], s68 offen nt
    v_mfma_f32_16x16x32_bf16 v[58:61], v[62:65], v[124:127], v[58:61]
    s_waitcnt vmcnt(6)
    s_cmpk_le_u32 s81, 469
    s_cbranch_scc1 L_w_72
    s_waitcnt vmcnt(4)
    s_cmpk_le_u32 s80, 469
    s_cbranch_scc0 L_w_72
    s_waitcnt vmcnt(3)
L_w_72:
    buffer_load_dwordx4 v[92:95], v1, s[8:11], s68 offen offset:256 nt
    v_and_b32_dpp v66, v28, v10 row_newbcast:13 row_mask:0xf bank_mask:0x3
    v_and_b32_dpp v67, v28, v11 row_newbcast:13 row_mask:0xf bank_mask:0x3
    v_and_b32_dpp v68, v28, v12 row_newbcast:13 row_mask:0xf bank_mask:0x3
    v_and_b32_dpp v69, v28, v13 row_newbcast:13 row_mask:0xf bank_mask:0x3
    v_and_b32_dpp v66, v36, v10 row_newbcast:13 row_mask:0xf bank_mask:0xc
    v_and_b32_dpp v67, v36, v11 row_newbcast:13 row_mask:0xf bank_mask:0xc
    v_and_b32_dpp v68, v36, v12 row_newbcast:13 row_mask:0xf bank_mask:0xc
    v_and_b32_dpp v69, v36, v13 row_newbcast:13 row_mask:0xf bank_mask:0xc
    s_nop 0
    s_nop 0
    v_mfma_f32_16x16x32_bf16 v[54:57], v[66:69], v[128:131], v[54:57]
    s_waitcnt vmcnt(6)
    s_cmpk_le_u32 s81, 470
    s_cbranch_scc1 L_w_73
    s_waitcnt vmcnt(4)
    s_cmpk_le_u32 s80, 470
    s_cbranch_scc0 L_w_73
    s_waitcnt vmcnt(3)
L_w_73:
    s_xor_b32 s68, s69, 0xe0a00
    buffer_load_dwordx4 v[96:99], v1, s[8:11], s68 offen nt
    v_mfma_f32_16x16x32_bf16 v[58:61], v[66:69], v[132:135], v[58:61]
    s_waitcnt vmcnt(6)
    s_cmpk_le_u32 s81, 471
    s_cbranch_scc1 L_w_74
    s_waitcnt vmcnt(4)
    s_cmpk_le_u32 s80, 471
    s_cbranch_scc0 L_w_74
    s_waitcnt vmcnt(3)
L_w_74:
    buffer_load_dwordx4 v[100:103], v1, s[8:11], s68 offen offset:256 nt
    v_and_b32_dpp v62, v28, v10 row_newbcast:2 row_mask:0xf bank_mask:0x3
    v_and_b32_dpp v63, v28, v11 row_newbcast:2 row_mask:0xf bank_mask:0x3
    v_and_b32_dpp v64, v28, v12 row_newbcast:2 row_mask:0xf bank_mask:0x3
    v_and_b32_dpp v65, v28, v13 row_newbcast:2 row_mask:0xf bank_mask:0x3
    v_and_b32_dpp v62, v36, v10 row_newbcast:2 row_mask:0xf bank_mask:0xc
    v_and_b32_dpp v63, v36, v11 row_newbcast:2 row_mask:0xf bank_mask:0xc
    v_and_b32_dpp v64, v36, v12 row_newbcast:2 row_mask:0xf bank_mask:0xc
    v_and_b32_dpp v65, v36, v13 row_newbcast:2 row_mask:0xf bank_mask:0xc
    s_nop 0
    s_nop 0
    v_mfma_f32_16x16x32_bf16 v[54:57], v[62:65], v[72:75], v[54:57]
    s_waitcnt vmcnt(6)
    s_cmpk_le_u32 s81, 472
    s_cbranch_scc1 L_w_75
    s_waitcnt vmcnt(4)
    s_cmpk_le_u32 s80, 472
    s_cbranch_scc0 L_w_75
    s_waitcnt vmcnt(3)
L_w_75:
    s_xor_b32 s68, s69, 0xe8000
    buffer_load_dwordx4 v[104:107], v1, s[8:11], s68 offen nt
    v_mfma_f32_16x16x32_bf16 v[58:61], v[62:65], v[76:79], v[58:61]
    s_waitcnt vmcnt(6)
    s_cmpk_le_u32 s81, 473
    s_cbranch_scc1 L_w_76
    s_waitcnt vmcnt(4)
    s_cmpk_le_u32 s80, 473
    s_cbranch_scc0 L_w_76
    s_waitcnt vmcnt(3)
L_w_76:
    buffer_load_dwordx4 v[108:111], v1, s[8:11], s68 offen offset:256 nt
    v_and_b32_dpp v66, v28, v10 row_newbcast:10 row_mask:0xf bank_mask:0x3
    v_and_b32_dpp v67, v28, v11 row_newbcast:10 row_mask:0xf bank_mask:0x3
    v_and_b32_dpp v68, v28, v12 row_newbcast:10 row_mask:0xf bank_mask:0x3
    v_and_b32_dpp v69, v28, v13 row_newbcast:10 row_mask:0xf bank_mask:0x3
    v_and_b32_dpp v66, v36, v10 row_newbcast:10 row_mask:0xf bank_mask:0xc
    v_and_b32_dpp v67, v36, v11 row_newbcast:10 row_mask:0xf bank_mask:0xc
    v_and_b32_dpp v68, v36, v12 row_newbcast:10 row_mask:0xf bank_mask:0xc
    v_and_b32_dpp v69, v36, v13 row_newbcast:10 row_mask:0xf bank_mask:0xc
    s_nop 0
    s_nop 0
    v_mfma_f32_16x16x32_bf16 v[54:57], v[66:69], v[80:83], v[54:57]
    s_waitcnt vmcnt(6)
    s_cmpk_le_u32 s81, 474
    s_cbranch_scc1 L_w_77
    s_waitcnt vmcnt(4)
    s_cmpk_le_u32 s80, 474
    s_cbranch_scc0 L_w_77
    s_waitcnt vmcnt(3)
L_w_77:
    s_xor_b32 s68, s69, 0xe8800
    buffer_load_dwordx4 v[112:115], v1, s[8:11], s68 offen nt
    v_mfma_f32_16x16x32_bf16 v[58:61], v[66:69], v[84:87], v[58:61]
    s_waitcnt vmcnt(6)
    s_cmpk_le_u32 s81, 475
    s_cbranch_scc1 L_w_78
    s_waitcnt vmcnt(4)
    s_cmpk_le_u32 s80, 475
    s_cbranch_scc0 L_w_78
    s_waitcnt vmcnt(3)
L_w_78:
    buffer_load_dwordx4 v[116:119], v1, s[8:11], s68 offen offset:256 nt
    v_and_b32_dpp v62, v28, v10 row_newbcast:6 row_mask:0xf bank_mask:0x3
    v_and_b32_dpp v63, v28, v11 row_newbcast:6 row_mask:0xf bank_mask:0x3
    v_and_b32_dpp v64, v28, v12 row_newbcast:6 row_mask:0xf bank_mask:0x3
    v_and_b32_dpp v65, v28, v13 row_newbcast:6 row_mask:0xf bank_mask:0x3
    v_and_b32_dpp v62, v36, v10 row_newbcast:6 row_mask:0xf bank_mask:0xc
    v_and_b32_dpp v63, v36, v11 row_newbcast:6 row_mask:0xf bank_mask:0xc
    v_and_b32_dpp v64, v36, v12 row_newbcast:6 row_mask:0xf bank_mask:0xc
    v_and_b32_dpp v65, v36, v13 row_newbcast:6 row_mask:0xf bank_mask:0xc
    s_nop 0
    s_nop 0
    v_mfma_f32_16x16x32_bf16 v[54:57], v[62:65], v[88:91], v[54:57]
    s_waitcnt vmcnt(6)
    s_cmpk_le_u32 s81, 476
    s_cbranch_scc1 L_w_79
    s_waitcnt vmcnt(4)
    s_cmpk_le_u32 s80, 476
    s_cbranch_scc0 L_w_79
    s_waitcnt vmcnt(3)
L_w_79:
    s_xor_b32 s68, s69, 0xe8200
    buffer_load_dwordx4 v[120:123], v1, s[8:11], s68 offen nt
    v_mfma_f32_16x16x32_bf16 v[58:61], v[62:65], v[92:95], v[58:61]
    s_waitcnt vmcnt(6)
    s_cmpk_le_u32 s81, 477
    s_cbranch_scc1 L_w_80
    s_waitcnt vmcnt(4)
    s_cmpk_le_u32 s80, 477
    s_cbranch_scc0 L_w_80
    s_waitcnt vmcnt(3)
L_w_80:
    buffer_load_dwordx4 v[124:127], v1, s[8:11], s68 offen offset:256 nt
    v_and_b32_dpp v66, v28, v10 row_newbcast:14 row_mask:0xf bank_mask:0x3
    v_and_b32_dpp v67, v28, v11 row_newbcast:14 row_mask:0xf bank_mask:0x3
    v_and_b32_dpp v68, v28, v12 row_newbcast:14 row_mask:0xf bank_mask:0x3
    v_and_b32_dpp v69, v28, v13 row_newbcast:14 row_mask:0xf bank_mask:0x3
    v_and_b32_dpp v66, v36, v10 row_newbcast:14 row_mask:0xf bank_mask:0xc
    v_and_b32_dpp v67, v36, v11 row_newbcast:14 row_mask:0xf bank_mask:0xc
    v_and_b32_dpp v68, v36, v12 row_newbcast:14 row_mask:0xf bank_mask:0xc
    v_and_b32_dpp v69, v36, v13 row_newbcast:14 row_mask:0xf bank_mask:0xc
    s_nop 0
    s_nop 0
    v_mfma_f32_16x16x32_bf16 v[54:57], v[66:69], v[96:99], v[54:57]
    s_waitcnt vmcnt(6)
    s_cmpk_le_u32 s81, 478
    s_cbranch_scc1 L_w_81
    s_waitcnt vmcnt(4)
    s_cmpk_le_u32 s80, 478
    s_cbranch_scc0 L_w_81
    s_waitcnt vmcnt(3)
L_w_81:
    s_xor_b32 s68, s69, 0xe8a00
    buffer_load_dwordx4 v[128:131], v1, s[8:11], s68 offen nt
    v_mfma_f32_16x16x32_bf16 v[58:61], v[66:69], v[100:103], v[58:61]
    s_waitcnt vmcnt(6)
    s_cmpk_le_u32 s81, 479
    s_cbranch_scc1 L_w_82
    s_waitcnt vmcnt(4)
    s_cmpk_le_u32 s80, 479
    s_cbranch_scc0 L_w_82
    s_waitcnt vmcnt(3)
L_w_82:
    buffer_load_dwordx4 v[132:135], v1, s[8:11], s68 offen offset:256 nt
    v_and_b32_dpp v62, v28, v10 row_newbcast:3 row_mask:0xf bank_mask:0x3
    v_and_b32_dpp v63, v28, v11 row_newbcast:3 row_mask:0xf bank_mask:0x3
    v_and_b32_dpp v64, v28, v12 row_newbcast:3 row_mask:0xf bank_mask:0x3
    v_and_b32_dpp v65, v28, v13 row_newbcast:3 row_mask:0xf bank_mask:0x3
    v_and_b32_dpp v62, v36, v10 row_newbcast:3 row_mask:0xf bank_mask:0xc
    v_and_b32_dpp v63, v36, v11 row_newbcast:3 row_mask:0xf bank_mask:0xc
    v_and_b32_dpp v64, v36, v12 row_newbcast:3 row_mask:0xf bank_mask:0xc
    v_and_b32_dpp v65, v36, v13 row_newbcast:3 row_mask:0xf bank_mask:0xc
    s_nop 0
    s_nop 0
    v_mfma_f32_16x16x32_bf16 v[54:57], v[62:65], v[104:107], v[54:57]
    s_waitcnt vmcnt(6)
    s_cmpk_le_u32 s81, 480
    s_cbranch_scc1 L_w_83
    s_waitcnt vmcnt(4)
    s_cmpk_le_u32 s80, 480
    s_cbranch_scc0 L_w_83
    s_waitcnt vmcnt(3)
L_w_83:
    s_xor_b32 s68, s69, 0xa4000
    buffer_load_dwordx4 v[72:75], v1, s[8:11], s68 offen nt
    v_mfma_f32_16x16x32_bf16 v[58:61], v[62:65], v[108:111], v[58:61]
    s_waitcnt vmcnt(6)
    s_cmpk_le_u32 s81, 481
    s_cbranch_scc1 L_w_84
    s_waitcnt vmcnt(4)
    s_cmpk_le_u32 s80, 481
    s_cbranch_scc0 L_w_84
    s_waitcnt vmcnt(3)
L_w_84:
    buffer_load_dwordx4 v[76:79], v1, s[8:11], s68 offen offset:256 nt
    v_and_b32_dpp v66, v28, v10 row_newbcast:11 row_mask:0xf bank_mask:0x3
    v_and_b32_dpp v67, v28, v11 row_newbcast:11 row_mask:0xf bank_mask:0x3
    v_and_b32_dpp v68, v28, v12 row_newbcast:11 row_mask:0xf bank_mask:0x3
    v_and_b32_dpp v69, v28, v13 row_newbcast:11 row_mask:0xf bank_mask:0x3
    v_and_b32_dpp v66, v36, v10 row_newbcast:11 row_mask:0xf bank_mask:0xc
    v_and_b32_dpp v67, v36, v11 row_newbcast:11 row_mask:0xf bank_mask:0xc
    v_and_b32_dpp v68, v36, v12 row_newbcast:11 row_mask:0xf bank_mask:0xc
    v_and_b32_dpp v69, v36, v13 row_newbcast:11 row_mask:0xf bank_mask:0xc
    s_nop 0
    s_nop 0
    v_mfma_f32_16x16x32_bf16 v[54:57], v[66:69], v[112:115], v[54:57]
    s_waitcnt vmcnt(6)
    s_cmpk_le_u32 s81, 482
    s_cbranch_scc1 L_w_85
    s_waitcnt vmcnt(4)
    s_cmpk_le_u32 s80, 482
    s_cbranch_scc0 L_w_85
    s_waitcnt vmcnt(3)
L_w_85:
    s_xor_b32 s68, s69, 0xa4800
    buffer_load_dwordx4 v[80:83], v1, s[8:11], s68 offen nt
    v_mfma_f32_16x16x32_bf16 v[58:61], v[66:69], v[116:119], v[58:61]
    s_waitcnt vmcnt(6)
    s_cmpk_le_u32 s81, 483
    s_cbranch_scc1 L_w_86
    s_waitcnt vmcnt(4)
    s_cmpk_le_u32 s80, 483
    s_cbranch_scc0 L_w_86
    s_waitcnt vmcnt(3)
L_w_86:
    buffer_load_dwordx4 v[84:87], v1, s[8:11], s68 offen offset:256 nt
    v_and_b32_dpp v62, v28, v10 row_newbcast:7 row_mask:0xf bank_mask:0x3
    v_and_b32_dpp v63, v28, v11 row_newbcast:7 row_mask:0xf bank_mask:0x3
    v_and_b32_dpp v64, v28, v12 row_newbcast:7 row_mask:0xf bank_mask:0x3
    v_and_b32_dpp v65, v28, v13 row_newbcast:7 row_mask:0xf bank_mask:0x3
    v_and_b32_dpp v62, v36, v10 row_newbcast:7 row_mask:0xf bank_mask:0xc
    v_and_b32_dpp v63, v36, v11 row_newbcast:7 row_mask:0xf bank_mask:0xc
    v_and_b32_dpp v64, v36, v12 row_newbcast:7 row_mask:0xf bank_mask:0xc
    v_and_b32_dpp v65, v36, v13 row_newbcast:7 row_mask:0xf bank_mask:0xc
    s_nop 0
    s_nop 0
    v_mfma_f32_16x16x32_bf16 v[54:57], v[62:65], v[120:123], v[54:57]
    s_waitcnt vmcnt(6)
    s_cmpk_le_u32 s81, 484
    s_cbranch_scc1 L_w_87
    s_waitcnt vmcnt(4)
    s_cmpk_le_u32 s80, 484
    s_cbranch_scc0 L_w_87
    s_waitcnt vmcnt(3)
L_w_87:
    s_xor_b32 s68, s69, 0xa4200
    buffer_load_dwordx4 v[88:91], v1, s[8:11], s68 offen nt
    v_mfma_f32_16x16x32_bf16 v[58:61], v[62:65], v[124:127], v[58:61]
    s_waitcnt vmcnt(6)
    s_cmpk_le_u32 s81, 485
    s_cbranch_scc1 L_w_88
    s_waitcnt vmcnt(4)
    s_cmpk_le_u32 s80, 485
    s_cbranch_scc0 L_w_88
    s_waitcnt vmcnt(3)
L_w_88:
    buffer_load_dwordx4 v[92:95], v1, s[8:11], s68 offen offset:256 nt
    v_and_b32_dpp v66, v28, v10 row_newbcast:15 row_mask:0xf bank_mask:0x3
    v_and_b32_dpp v67, v28, v11 row_newbcast:15 row_mask:0xf bank_mask:0x3
    v_and_b32_dpp v68, v28, v12 row_newbcast:15 row_mask:0xf bank_mask:0x3
    v_and_b32_dpp v69, v28, v13 row_newbcast:15 row_mask:0xf bank_mask:0x3
    v_and_b32_dpp v66, v36, v10 row_newbcast:15 row_mask:0xf bank_mask:0xc
    v_and_b32_dpp v67, v36, v11 row_newbcast:15 row_mask:0xf bank_mask:0xc
    v_and_b32_dpp v68, v36, v12 row_newbcast:15 row_mask:0xf bank_mask:0xc
    v_and_b32_dpp v69, v36, v13 row_newbcast:15 row_mask:0xf bank_mask:0xc
    s_nop 0
    s_nop 0
    v_mfma_f32_16x16x32_bf16 v[54:57], v[66:69], v[128:131], v[54:57]
    s_waitcnt vmcnt(6)
    s_cmpk_le_u32 s81, 486
    s_cbranch_scc1 L_w_89
    s_waitcnt vmcnt(4)
    s_cmpk_le_u32 s80, 486
    s_cbranch_scc0 L_w_89
    s_waitcnt vmcnt(3)
L_w_89:
    s_xor_b32 s68, s69, 0xa4a00
    buffer_load_dwordx4 v[96:99], v1, s[8:11], s68 offen nt
    v_mfma_f32_16x16x32_bf16 v[58:61], v[66:69], v[132:135], v[58:61]
    s_xor_b32 s69, s69, 0xa4000
    buffer_load_dwordx4 v[100:103], v1, s[8:11], s68 offen offset:256 nt
    s_xor_b32 s68, s69, 0x8000
    buffer_load_dwordx4 v[104:107], v1, s[8:11], s68 offen nt
    buffer_load_dwordx4 v[108:111], v1, s[8:11], s68 offen offset:256 nt
    s_xor_b32 s68, s69, 0x8800
    buffer_load_dwordx4 v[112:115], v1, s[8:11], s68 offen nt
    buffer_load_dwordx4 v[116:119], v1, s[8:11], s68 offen offset:256 nt
    s_xor_b32 s68, s69, 0x8200
    buffer_load_dwordx4 v[120:123], v1, s[8:11], s68 offen nt
    buffer_load_dwordx4 v[124:127], v1, s[8:11], s68 offen offset:256 nt
    s_xor_b32 s68, s69, 0x8a00
    buffer_load_dwordx4 v[128:131], v1, s[8:11], s68 offen nt
    v_mov_b32 v25, v29
    v_mov_b32 v33, v37
    v_lshrrev_b32 v2, 4, v0
    v_and_b32 v3, 15, v0
    v_bfe_u32 v4, v0, 1, 2
    v_and_b32 v5, 1, v0
    v_lshl_add_u32 v4, v4, 1, v5
    v_bfe_u32 v5, v0, 4, 1
    v_lshl_add_u32 v4, v4, 1, v5
    v_mul_u32_u24 v40, 80, v4
    v_lshrrev_b32 v4, 5, v0
    v_bfe_u32 v5, v0, 3, 1
    v_lshl_add_u32 v4, v4, 1, v5
    v_lshl_add_u32 v40, v4, 3, v40
    s_mul_i32 s71, s62, 1280
    v_add_u32 v40, s71, v40
    v_and_b32 v4, 3, v0
    v_lshl_add_u32 v4, v4, 2, v2
    v_mul_u32_u24 v41, 80, v4
    v_lshl_add_u32 v41, v5, 5, v41
    v_lshlrev_b32 v4, 2, v4
    v_add_u32 v6, v4, v5
    s_mul_i32 s71, s62, 112
    v_add_u32 v18, s71, v6
    v_lshlrev_b32 v18, 2, v18
    v_add_u32 v18, 5248, v18
    v_lshrrev_b32 v20, 3, v6
    v_lshl_add_u32 v20, v6, 1, v20
    v_lshlrev_b32 v20, 4, v20
    s_lshl_b32 s71, s67, 6
    v_add_u32 v6, s71, v6
    v_lshlrev_b32 v6, 1, v6
    global_load_ushort v14, v6, s[50:51] nt
    global_load_ushort v15, v6, s[50:51] offset:4 nt
    v_and_b32 v4, 7, v0
    v_bfe_u32 v19, v0, 4, 1
    v_lshl_add_u32 v19, v4, 1, v19
    v_lshlrev_b32 v19, 7, v19
    v_lshl_add_u32 v19, v5, 2, v19
    v_lshl_add_u32 v19, v4, 4, v19
    s_lshl_b32 s71, s62, 3
    v_add_u32 v19, s71, v19
    v_lshrrev_b32 v4, 5, v0
    v_lshlrev_b32 v42, 8, v4
    v_lshl_add_u32 v42, v3, 5, v42
    v_and_b32 v5, 16, v0
    v_add_u32 v42, v42, v5
    s_lshl_b32 s71, s62, 9
    v_add_u32 v42, s71, v42
    s_cmp_eq_u32 s62, 3
    s_cselect_b32 s72, 15, 31
    v_and_b32 v5, 31, v0
    v_min_u32 v5, s72, v5
    v_lshlrev_b32 v49, 4, v5
    v_lshl_add_u32 v49, v4, 15, v49
    v_add_u32 v49, s71, v49
    v_lshrrev_b32 v7, 4, v5
    v_and_b32 v8, 1, v5
    v_lshl_add_u32 v7, v7, 1, v8
    v_bfe_u32 v8, v5, 1, 3
    v_lshl_add_u32 v7, v7, 4, v8
    v_lshlrev_b32 v34, 2, v7
    s_cmp_lt_u32 s66, 16
    s_cselect_b32 vcc_lo, -1, 0
    s_cselect_b32 vcc_hi, 0, -1
    v_mov_b32 v7, 0x10000000
    v_cndmask_b32 v7, v49, v7, vcc
    v_cndmask_b32 v8, v43, 0, vcc
    s_bitcmp1_b32 s66, 0
    s_cselect_b64 vcc, -1, 0
    v_cndmask_b32 v26, v7, v49, vcc
    v_cndmask_b32 v27, v49, v7, vcc
    v_cndmask_b32 v28, v8, v43, vcc
    v_cndmask_b32 v29, v43, v8, vcc
    s_lshl_b32 s71, s62, 8
    v_lshlrev_b32 v5, 3, v5
    v_add_u32 v21, s71, v5
    buffer_load_dwordx2 v[52:53], v21, s[28:31], 0 offen nt
    v_lshlrev_b32 v21, 1, v21
    v_and_b32 v5, 3, v0
    v_lshl_add_u32 v5, v5, 2, v2
    v_lshlrev_b32 v17, 1, v5
    s_lshl_b32 s71, s67, 5
    v_add_u32 v5, s71, v17
    global_load_ushort v16, v5, s[54:55] nt
    v_bfe_u32 v4, v0, 2, 1
    v_cmp_eq_u32 vcc, 0, v4
    v_mov_b32 v5, 0xffff
    v_and_b32 v48, 3, v0
    v_cndmask_b32 v44, 0, v5, vcc
    v_cndmask_b32 v45, v5, 0, vcc
    v_mul_u32_u24 v48, 0x5555, v48
    v_lshlrev_b32 v46, 16, v44
    v_lshlrev_b32 v47, 16, v45
    s_cmp_eq_u32 s62, 3
    s_cselect_b32 s78, 0, 0x00ff00ff
    s_cselect_b32 s94, 0xffff, -1
    s_mov_b32 s95, 0x3c000000
    s_cselect_b32 s95, 0x3c800000, s95
    s_bfe_u32 s88, s66, 0x30001
    s_lshl_b32 s79, s65, 16
    s_lshl_b32 s91, s66, 11
    s_add_u32 s91, s91, s79
    s_lshl_b32 s92, s3, 11
    s_add_u32 s92, s92, s79
    s_add_u32 s92, s92, 1048576
    s_add_u32 s91, s91, 65536
    s_lshl_b32 s89, s67, 6
    s_add_u32 s89, s89, s79
    s_add_u32 s89, s89, 1048576
    s_add_u32 s79, s79, 65536
    s_add_u32 s80, s88, 1
    s_and_b32 s80, s80, 7
    s_lshl_b32 s80, s80, 12
    s_add_u32 s80, s80, s79
    s_add_u32 s81, s88, 2
    s_and_b32 s81, s81, 7
    s_lshl_b32 s81, s81, 12
    s_add_u32 s81, s81, s79
    s_add_u32 s82, s88, 3
    s_and_b32 s82, s82, 7
    s_lshl_b32 s82, s82, 12
    s_add_u32 s82, s82, s79
    s_add_u32 s83, s88, 4
    s_and_b32 s83, s83, 7
    s_lshl_b32 s83, s83, 12
    s_add_u32 s83, s83, s79
    s_add_u32 s84, s88, 5
    s_and_b32 s84, s84, 7
    s_lshl_b32 s84, s84, 12
    s_add_u32 s84, s84, s79
    s_add_u32 s85, s88, 6
    s_and_b32 s85, s85, 7
    s_lshl_b32 s85, s85, 12
    s_add_u32 s85, s85, s79
    s_add_u32 s86, s88, 7
    s_and_b32 s86, s86, 7
    s_lshl_b32 s86, s86, 12
    s_add_u32 s86, s86, s79
    s_add_u32 s87, s88, 8
    s_and_b32 s87, s87, 7
    s_lshl_b32 s87, s87, 12
    s_add_u32 s87, s87, s79
    v_lshrrev_b32 v2, 2, v0
    v_and_b32 v3, 3, v0
    v_lshlrev_b32 v3, 4, v3
    v_add_u32 v4, 16, v2
    v_min_u32 v4, 27, v4
    v_lshl_add_u32 v71, v2, 11, v3
    v_lshl_add_u32 v70, v4, 11, v3
    v_mov_b32 v5, 0x10000000
    v_cmp_eq_u32 vcc, s3, v2
    v_and_b32 v7, 1, v0
    v_bfe_u32 v8, v0, 1, 1
    v_cndmask_b32 v71, v71, v5, vcc
    v_cndmask_b32 v36, v43, 0, vcc
    v_cmp_eq_u32 vcc, s3, v4
    v_lshl_add_u32 v7, v7, 4, v8
    s_and_b32 s71, s3, 3
    v_cndmask_b32 v70, v70, v5, vcc
    v_cndmask_b32 v37, v43, 0, vcc
    s_lshl_b32 s71, s71, 1
    s_bfe_u32 s72, s3, 0x10002
    s_lshl_b32 s72, s72, 5
    s_add_u32 s71, s71, s72
    v_add_u32 v35, s71, v7
    v_lshrrev_b32 v7, 4, v0
    v_lshl_add_u32 v35, v35, 2, v7
    v_lshlrev_b32 v35, 2, v35
    s_lshr_b32 s73, s3, 3
    v_and_b32_dpp v62, v25, v10 row_newbcast:0 row_mask:0xf bank_mask:0x3
    v_and_b32_dpp v63, v25, v11 row_newbcast:0 row_mask:0xf bank_mask:0x3
    v_and_b32_dpp v64, v25, v12 row_newbcast:0 row_mask:0xf bank_mask:0x3
    v_and_b32_dpp v65, v25, v13 row_newbcast:0 row_mask:0xf bank_mask:0x3
    v_and_b32_dpp v62, v33, v10 row_newbcast:0 row_mask:0xf bank_mask:0xc
    v_and_b32_dpp v63, v33, v11 row_newbcast:0 row_mask:0xf bank_mask:0xc
    v_and_b32_dpp v64, v33, v12 row_newbcast:0 row_mask:0xf bank_mask:0xc
    v_and_b32_dpp v65, v33, v13 row_newbcast:0 row_mask:0xf bank_mask:0xc
    s_waitcnt vmcnt(14)
    buffer_load_dwordx4 v[132:135], v1, s[8:11], s68 offen offset:256 nt
    v_mfma_f32_16x16x32_bf16 v[54:57], v[62:65], v[72:75], v[54:57]
    s_waitcnt vmcnt(14)
    s_xor_b32 s68, s69, 0x40000
    buffer_load_dwordx4 v[72:75], v1, s[8:11], s68 offen nt
    v_mfma_f32_16x16x32_bf16 v[58:61], v[62:65], v[76:79], v[58:61]
    v_and_b32_dpp v66, v25, v10 row_newbcast:8 row_mask:0xf bank_mask:0x3
    v_and_b32_dpp v67, v25, v11 row_newbcast:8 row_mask:0xf bank_mask:0x3
    v_and_b32_dpp v68, v25, v12 row_newbcast:8 row_mask:0xf bank_mask:0x3
    v_and_b32_dpp v69, v25, v13 row_newbcast:8 row_mask:0xf bank_mask:0x3
    v_and_b32_dpp v66, v33, v10 row_newbcast:8 row_mask:0xf bank_mask:0xc
    v_and_b32_dpp v67, v33, v11 row_newbcast:8 row_mask:0xf bank_mask:0xc
    v_and_b32_dpp v68, v33, v12 row_newbcast:8 row_mask:0xf bank_mask:0xc
    v_and_b32_dpp v69, v33, v13 row_newbcast:8 row_mask:0xf bank_mask:0xc
    s_waitcnt vmcnt(14)
    buffer_load_dwordx4 v[76:79], v1, s[8:11], s68 offen offset:256 nt
    v_mfma_f32_16x16x32_bf16 v[54:57], v[66:69], v[80:83], v[54:57]
    s_waitcnt vmcnt(14)
    s_xor_b32 s68, s69, 0x40800
    buffer_load_dwordx4 v[80:83], v1, s[8:11], s68 offen nt
    v_mfma_f32_16x16x32_bf16 v[58:61], v[66:69], v[84:87], v[58:61]
    v_and_b32_dpp v62, v25, v10 row_newbcast:4 row_mask:0xf bank_mask:0x3
    v_and_b32_dpp v63, v25, v11 row_newbcast:4 row_mask:0xf bank_mask:0x3
    v_and_b32_dpp v64, v25, v12 row_newbcast:4 row_mask:0xf bank_mask:0x3
    v_and_b32_dpp v65, v25, v13 row_newbcast:4 row_mask:0xf bank_mask:0x3
    v_and_b32_dpp v62, v33, v10 row_newbcast:4 row_mask:0xf bank_mask:0xc
    v_and_b32_dpp v63, v33, v11 row_newbcast:4 row_mask:0xf bank_mask:0xc
    v_and_b32_dpp v64, v33, v12 row_newbcast:4 row_mask:0xf bank_mask:0xc
    v_and_b32_dpp v65, v33, v13 row_newbcast:4 row_mask:0xf bank_mask:0xc
    s_waitcnt vmcnt(14)
    buffer_load_dwordx4 v[84:87], v1, s[8:11], s68 offen offset:256 nt
    v_mfma_f32_16x16x32_bf16 v[54:57], v[62:65], v[88:91], v[54:57]
    s_waitcnt vmcnt(14)
    s_xor_b32 s68, s69, 0x40200
    buffer_load_dwordx4 v[88:91], v1, s[8:11], s68 offen nt
    v_mfma_f32_16x16x32_bf16 v[58:61], v[62:65], v[92:95], v[58:61]
    v_and_b32_dpp v66, v25, v10 row_newbcast:12 row_mask:0xf bank_mask:0x3
    v_and_b32_dpp v67, v25, v11 row_newbcast:12 row_mask:0xf bank_mask:0x3
    v_and_b32_dpp v68, v25, v12 row_newbcast:12 row_mask:0xf bank_mask:0x3
    v_and_b32_dpp v69, v25, v13 row_newbcast:12 row_mask:0xf bank_mask:0x3
    v_and_b32_dpp v66, v33, v10 row_newbcast:12 row_mask:0xf bank_mask:0xc
    v_and_b32_dpp v67, v33, v11 row_newbcast:12 row_mask:0xf bank_mask:0xc
    v_and_b32_dpp v68, v33, v12 row_newbcast:12 row_mask:0xf bank_mask:0xc
    v_and_b32_dpp v69, v33, v13 row_newbcast:12 row_mask:0xf bank_mask:0xc
    s_waitcnt vmcnt(14)
    buffer_load_dwordx4 v[92:95], v1, s[8:11], s68 offen offset:256 nt
    v_mfma_f32_16x16x32_bf16 v[54:57], v[66:69], v[96:99], v[54:57]
    s_waitcnt vmcnt(14)
    s_xor_b32 s68, s69, 0x40a00
    buffer_load_dwordx4 v[96:99], v1, s[8:11], s68 offen nt
    v_mfma_f32_16x16x32_bf16 v[58:61], v[66:69], v[100:103], v[58:61]
    v_and_b32_dpp v62, v25, v10 row_newbcast:1 row_mask:0xf bank_mask:0x3
    v_and_b32_dpp v63, v25, v11 row_newbcast:1 row_mask:0xf bank_mask:0x3
    v_and_b32_dpp v64, v25, v12 row_newbcast:1 row_mask:0xf bank_mask:0x3
    v_and_b32_dpp v65, v25, v13 row_newbcast:1 row_mask:0xf bank_mask:0x3
    v_and_b32_dpp v62, v33, v10 row_newbcast:1 row_mask:0xf bank_mask:0xc
    v_and_b32_dpp v63, v33, v11 row_newbcast:1 row_mask:0xf bank_mask:0xc
    v_and_b32_dpp v64, v33, v12 row_newbcast:1 row_mask:0xf bank_mask:0xc
    v_and_b32_dpp v65, v33, v13 row_newbcast:1 row_mask:0xf bank_mask:0xc
    s_waitcnt vmcnt(14)
    buffer_load_dwordx4 v[100:103], v1, s[8:11], s68 offen offset:256 nt
    v_mfma_f32_16x16x32_bf16 v[54:57], v[62:65], v[104:107], v[54:57]
    s_waitcnt vmcnt(14)
    s_xor_b32 s68, s69, 0x48000
    buffer_load_dwordx4 v[104:107], v1, s[8:11], s68 offen nt
    v_mfma_f32_16x16x32_bf16 v[58:61], v[62:65], v[108:111], v[58:61]
    v_and_b32_dpp v66, v25, v10 row_newbcast:9 row_mask:0xf bank_mask:0x3
    v_and_b32_dpp v67, v25, v11 row_newbcast:9 row_mask:0xf bank_mask:0x3
    v_and_b32_dpp v68, v25, v12 row_newbcast:9 row_mask:0xf bank_mask:0x3
    v_and_b32_dpp v69, v25, v13 row_newbcast:9 row_mask:0xf bank_mask:0x3
    v_and_b32_dpp v66, v33, v10 row_newbcast:9 row_mask:0xf bank_mask:0xc
    v_and_b32_dpp v67, v33, v11 row_newbcast:9 row_mask:0xf bank_mask:0xc
    v_and_b32_dpp v68, v33, v12 row_newbcast:9 row_mask:0xf bank_mask:0xc
    v_and_b32_dpp v69, v33, v13 row_newbcast:9 row_mask:0xf bank_mask:0xc
    s_waitcnt vmcnt(14)
    buffer_load_dwordx4 v[108:111], v1, s[8:11], s68 offen offset:256 nt
    v_mfma_f32_16x16x32_bf16 v[54:57], v[66:69], v[112:115], v[54:57]
    s_waitcnt vmcnt(14)
    s_xor_b32 s68, s69, 0x48800
    buffer_load_dwordx4 v[112:115], v1, s[8:11], s68 offen nt
    v_mfma_f32_16x16x32_bf16 v[58:61], v[66:69], v[116:119], v[58:61]
    v_and_b32_dpp v62, v25, v10 row_newbcast:5 row_mask:0xf bank_mask:0x3
    v_and_b32_dpp v63, v25, v11 row_newbcast:5 row_mask:0xf bank_mask:0x3
    v_and_b32_dpp v64, v25, v12 row_newbcast:5 row_mask:0xf bank_mask:0x3
    v_and_b32_dpp v65, v25, v13 row_newbcast:5 row_mask:0xf bank_mask:0x3
    v_and_b32_dpp v62, v33, v10 row_newbcast:5 row_mask:0xf bank_mask:0xc
    v_and_b32_dpp v63, v33, v11 row_newbcast:5 row_mask:0xf bank_mask:0xc
    v_and_b32_dpp v64, v33, v12 row_newbcast:5 row_mask:0xf bank_mask:0xc
    v_and_b32_dpp v65, v33, v13 row_newbcast:5 row_mask:0xf bank_mask:0xc
    s_waitcnt vmcnt(14)
    buffer_load_dwordx4 v[116:119], v1, s[8:11], s68 offen offset:256 nt
    v_mfma_f32_16x16x32_bf16 v[54:57], v[62:65], v[120:123], v[54:57]
    s_waitcnt vmcnt(14)
    s_xor_b32 s68, s69, 0x48200
    buffer_load_dwordx4 v[120:123], v1, s[8:11], s68 offen nt
    v_mfma_f32_16x16x32_bf16 v[58:61], v[62:65], v[124:127], v[58:61]
    v_and_b32_dpp v66, v25, v10 row_newbcast:13 row_mask:0xf bank_mask:0x3
    v_and_b32_dpp v67, v25, v11 row_newbcast:13 row_mask:0xf bank_mask:0x3
    v_and_b32_dpp v68, v25, v12 row_newbcast:13 row_mask:0xf bank_mask:0x3
    v_and_b32_dpp v69, v25, v13 row_newbcast:13 row_mask:0xf bank_mask:0x3
    v_and_b32_dpp v66, v33, v10 row_newbcast:13 row_mask:0xf bank_mask:0xc
    v_and_b32_dpp v67, v33, v11 row_newbcast:13 row_mask:0xf bank_mask:0xc
    v_and_b32_dpp v68, v33, v12 row_newbcast:13 row_mask:0xf bank_mask:0xc
    v_and_b32_dpp v69, v33, v13 row_newbcast:13 row_mask:0xf bank_mask:0xc
    s_waitcnt vmcnt(14)
    buffer_load_dwordx4 v[124:127], v1, s[8:11], s68 offen offset:256 nt
    v_mfma_f32_16x16x32_bf16 v[54:57], v[66:69], v[128:131], v[54:57]
    s_waitcnt vmcnt(14)
    s_xor_b32 s68, s69, 0x48a00
    buffer_load_dwordx4 v[128:131], v1, s[8:11], s68 offen nt
    v_mfma_f32_16x16x32_bf16 v[58:61], v[66:69], v[132:135], v[58:61]
    v_and_b32_dpp v62, v25, v10 row_newbcast:2 row_mask:0xf bank_mask:0x3
    v_and_b32_dpp v63, v25, v11 row_newbcast:2 row_mask:0xf bank_mask:0x3
    v_and_b32_dpp v64, v25, v12 row_newbcast:2 row_mask:0xf bank_mask:0x3
    v_and_b32_dpp v65, v25, v13 row_newbcast:2 row_mask:0xf bank_mask:0x3
    v_and_b32_dpp v62, v33, v10 row_newbcast:2 row_mask:0xf bank_mask:0xc
    v_and_b32_dpp v63, v33, v11 row_newbcast:2 row_mask:0xf bank_mask:0xc
    v_and_b32_dpp v64, v33, v12 row_newbcast:2 row_mask:0xf bank_mask:0xc
    v_and_b32_dpp v65, v33, v13 row_newbcast:2 row_mask:0xf bank_mask:0xc
    s_waitcnt vmcnt(14)
    buffer_load_dwordx4 v[132:135], v1, s[8:11], s68 offen offset:256 nt
    v_mfma_f32_16x16x32_bf16 v[54:57], v[62:65], v[72:75], v[54:57]
    s_waitcnt vmcnt(14)
    v_mfma_f32_16x16x32_bf16 v[58:61], v[62:65], v[76:79], v[58:61]
    v_and_b32_dpp v66, v25, v10 row_newbcast:10 row_mask:0xf bank_mask:0x3
    v_and_b32_dpp v67, v25, v11 row_newbcast:10 row_mask:0xf bank_mask:0x3
    v_and_b32_dpp v68, v25, v12 row_newbcast:10 row_mask:0xf bank_mask:0x3
    v_and_b32_dpp v69, v25, v13 row_newbcast:10 row_mask:0xf bank_mask:0x3
    v_and_b32_dpp v66, v33, v10 row_newbcast:10 row_mask:0xf bank_mask:0xc
    v_and_b32_dpp v67, v33, v11 row_newbcast:10 row_mask:0xf bank_mask:0xc
    v_and_b32_dpp v68, v33, v12 row_newbcast:10 row_mask:0xf bank_mask:0xc
    v_and_b32_dpp v69, v33, v13 row_newbcast:10 row_mask:0xf bank_mask:0xc
    s_waitcnt vmcnt(13)
    s_nop 0
    v_mfma_f32_16x16x32_bf16 v[54:57], v[66:69], v[80:83], v[54:57]
    s_waitcnt vmcnt(12)
    v_mfma_f32_16x16x32_bf16 v[58:61], v[66:69], v[84:87], v[58:61]
    v_and_b32_dpp v62, v25, v10 row_newbcast:6 row_mask:0xf bank_mask:0x3
    v_and_b32_dpp v63, v25, v11 row_newbcast:6 row_mask:0xf bank_mask:0x3
    v_and_b32_dpp v64, v25, v12 row_newbcast:6 row_mask:0xf bank_mask:0x3
    v_and_b32_dpp v65, v25, v13 row_newbcast:6 row_mask:0xf bank_mask:0x3
    v_and_b32_dpp v62, v33, v10 row_newbcast:6 row_mask:0xf bank_mask:0xc
    v_and_b32_dpp v63, v33, v11 row_newbcast:6 row_mask:0xf bank_mask:0xc
    v_and_b32_dpp v64, v33, v12 row_newbcast:6 row_mask:0xf bank_mask:0xc
    v_and_b32_dpp v65, v33, v13 row_newbcast:6 row_mask:0xf bank_mask:0xc
    s_waitcnt vmcnt(11)
    s_nop 0
    v_mfma_f32_16x16x32_bf16 v[54:57], v[62:65], v[88:91], v[54:57]
    s_waitcnt vmcnt(10)
    v_mfma_f32_16x16x32_bf16 v[58:61], v[62:65], v[92:95], v[58:61]
    v_and_b32_dpp v66, v25, v10 row_newbcast:14 row_mask:0xf bank_mask:0x3
    v_and_b32_dpp v67, v25, v11 row_newbcast:14 row_mask:0xf bank_mask:0x3
    v_and_b32_dpp v68, v25, v12 row_newbcast:14 row_mask:0xf bank_mask:0x3
    v_and_b32_dpp v69, v25, v13 row_newbcast:14 row_mask:0xf bank_mask:0x3
    v_and_b32_dpp v66, v33, v10 row_newbcast:14 row_mask:0xf bank_mask:0xc
    v_and_b32_dpp v67, v33, v11 row_newbcast:14 row_mask:0xf bank_mask:0xc
    v_and_b32_dpp v68, v33, v12 row_newbcast:14 row_mask:0xf bank_mask:0xc
    v_and_b32_dpp v69, v33, v13 row_newbcast:14 row_mask:0xf bank_mask:0xc
    s_waitcnt vmcnt(9)
    s_nop 0
    v_mfma_f32_16x16x32_bf16 v[54:57], v[66:69], v[96:99], v[54:57]
    s_waitcnt vmcnt(8)
    v_mfma_f32_16x16x32_bf16 v[58:61], v[66:69], v[100:103], v[58:61]
    v_and_b32_dpp v62, v25, v10 row_newbcast:3 row_mask:0xf bank_mask:0x3
    v_and_b32_dpp v63, v25, v11 row_newbcast:3 row_mask:0xf bank_mask:0x3
    v_and_b32_dpp v64, v25, v12 row_newbcast:3 row_mask:0xf bank_mask:0x3
    v_and_b32_dpp v65, v25, v13 row_newbcast:3 row_mask:0xf bank_mask:0x3
    v_and_b32_dpp v62, v33, v10 row_newbcast:3 row_mask:0xf bank_mask:0xc
    v_and_b32_dpp v63, v33, v11 row_newbcast:3 row_mask:0xf bank_mask:0xc
    v_and_b32_dpp v64, v33, v12 row_newbcast:3 row_mask:0xf bank_mask:0xc
    v_and_b32_dpp v65, v33, v13 row_newbcast:3 row_mask:0xf bank_mask:0xc
    s_waitcnt vmcnt(7)
    s_nop 0
    v_mfma_f32_16x16x32_bf16 v[54:57], v[62:65], v[104:107], v[54:57]
    s_waitcnt vmcnt(6)
    v_mfma_f32_16x16x32_bf16 v[58:61], v[62:65], v[108:111], v[58:61]
    v_and_b32_dpp v66, v25, v10 row_newbcast:11 row_mask:0xf bank_mask:0x3
    v_and_b32_dpp v67, v25, v11 row_newbcast:11 row_mask:0xf bank_mask:0x3
    v_and_b32_dpp v68, v25, v12 row_newbcast:11 row_mask:0xf bank_mask:0x3
    v_and_b32_dpp v69, v25, v13 row_newbcast:11 row_mask:0xf bank_mask:0x3
    v_and_b32_dpp v66, v33, v10 row_newbcast:11 row_mask:0xf bank_mask:0xc
    v_and_b32_dpp v67, v33, v11 row_newbcast:11 row_mask:0xf bank_mask:0xc
    v_and_b32_dpp v68, v33, v12 row_newbcast:11 row_mask:0xf bank_mask:0xc
    v_and_b32_dpp v69, v33, v13 row_newbcast:11 row_mask:0xf bank_mask:0xc
    s_waitcnt vmcnt(5)
    s_nop 0
    v_mfma_f32_16x16x32_bf16 v[54:57], v[66:69], v[112:115], v[54:57]
    s_waitcnt vmcnt(4)
    v_mfma_f32_16x16x32_bf16 v[58:61], v[66:69], v[116:119], v[58:61]
    v_and_b32_dpp v62, v25, v10 row_newbcast:7 row_mask:0xf bank_mask:0x3
    v_and_b32_dpp v63, v25, v11 row_newbcast:7 row_mask:0xf bank_mask:0x3
    v_and_b32_dpp v64, v25, v12 row_newbcast:7 row_mask:0xf bank_mask:0x3
    v_and_b32_dpp v65, v25, v13 row_newbcast:7 row_mask:0xf bank_mask:0x3
    v_and_b32_dpp v62, v33, v10 row_newbcast:7 row_mask:0xf bank_mask:0xc
    v_and_b32_dpp v63, v33, v11 row_newbcast:7 row_mask:0xf bank_mask:0xc
    v_and_b32_dpp v64, v33, v12 row_newbcast:7 row_mask:0xf bank_mask:0xc
    v_and_b32_dpp v65, v33, v13 row_newbcast:7 row_mask:0xf bank_mask:0xc
    s_waitcnt vmcnt(3)
    s_nop 0
    v_mfma_f32_16x16x32_bf16 v[54:57], v[62:65], v[120:123], v[54:57]
    s_waitcnt vmcnt(2)
    v_mfma_f32_16x16x32_bf16 v[58:61], v[62:65], v[124:127], v[58:61]
    v_and_b32_dpp v66, v25, v10 row_newbcast:15 row_mask:0xf bank_mask:0x3
    v_and_b32_dpp v67, v25, v11 row_newbcast:15 row_mask:0xf bank_mask:0x3
    v_and_b32_dpp v68, v25, v12 row_newbcast:15 row_mask:0xf bank_mask:0x3
    v_and_b32_dpp v69, v25, v13 row_newbcast:15 row_mask:0xf bank_mask:0x3
    v_and_b32_dpp v66, v33, v10 row_newbcast:15 row_mask:0xf bank_mask:0xc
    v_and_b32_dpp v67, v33, v11 row_newbcast:15 row_mask:0xf bank_mask:0xc
    v_and_b32_dpp v68, v33, v12 row_newbcast:15 row_mask:0xf bank_mask:0xc
    v_and_b32_dpp v69, v33, v13 row_newbcast:15 row_mask:0xf bank_mask:0xc
    s_waitcnt vmcnt(1)
    s_nop 0
    v_mfma_f32_16x16x32_bf16 v[54:57], v[66:69], v[128:131], v[54:57]
    s_waitcnt vmcnt(0)
    v_mfma_f32_16x16x32_bf16 v[58:61], v[66:69], v[132:135], v[58:61]
    s_nop 7
    v_permlane32_swap_b32 v54, v58
    v_permlane32_swap_b32 v55, v59
    v_permlane32_swap_b32 v56, v60
    v_permlane32_swap_b32 v57, v61
    v_add_f32 v62, v54, v58
    v_add_f32 v64, v55, v59
    v_add_f32 v63, v56, v60
    v_add_f32 v65, v57, v61
    ds_write_b64 v40, v[62:63] offset:0
    ds_write_b64 v40, v[64:65] offset:32
    s_waitcnt lgkmcnt(0)
    s_barrier
    ds_read_b128 v[72:75], v41 offset:0
    ds_read_b128 v[76:79], v41 offset:16
    ds_read_b128 v[80:83], v41 offset:1280
    ds_read_b128 v[84:87], v41 offset:1296
    ds_read_b128 v[88:91], v41 offset:2560
    ds_read_b128 v[92:95], v41 offset:2576
    ds_read_b128 v[96:99], v41 offset:3840
    ds_read_b128 v[100:103], v41 offset:3856
    v_mov_b32 v54, 0
    v_mov_b32 v55, 0
    v_mov_b32 v56, 0
    v_mov_b32 v57, 0
    v_mov_b32 v58, 0
    v_mov_b32 v59, 0
    v_mov_b32 v60, 0
    v_mov_b32 v61, 0
    s_waitcnt lgkmcnt(6)
    v_pk_mul_f32 v[72:73], v[72:73], v[38:39] op_sel_hi:[1,0]
    v_pk_mul_f32 v[74:75], v[74:75], v[38:39] op_sel_hi:[1,0]
    v_pk_mul_f32 v[76:77], v[76:77], v[38:39] op_sel_hi:[1,0]
    v_pk_mul_f32 v[78:79], v[78:79], v[38:39] op_sel_hi:[1,0]
    s_waitcnt lgkmcnt(4)
    v_pk_fma_f32 v[72:73], v[80:81], v[38:39], v[72:73] op_sel:[0,1,0] op_sel_hi:[1,1,1]
    v_pk_fma_f32 v[74:75], v[82:83], v[38:39], v[74:75] op_sel:[0,1,0] op_sel_hi:[1,1,1]
    v_pk_fma_f32 v[76:77], v[84:85], v[38:39], v[76:77] op_sel:[0,1,0] op_sel_hi:[1,1,1]
    v_pk_fma_f32 v[78:79], v[86:87], v[38:39], v[78:79] op_sel:[0,1,0] op_sel_hi:[1,1,1]
    s_waitcnt lgkmcnt(2)
    v_pk_fma_f32 v[72:73], v[88:89], v[50:51], v[72:73] op_sel:[0,0,0] op_sel_hi:[1,0,1]
    v_pk_fma_f32 v[74:75], v[90:91], v[50:51], v[74:75] op_sel:[0,0,0] op_sel_hi:[1,0,1]
    v_pk_fma_f32 v[76:77], v[92:93], v[50:51], v[76:77] op_sel:[0,0,0] op_sel_hi:[1,0,1]
    v_pk_fma_f32 v[78:79], v[94:95], v[50:51], v[78:79] op_sel:[0,0,0] op_sel_hi:[1,0,1]
    s_waitcnt lgkmcnt(0)
    v_pk_fma_f32 v[72:73], v[96:97], v[50:51], v[72:73] op_sel:[0,1,0] op_sel_hi:[1,1,1]
    v_pk_fma_f32 v[74:75], v[98:99], v[50:51], v[74:75] op_sel:[0,1,0] op_sel_hi:[1,1,1]
    v_pk_fma_f32 v[76:77], v[100:101], v[50:51], v[76:77] op_sel:[0,1,0] op_sel_hi:[1,1,1]
    v_pk_fma_f32 v[78:79], v[102:103], v[50:51], v[78:79] op_sel:[0,1,0] op_sel_hi:[1,1,1]
    v_cvt_pk_bf16_f32 v30, v72, v73
    v_cvt_pk_bf16_f32 v31, v74, v75
    v_cvt_pk_bf16_f32 v32, v76, v77
    v_cvt_pk_bf16_f32 v33, v78, v79
    v_and_b32_dpp v62, v30, v44 quad_perm:[0,0,0,0] row_mask:0xf bank_mask:0xf
    v_and_b32_dpp v63, v30, v45 quad_perm:[0,0,0,0] row_mask:0xf bank_mask:0xf
    v_and_b32_dpp v64, v30, v46 quad_perm:[0,0,0,0] row_mask:0xf bank_mask:0xf
    v_and_b32_dpp v65, v30, v47 quad_perm:[0,0,0,0] row_mask:0xf bank_mask:0xf
    v_and_b32_dpp v66, v30, v44 quad_perm:[1,1,1,1] row_mask:0xf bank_mask:0xf
    v_and_b32_dpp v67, v30, v45 quad_perm:[1,1,1,1] row_mask:0xf bank_mask:0xf
    v_smfmac_f32_16x16x64_bf16 v[54:57], v[62:65], a[0:7], v48
    v_and_b32_dpp v68, v30, v46 quad_perm:[1,1,1,1] row_mask:0xf bank_mask:0xf
    v_and_b32_dpp v69, v30, v47 quad_perm:[1,1,1,1] row_mask:0xf bank_mask:0xf
    v_smfmac_f32_16x16x64_bf16 v[58:61], v[62:65], a[8:15], v48
    v_and_b32_dpp v62, v30, v44 quad_perm:[2,2,2,2] row_mask:0xf bank_mask:0xf
    v_and_b32_dpp v63, v30, v45 quad_perm:[2,2,2,2] row_mask:0xf bank_mask:0xf
    v_smfmac_f32_16x16x64_bf16 v[54:57], v[66:69], a[16:23], v48
    v_and_b32_dpp v64, v30, v46 quad_perm:[2,2,2,2] row_mask:0xf bank_mask:0xf
    v_and_b32_dpp v65, v30, v47 quad_perm:[2,2,2,2] row_mask:0xf bank_mask:0xf
    v_smfmac_f32_16x16x64_bf16 v[58:61], v[66:69], a[24:31], v48
    v_and_b32_dpp v66, v30, v44 quad_perm:[3,3,3,3] row_mask:0xf bank_mask:0xf
    v_and_b32_dpp v67, v30, v45 quad_perm:[3,3,3,3] row_mask:0xf bank_mask:0xf
    v_smfmac_f32_16x16x64_bf16 v[54:57], v[62:65], a[32:39], v48
    v_and_b32_dpp v68, v30, v46 quad_perm:[3,3,3,3] row_mask:0xf bank_mask:0xf
    v_and_b32_dpp v69, v30, v47 quad_perm:[3,3,3,3] row_mask:0xf bank_mask:0xf
    v_smfmac_f32_16x16x64_bf16 v[58:61], v[62:65], a[40:47], v48
    v_and_b32_dpp v62, v31, v44 quad_perm:[0,0,0,0] row_mask:0xf bank_mask:0xf
    v_and_b32_dpp v63, v31, v45 quad_perm:[0,0,0,0] row_mask:0xf bank_mask:0xf
    v_smfmac_f32_16x16x64_bf16 v[54:57], v[66:69], a[48:55], v48
    v_and_b32_dpp v64, v31, v46 quad_perm:[0,0,0,0] row_mask:0xf bank_mask:0xf
    v_and_b32_dpp v65, v31, v47 quad_perm:[0,0,0,0] row_mask:0xf bank_mask:0xf
    v_smfmac_f32_16x16x64_bf16 v[58:61], v[66:69], a[56:63], v48
    v_and_b32_dpp v66, v31, v44 quad_perm:[1,1,1,1] row_mask:0xf bank_mask:0xf
    v_and_b32_dpp v67, v31, v45 quad_perm:[1,1,1,1] row_mask:0xf bank_mask:0xf
    v_smfmac_f32_16x16x64_bf16 v[54:57], v[62:65], a[64:71], v48
    v_and_b32_dpp v68, v31, v46 quad_perm:[1,1,1,1] row_mask:0xf bank_mask:0xf
    v_and_b32_dpp v69, v31, v47 quad_perm:[1,1,1,1] row_mask:0xf bank_mask:0xf
    v_smfmac_f32_16x16x64_bf16 v[58:61], v[62:65], a[72:79], v48
    v_and_b32_dpp v62, v31, v44 quad_perm:[2,2,2,2] row_mask:0xf bank_mask:0xf
    v_and_b32_dpp v63, v31, v45 quad_perm:[2,2,2,2] row_mask:0xf bank_mask:0xf
    v_smfmac_f32_16x16x64_bf16 v[54:57], v[66:69], a[80:87], v48
    v_and_b32_dpp v64, v31, v46 quad_perm:[2,2,2,2] row_mask:0xf bank_mask:0xf
    v_and_b32_dpp v65, v31, v47 quad_perm:[2,2,2,2] row_mask:0xf bank_mask:0xf
    v_smfmac_f32_16x16x64_bf16 v[58:61], v[66:69], a[88:95], v48
    v_and_b32_dpp v66, v31, v44 quad_perm:[3,3,3,3] row_mask:0xf bank_mask:0xf
    v_and_b32_dpp v67, v31, v45 quad_perm:[3,3,3,3] row_mask:0xf bank_mask:0xf
    v_smfmac_f32_16x16x64_bf16 v[54:57], v[62:65], a[96:103], v48
    v_and_b32_dpp v68, v31, v46 quad_perm:[3,3,3,3] row_mask:0xf bank_mask:0xf
    v_and_b32_dpp v69, v31, v47 quad_perm:[3,3,3,3] row_mask:0xf bank_mask:0xf
    v_smfmac_f32_16x16x64_bf16 v[58:61], v[62:65], a[104:111], v48
    v_and_b32_dpp v62, v32, v44 quad_perm:[0,0,0,0] row_mask:0xf bank_mask:0xf
    v_and_b32_dpp v63, v32, v45 quad_perm:[0,0,0,0] row_mask:0xf bank_mask:0xf
    v_smfmac_f32_16x16x64_bf16 v[54:57], v[66:69], a[112:119], v48
    v_and_b32_dpp v64, v32, v46 quad_perm:[0,0,0,0] row_mask:0xf bank_mask:0xf
    v_and_b32_dpp v65, v32, v47 quad_perm:[0,0,0,0] row_mask:0xf bank_mask:0xf
    v_smfmac_f32_16x16x64_bf16 v[58:61], v[66:69], a[120:127], v48
    v_and_b32_dpp v66, v32, v44 quad_perm:[1,1,1,1] row_mask:0xf bank_mask:0xf
    v_and_b32_dpp v67, v32, v45 quad_perm:[1,1,1,1] row_mask:0xf bank_mask:0xf
    v_smfmac_f32_16x16x64_bf16 v[54:57], v[62:65], a[128:135], v48
    v_and_b32_dpp v68, v32, v46 quad_perm:[1,1,1,1] row_mask:0xf bank_mask:0xf
    v_and_b32_dpp v69, v32, v47 quad_perm:[1,1,1,1] row_mask:0xf bank_mask:0xf
    v_smfmac_f32_16x16x64_bf16 v[58:61], v[62:65], a[136:143], v48
    v_and_b32_dpp v62, v32, v44 quad_perm:[2,2,2,2] row_mask:0xf bank_mask:0xf
    v_and_b32_dpp v63, v32, v45 quad_perm:[2,2,2,2] row_mask:0xf bank_mask:0xf
    v_smfmac_f32_16x16x64_bf16 v[54:57], v[66:69], a[144:151], v48
    v_and_b32_dpp v64, v32, v46 quad_perm:[2,2,2,2] row_mask:0xf bank_mask:0xf
    v_and_b32_dpp v65, v32, v47 quad_perm:[2,2,2,2] row_mask:0xf bank_mask:0xf
    v_smfmac_f32_16x16x64_bf16 v[58:61], v[66:69], a[152:159], v48
    v_and_b32_dpp v66, v32, v44 quad_perm:[3,3,3,3] row_mask:0xf bank_mask:0xf
    v_and_b32_dpp v67, v32, v45 quad_perm:[3,3,3,3] row_mask:0xf bank_mask:0xf
    v_smfmac_f32_16x16x64_bf16 v[54:57], v[62:65], a[160:167], v48
    v_and_b32_dpp v68, v32, v46 quad_perm:[3,3,3,3] row_mask:0xf bank_mask:0xf
    v_and_b32_dpp v69, v32, v47 quad_perm:[3,3,3,3] row_mask:0xf bank_mask:0xf
    v_smfmac_f32_16x16x64_bf16 v[58:61], v[62:65], a[168:175], v48
    v_and_b32_dpp v62, v33, v44 quad_perm:[0,0,0,0] row_mask:0xf bank_mask:0xf
    v_and_b32_dpp v63, v33, v45 quad_perm:[0,0,0,0] row_mask:0xf bank_mask:0xf
    v_smfmac_f32_16x16x64_bf16 v[54:57], v[66:69], a[176:183], v48
    v_and_b32_dpp v64, v33, v46 quad_perm:[0,0,0,0] row_mask:0xf bank_mask:0xf
    v_and_b32_dpp v65, v33, v47 quad_perm:[0,0,0,0] row_mask:0xf bank_mask:0xf
    v_smfmac_f32_16x16x64_bf16 v[58:61], v[66:69], a[184:191], v48
    v_and_b32_dpp v66, v33, v44 quad_perm:[1,1,1,1] row_mask:0xf bank_mask:0xf
    v_and_b32_dpp v67, v33, v45 quad_perm:[1,1,1,1] row_mask:0xf bank_mask:0xf
    v_smfmac_f32_16x16x64_bf16 v[54:57], v[62:65], a[192:199], v48
    v_and_b32_dpp v68, v33, v46 quad_perm:[1,1,1,1] row_mask:0xf bank_mask:0xf
    v_and_b32_dpp v69, v33, v47 quad_perm:[1,1,1,1] row_mask:0xf bank_mask:0xf
    v_smfmac_f32_16x16x64_bf16 v[58:61], v[62:65], a[200:207], v48
    v_and_b32_dpp v62, v33, v44 quad_perm:[2,2,2,2] row_mask:0xf bank_mask:0xf
    v_and_b32_dpp v63, v33, v45 quad_perm:[2,2,2,2] row_mask:0xf bank_mask:0xf
    v_smfmac_f32_16x16x64_bf16 v[54:57], v[66:69], a[208:215], v48
    v_and_b32_dpp v64, v33, v46 quad_perm:[2,2,2,2] row_mask:0xf bank_mask:0xf
    v_and_b32_dpp v65, v33, v47 quad_perm:[2,2,2,2] row_mask:0xf bank_mask:0xf
    v_smfmac_f32_16x16x64_bf16 v[58:61], v[66:69], a[216:223], v48
    v_and_b32_dpp v66, v33, v44 quad_perm:[3,3,3,3] row_mask:0xf bank_mask:0xf
    v_and_b32_dpp v67, v33, v45 quad_perm:[3,3,3,3] row_mask:0xf bank_mask:0xf
    v_smfmac_f32_16x16x64_bf16 v[54:57], v[62:65], a[224:231], v48
    v_and_b32_dpp v68, v33, v46 quad_perm:[3,3,3,3] row_mask:0xf bank_mask:0xf
    v_and_b32_dpp v69, v33, v47 quad_perm:[3,3,3,3] row_mask:0xf bank_mask:0xf
    v_smfmac_f32_16x16x64_bf16 v[58:61], v[62:65], a[232:239], v48
    s_nop 0
    v_smfmac_f32_16x16x64_bf16 v[54:57], v[66:69], a[240:247], v48
    v_smfmac_f32_16x16x64_bf16 v[58:61], v[66:69], a[248:255], v48
    s_nop 7
    v_permlane32_swap_b32 v54, v58
    v_permlane32_swap_b32 v55, v59
    v_permlane32_swap_b32 v56, v60
    v_permlane32_swap_b32 v57, v61
    v_add_f32_dpp v54, v58, v54 row_ror:8 row_mask:0xf bank_mask:0xf
    v_add_f32_dpp v55, v59, v55 row_ror:8 row_mask:0xf bank_mask:0xf
    v_add_f32_dpp v56, v60, v56 row_ror:8 row_mask:0xf bank_mask:0xf
    v_add_f32_dpp v57, v61, v57 row_ror:8 row_mask:0xf bank_mask:0xf
    v_bfi_b32 v62, s77, v54, v43
    v_bfi_b32 v63, s77, v55, v43
    v_bfi_b32 v64, s77, v56, v43
    v_bfi_b32 v65, s77, v57, v43
    s_mov_b32 exec_lo, 0x00ff00ff
    s_mov_b32 exec_hi, s78
    buffer_store_dwordx4 v[62:65], v42, s[32:35], s91 offen sc1
    s_mov_b64 exec, -1
    s_cmp_ge_u32 s3, 28
    s_cbranch_scc1 L_end
    ds_bpermute_b32 v54, v34, v62
    ds_bpermute_b32 v55, v34, v63
    ds_bpermute_b32 v56, v34, v64
    ds_bpermute_b32 v57, v34, v65
    s_waitcnt vmcnt(0)
    buffer_load_dwordx4 v[72:75], v49, s[32:35], s80 offen sc1
    buffer_load_dwordx4 v[76:79], v49, s[32:35], s80 offen offset:2048 sc1
    buffer_load_dwordx4 v[80:83], v49, s[32:35], s81 offen sc1
    buffer_load_dwordx4 v[84:87], v49, s[32:35], s81 offen offset:2048 sc1
    buffer_load_dwordx4 v[88:91], v49, s[32:35], s82 offen sc1
    buffer_load_dwordx4 v[92:95], v49, s[32:35], s82 offen offset:2048 sc1
    buffer_load_dwordx4 v[96:99], v49, s[32:35], s83 offen sc1
    buffer_load_dwordx4 v[100:103], v49, s[32:35], s83 offen offset:2048 sc1
    buffer_load_dwordx4 v[104:107], v49, s[32:35], s84 offen sc1
    buffer_load_dwordx4 v[108:111], v49, s[32:35], s84 offen offset:2048 sc1
    buffer_load_dwordx4 v[112:115], v49, s[32:35], s85 offen sc1
    buffer_load_dwordx4 v[116:119], v49, s[32:35], s85 offen offset:2048 sc1
    buffer_load_dwordx4 v[120:123], v49, s[32:35], s86 offen sc1
    buffer_load_dwordx4 v[124:127], v49, s[32:35], s86 offen offset:2048 sc1
    buffer_load_dwordx4 v[128:131], v26, s[32:35], s87 offen sc1
    buffer_load_dwordx4 v[132:135], v27, s[32:35], s87 offen offset:2048 sc1
    s_movk_i32 s93, 0xff
    s_mov_b32 s90, 0
    s_waitcnt lgkmcnt(0)
    s_mov_b32 exec_lo, 0
    v_lshlrev_b32 v54, 16, v52
    v_and_b32 v55, s76, v52
    v_lshlrev_b32 v56, 16, v53
    v_and_b32 v57, s76, v53
    s_mov_b32 exec_lo, -1
    v_mov_b32 v38, 0xc0135761
    v_mov_b32 v39, 0xbdd2d3e8
    s_waitcnt vmcnt(14)
    v_xor_b32 v3, v72, v43
    v_xor_b32 v4, v76, v43
    v_bitop3_b32 v3, v3, v74, v43 bitop3:0xf6
    v_bitop3_b32 v4, v4, v78, v43 bitop3:0xf6
    v_bitop3_b32 v3, v3, v4, s77 bitop3:0x54
    v_cmp_ne_u32 vcc, 0, v3
    v_pk_add_f32 v[72:73], v[72:73], v[76:77]
    v_pk_add_f32 v[74:75], v[74:75], v[78:79]
    s_cbranch_vccnz L_g0_0
    v_pk_add_f32 v[54:55], v[54:55], v[72:73]
    v_pk_add_f32 v[56:57], v[56:57], v[74:75]
    s_bitset0_b32 s93, 0
L_g0_0:
    s_waitcnt vmcnt(12)
    v_xor_b32 v3, v80, v43
    v_xor_b32 v4, v84, v43
    v_bitop3_b32 v3, v3, v82, v43 bitop3:0xf6
    v_bitop3_b32 v4, v4, v86, v43 bitop3:0xf6
    v_bitop3_b32 v3, v3, v4, s77 bitop3:0x54
    v_cmp_ne_u32 vcc, 0, v3
    v_pk_add_f32 v[80:81], v[80:81], v[84:85]
    v_pk_add_f32 v[82:83], v[82:83], v[86:87]
    s_cbranch_vccnz L_g0_1
    v_pk_add_f32 v[54:55], v[54:55], v[80:81]
    v_pk_add_f32 v[56:57], v[56:57], v[82:83]
    s_bitset0_b32 s93, 1
L_g0_1:
    s_waitcnt vmcnt(10)
    v_xor_b32 v3, v88, v43
    v_xor_b32 v4, v92, v43
    v_bitop3_b32 v3, v3, v90, v43 bitop3:0xf6
    v_bitop3_b32 v4, v4, v94, v43 bitop3:0xf6
    v_bitop3_b32 v3, v3, v4, s77 bitop3:0x54
    v_cmp_ne_u32 vcc, 0, v3
    v_pk_add_f32 v[88:89], v[88:89], v[92:93]
    v_pk_add_f32 v[90:91], v[90:91], v[94:95]
    s_cbranch_vccnz L_g0_2
    v_pk_add_f32 v[54:55], v[54:55], v[88:89]
    v_pk_add_f32 v[56:57], v[56:57], v[90:91]
    s_bitset0_b32 s93, 2
L_g0_2:
    s_waitcnt vmcnt(8)
    v_xor_b32 v3, v96, v43
    v_xor_b32 v4, v100, v43
    v_bitop3_b32 v3, v3, v98, v43 bitop3:0xf6
    v_bitop3_b32 v4, v4, v102, v43 bitop3:0xf6
    v_bitop3_b32 v3, v3, v4, s77 bitop3:0x54
    v_cmp_ne_u32 vcc, 0, v3
    v_pk_add_f32 v[96:97], v[96:97], v[100:101]
    v_pk_add_f32 v[98:99], v[98:99], v[102:103]
    s_cbranch_vccnz L_g0_3
    v_pk_add_f32 v[54:55], v[54:55], v[96:97]
    v_pk_add_f32 v[56:57], v[56:57], v[98:99]
    s_bitset0_b32 s93, 3
L_g0_3:
    s_waitcnt vmcnt(6)
    v_xor_b32 v3, v104, v43
    v_xor_b32 v4, v108, v43
    v_bitop3_b32 v3, v3, v106, v43 bitop3:0xf6
    v_bitop3_b32 v4, v4, v110, v43 bitop3:0xf6
    v_bitop3_b32 v3, v3, v4, s77 bitop3:0x54
    v_cmp_ne_u32 vcc, 0, v3
    v_pk_add_f32 v[104:105], v[104:105], v[108:109]
    v_pk_add_f32 v[106:107], v[106:107], v[110:111]
    s_cbranch_vccnz L_g0_4
    v_pk_add_f32 v[54:55], v[54:55], v[104:105]
    v_pk_add_f32 v[56:57], v[56:57], v[106:107]
    s_bitset0_b32 s93, 4
L_g0_4:
    s_waitcnt vmcnt(4)
    v_xor_b32 v3, v112, v43
    v_xor_b32 v4, v116, v43
    v_bitop3_b32 v3, v3, v114, v43 bitop3:0xf6
    v_bitop3_b32 v4, v4, v118, v43 bitop3:0xf6
    v_bitop3_b32 v3, v3, v4, s77 bitop3:0x54
    v_cmp_ne_u32 vcc, 0, v3
    v_pk_add_f32 v[112:113], v[112:113], v[116:117]
    v_pk_add_f32 v[114:115], v[114:115], v[118:119]
    s_cbranch_vccnz L_g0_5
    v_pk_add_f32 v[54:55], v[54:55], v[112:113]
    v_pk_add_f32 v[56:57], v[56:57], v[114:115]
    s_bitset0_b32 s93, 5
L_g0_5:
    s_waitcnt vmcnt(2)
    v_xor_b32 v3, v120, v43
    v_xor_b32 v4, v124, v43
    v_bitop3_b32 v3, v3, v122, v43 bitop3:0xf6
    v_bitop3_b32 v4, v4, v126, v43 bitop3:0xf6
    v_bitop3_b32 v3, v3, v4, s77 bitop3:0x54
    v_cmp_ne_u32 vcc, 0, v3
    v_pk_add_f32 v[120:121], v[120:121], v[124:125]
    v_pk_add_f32 v[122:123], v[122:123], v[126:127]
    s_cbranch_vccnz L_g0_6
    v_pk_add_f32 v[54:55], v[54:55], v[120:121]
    v_pk_add_f32 v[56:57], v[56:57], v[122:123]
    s_bitset0_b32 s93, 6
L_g0_6:
    s_waitcnt vmcnt(0)
    v_xor_b32 v3, v128, v28
    v_xor_b32 v4, v132, v29
    v_bitop3_b32 v3, v3, v130, v28 bitop3:0xf6
    v_bitop3_b32 v4, v4, v134, v29 bitop3:0xf6
    v_bitop3_b32 v3, v3, v4, s77 bitop3:0x54
    v_cmp_ne_u32 vcc, 0, v3
    v_pk_add_f32 v[128:129], v[128:129], v[132:133]
    v_pk_add_f32 v[130:131], v[130:131], v[134:135]
    s_cbranch_vccnz L_g0_7
    v_pk_add_f32 v[54:55], v[54:55], v[128:129]
    v_pk_add_f32 v[56:57], v[56:57], v[130:131]
    s_bitset0_b32 s93, 7
L_g0_7:
    s_cmp_eq_u32 s93, 0
    s_cbranch_scc1 L_gdone
    s_bitcmp1_b32 s93, 0
    s_cbranch_scc0 L_g1_0
    buffer_load_dwordx4 v[72:75], v49, s[32:35], s80 offen sc1
    buffer_load_dwordx4 v[76:79], v49, s[32:35], s80 offen offset:2048 sc1
L_g1_0:
    s_bitcmp1_b32 s93, 1
    s_cbranch_scc0 L_g1_1
    buffer_load_dwordx4 v[80:83], v49, s[32:35], s81 offen sc1
    buffer_load_dwordx4 v[84:87], v49, s[32:35], s81 offen offset:2048 sc1
L_g1_1:
    s_bitcmp1_b32 s93, 2
    s_cbranch_scc0 L_g1_2
    buffer_load_dwordx4 v[88:91], v49, s[32:35], s82 offen sc1
    buffer_load_dwordx4 v[92:95], v49, s[32:35], s82 offen offset:2048 sc1
L_g1_2:
    s_bitcmp1_b32 s93, 3
    s_cbranch_scc0 L_g1_3
    buffer_load_dwordx4 v[96:99], v49, s[32:35], s83 offen sc1
    buffer_load_dwordx4 v[100:103], v49, s[32:35], s83 offen offset:2048 sc1
L_g1_3:
    s_bitcmp1_b32 s93, 4
    s_cbranch_scc0 L_g1_4
    buffer_load_dwordx4 v[104:107], v49, s[32:35], s84 offen sc1
    buffer_load_dwordx4 v[108:111], v49, s[32:35], s84 offen offset:2048 sc1
L_g1_4:
    s_bitcmp1_b32 s93, 5
    s_cbranch_scc0 L_g1_5
    buffer_load_dwordx4 v[112:115], v49, s[32:35], s85 offen sc1
    buffer_load_dwordx4 v[116:119], v49, s[32:35], s85 offen offset:2048 sc1
L_g1_5:
    s_bitcmp1_b32 s93, 6
    s_cbranch_scc0 L_g1_6
    buffer_load_dwordx4 v[120:123], v49, s[32:35], s86 offen sc1
    buffer_load_dwordx4 v[124:127], v49, s[32:35], s86 offen offset:2048 sc1
L_g1_6:
    s_bitcmp1_b32 s93, 7
    s_cbranch_scc0 L_g1_7
    buffer_load_dwordx4 v[128:131], v26, s[32:35], s87 offen sc1
    buffer_load_dwordx4 v[132:135], v27, s[32:35], s87 offen offset:2048 sc1
L_g1_7:
L_gtop:
    s_waitcnt vmcnt(0)
    s_bitcmp1_b32 s93, 0
    s_cbranch_scc0 L_gb_0
    v_xor_b32 v3, v72, v43
    v_xor_b32 v4, v76, v43
    v_bitop3_b32 v3, v3, v74, v43 bitop3:0xf6
    v_bitop3_b32 v4, v4, v78, v43 bitop3:0xf6
    v_bitop3_b32 v3, v3, v4, s77 bitop3:0x54
    v_cmp_ne_u32 vcc, 0, v3
    v_pk_add_f32 v[72:73], v[72:73], v[76:77]
    v_pk_add_f32 v[74:75], v[74:75], v[78:79]
    s_cbranch_vccnz L_gf_0
    v_pk_add_f32 v[54:55], v[54:55], v[72:73]
    v_pk_add_f32 v[56:57], v[56:57], v[74:75]
    s_bitset0_b32 s93, 0
L_gb_0:
    s_bitcmp1_b32 s93, 1
    s_cbranch_scc0 L_gb_1
    v_xor_b32 v3, v80, v43
    v_xor_b32 v4, v84, v43
    v_bitop3_b32 v3, v3, v82, v43 bitop3:0xf6
    v_bitop3_b32 v4, v4, v86, v43 bitop3:0xf6
    v_bitop3_b32 v3, v3, v4, s77 bitop3:0x54
    v_cmp_ne_u32 vcc, 0, v3
    v_pk_add_f32 v[80:81], v[80:81], v[84:85]
    v_pk_add_f32 v[82:83], v[82:83], v[86:87]
    s_cbranch_vccnz L_gf_1
    v_pk_add_f32 v[54:55], v[54:55], v[80:81]
    v_pk_add_f32 v[56:57], v[56:57], v[82:83]
    s_bitset0_b32 s93, 1
L_gb_1:
    s_bitcmp1_b32 s93, 2
    s_cbranch_scc0 L_gb_2
    v_xor_b32 v3, v88, v43
    v_xor_b32 v4, v92, v43
    v_bitop3_b32 v3, v3, v90, v43 bitop3:0xf6
    v_bitop3_b32 v4, v4, v94, v43 bitop3:0xf6
    v_bitop3_b32 v3, v3, v4, s77 bitop3:0x54
    v_cmp_ne_u32 vcc, 0, v3
    v_pk_add_f32 v[88:89], v[88:89], v[92:93]
    v_pk_add_f32 v[90:91], v[90:91], v[94:95]
    s_cbranch_vccnz L_gf_2
    v_pk_add_f32 v[54:55], v[54:55], v[88:89]
    v_pk_add_f32 v[56:57], v[56:57], v[90:91]
    s_bitset0_b32 s93, 2
L_gb_2:
    s_bitcmp1_b32 s93, 3
    s_cbranch_scc0 L_gb_3
    v_xor_b32 v3, v96, v43
    v_xor_b32 v4, v100, v43
    v_bitop3_b32 v3, v3, v98, v43 bitop3:0xf6
    v_bitop3_b32 v4, v4, v102, v43 bitop3:0xf6
    v_bitop3_b32 v3, v3, v4, s77 bitop3:0x54
    v_cmp_ne_u32 vcc, 0, v3
    v_pk_add_f32 v[96:97], v[96:97], v[100:101]
    v_pk_add_f32 v[98:99], v[98:99], v[102:103]
    s_cbranch_vccnz L_gf_3
    v_pk_add_f32 v[54:55], v[54:55], v[96:97]
    v_pk_add_f32 v[56:57], v[56:57], v[98:99]
    s_bitset0_b32 s93, 3
L_gb_3:
    s_bitcmp1_b32 s93, 4
    s_cbranch_scc0 L_gb_4
    v_xor_b32 v3, v104, v43
    v_xor_b32 v4, v108, v43
    v_bitop3_b32 v3, v3, v106, v43 bitop3:0xf6
    v_bitop3_b32 v4, v4, v110, v43 bitop3:0xf6
    v_bitop3_b32 v3, v3, v4, s77 bitop3:0x54
    v_cmp_ne_u32 vcc, 0, v3
    v_pk_add_f32 v[104:105], v[104:105], v[108:109]
    v_pk_add_f32 v[106:107], v[106:107], v[110:111]
    s_cbranch_vccnz L_gf_4
    v_pk_add_f32 v[54:55], v[54:55], v[104:105]
    v_pk_add_f32 v[56:57], v[56:57], v[106:107]
    s_bitset0_b32 s93, 4
L_gb_4:
    s_bitcmp1_b32 s93, 5
    s_cbranch_scc0 L_gb_5
    v_xor_b32 v3, v112, v43
    v_xor_b32 v4, v116, v43
    v_bitop3_b32 v3, v3, v114, v43 bitop3:0xf6
    v_bitop3_b32 v4, v4, v118, v43 bitop3:0xf6
    v_bitop3_b32 v3, v3, v4, s77 bitop3:0x54
    v_cmp_ne_u32 vcc, 0, v3
    v_pk_add_f32 v[112:113], v[112:113], v[116:117]
    v_pk_add_f32 v[114:115], v[114:115], v[118:119]
    s_cbranch_vccnz L_gf_5
    v_pk_add_f32 v[54:55], v[54:55], v[112:113]
    v_pk_add_f32 v[56:57], v[56:57], v[114:115]
    s_bitset0_b32 s93, 5
L_gb_5:
    s_bitcmp1_b32 s93, 6
    s_cbranch_scc0 L_gb_6
    v_xor_b32 v3, v120, v43
    v_xor_b32 v4, v124, v43
    v_bitop3_b32 v3, v3, v122, v43 bitop3:0xf6
    v_bitop3_b32 v4, v4, v126, v43 bitop3:0xf6
    v_bitop3_b32 v3, v3, v4, s77 bitop3:0x54
    v_cmp_ne_u32 vcc, 0, v3
    v_pk_add_f32 v[120:121], v[120:121], v[124:125]
    v_pk_add_f32 v[122:123], v[122:123], v[126:127]
    s_cbranch_vccnz L_gf_6
    v_pk_add_f32 v[54:55], v[54:55], v[120:121]
    v_pk_add_f32 v[56:57], v[56:57], v[122:123]
    s_bitset0_b32 s93, 6
L_gb_6:
    s_bitcmp1_b32 s93, 7
    s_cbranch_scc0 L_gb_7
    v_xor_b32 v3, v128, v28
    v_xor_b32 v4, v132, v29
    v_bitop3_b32 v3, v3, v130, v28 bitop3:0xf6
    v_bitop3_b32 v4, v4, v134, v29 bitop3:0xf6
    v_bitop3_b32 v3, v3, v4, s77 bitop3:0x54
    v_cmp_ne_u32 vcc, 0, v3
    v_pk_add_f32 v[128:129], v[128:129], v[132:133]
    v_pk_add_f32 v[130:131], v[130:131], v[134:135]
    s_cbranch_vccnz L_gf_7
    v_pk_add_f32 v[54:55], v[54:55], v[128:129]
    v_pk_add_f32 v[56:57], v[56:57], v[130:131]
    s_bitset0_b32 s93, 7
L_gb_7:
    s_bcnt1_i32_b32 s71, s93
    s_cbranch_scc0 L_gdone
    s_bitcmp1_b32 s93, 7
    s_cbranch_scc1 L_gmany
    s_cmp_eq_u32 s71, 1
    s_cbranch_scc1 L_gone
L_gmany:
    s_add_u32 s90, s90, 1
    s_cmp_lt_u32 s90, 0x40000
    s_cbranch_scc1 L_gtop
    s_branch L_gdone
L_gf_0:
    buffer_load_dwordx4 v[72:75], v49, s[32:35], s80 offen sc1
    buffer_load_dwordx4 v[76:79], v49, s[32:35], s80 offen offset:2048 sc1
    s_branch L_gb_0
L_gf_1:
    buffer_load_dwordx4 v[80:83], v49, s[32:35], s81 offen sc1
    buffer_load_dwordx4 v[84:87], v49, s[32:35], s81 offen offset:2048 sc1
    s_branch L_gb_1
L_gf_2:
    buffer_load_dwordx4 v[88:91], v49, s[32:35], s82 offen sc1
    buffer_load_dwordx4 v[92:95], v49, s[32:35], s82 offen offset:2048 sc1
    s_branch L_gb_2
L_gf_3:
    buffer_load_dwordx4 v[96:99], v49, s[32:35], s83 offen sc1
    buffer_load_dwordx4 v[100:103], v49, s[32:35], s83 offen offset:2048 sc1
    s_branch L_gb_3
L_gf_4:
    buffer_load_dwordx4 v[104:107], v49, s[32:35], s84 offen sc1
    buffer_load_dwordx4 v[108:111], v49, s[32:35], s84 offen offset:2048 sc1
    s_branch L_gb_4
L_gf_5:
    buffer_load_dwordx4 v[112:115], v49, s[32:35], s85 offen sc1
    buffer_load_dwordx4 v[116:119], v49, s[32:35], s85 offen offset:2048 sc1
    s_branch L_gb_5
L_gf_6:
    buffer_load_dwordx4 v[120:123], v49, s[32:35], s86 offen sc1
    buffer_load_dwordx4 v[124:127], v49, s[32:35], s86 offen offset:2048 sc1
    s_branch L_gb_6
L_gf_7:
    buffer_load_dwordx4 v[128:131], v26, s[32:35], s87 offen sc1
    buffer_load_dwordx4 v[132:135], v27, s[32:35], s87 offen offset:2048 sc1
    s_branch L_gb_7
L_gone:
    s_ff1_i32_b32 s72, s93
    s_add_u32 s72, s72, s88
    s_add_u32 s72, s72, 1
    s_and_b32 s72, s72, 7
    s_lshl_b32 s72, s72, 12
    s_add_u32 s72, s72, s79
L_gone1:
    buffer_load_dwordx4 v[72:75], v49, s[32:35], s72 offen sc1
    buffer_load_dwordx4 v[76:79], v49, s[32:35], s72 offen offset:2048 sc1
    s_add_u32 s90, s90, 1
    s_cmp_ge_u32 s90, 0x40000
    s_cbranch_scc1 L_gdone
    s_waitcnt vmcnt(0)
    v_xor_b32 v3, v72, v43
    v_xor_b32 v4, v76, v43
    v_bitop3_b32 v3, v3, v74, v43 bitop3:0xf6
    v_bitop3_b32 v4, v4, v78, v43 bitop3:0xf6
    v_bitop3_b32 v3, v3, v4, s77 bitop3:0x54
    v_cmp_ne_u32 vcc, 0, v3
    v_pk_add_f32 v[72:73], v[72:73], v[76:77]
    v_pk_add_f32 v[74:75], v[74:75], v[78:79]
    s_cbranch_vccnz L_gone1
    v_pk_add_f32 v[54:55], v[54:55], v[72:73]
    v_pk_add_f32 v[56:57], v[56:57], v[74:75]
L_gdone:
    v_mov_b32 v58, v54
    v_mov_b32 v59, v55
    v_mov_b32 v60, v56
    v_mov_b32 v61, v57
    v_mov_b32 v114, 0
    v_mov_b32 v115, 0
    v_permlane32_swap_b32 v58, v54
    v_permlane32_swap_b32 v59, v55
    v_permlane32_swap_b32 v60, v56
    v_permlane32_swap_b32 v61, v57
    v_pk_add_f32 v[54:55], v[54:55], v[58:59]
    v_pk_add_f32 v[56:57], v[56:57], v[60:61]
    s_lshl_b32 s70, s62, 3
    v_readlane_b32 s72, v54, 0
    ds_write_b128 v21, v[54:57] offset:5248
    s_mov_b32 exec_lo, s94
    v_pk_add_f32 v[108:109], v[54:55], s[72:73] op_sel_hi:[1,0] neg_lo:[0,1] neg_hi:[0,1]
    v_pk_add_f32 v[110:111], v[56:57], s[72:73] op_sel_hi:[1,0] neg_lo:[0,1] neg_hi:[0,1]
    v_pk_mul_f32 v[104:105], v[108:109], v[108:109]
    v_pk_add_f32 v[106:107], v[108:109], v[110:111]
    v_pk_fma_f32 v[104:105], v[110:111], v[110:111], v[104:105]
    v_add_f32 v114, v106, v107
    v_add_f32 v115, v104, v105
    s_mov_b32 exec_lo, -1
    v_mov_b32 v2, s70
    v_add_f32_dpp v114, v114, v114 row_ror:8 row_mask:0xf bank_mask:0xf
    v_add_f32_dpp v115, v115, v115 row_ror:8 row_mask:0xf bank_mask:0xf
    v_mov_b32 v3, 0
    v_add_f32_dpp v114, v114, v114 row_ror:4 row_mask:0xf bank_mask:0xf
    v_add_f32_dpp v115, v115, v115 row_ror:4 row_mask:0xf bank_mask:0xf
    v_mov_b32 v54, 0
    v_add_f32_dpp v114, v114, v114 row_ror:2 row_mask:0xf bank_mask:0xf
    v_add_f32_dpp v115, v115, v115 row_ror:2 row_mask:0xf bank_mask:0xf
    v_mov_b32 v55, 0
    v_add_f32_dpp v114, v114, v114 row_ror:1 row_mask:0xf bank_mask:0xf
    v_add_f32_dpp v115, v115, v115 row_ror:1 row_mask:0xf bank_mask:0xf
    v_mov_b32 v56, 0
    v_add_f32_dpp v114, v114, v114 row_bcast:15 row_mask:0x2 bank_mask:0xf
    v_add_f32_dpp v115, v115, v115 row_bcast:15 row_mask:0x2 bank_mask:0xf
    v_mul_f32 v104, s95, v114
    v_mov_b32 v57, 0
    v_fma_f32 v115, -v104, v114, v115
    v_add_f32 v114, s72, v104
    s_mov_b32 exec_lo, 0x10000
    s_mov_b32 exec_hi, 0
    ds_write_b64 v2, v[114:115] offset:7296
    s_mov_b64 exec, -1
    s_waitcnt lgkmcnt(0)
    s_barrier
    ds_read_b128 v[104:107], v3 offset:7296
    ds_read_b128 v[108:111], v3 offset:7312
    ds_read2_b32 v[120:121], v18 offset0:0 offset1:2
    ds_read2_b32 v[122:123], v18 offset0:64 offset1:66
    s_waitcnt lgkmcnt(2)
    v_add_f32 v6, v104, v106
    v_fma_f32 v7, v110, 0.5, v108
    v_add_f32 v8, v105, v107
    v_add_f32 v6, v6, v7
    v_add_f32 v9, v109, v111
    v_mul_f32 v6, 0x3e924925, v6
    v_add_f32 v8, v8, v9
    v_sub_f32 v104, v104, v6
    v_sub_f32 v106, v106, v6
    v_sub_f32 v108, v108, v6
    v_sub_f32 v110, v110, v6
    v_mul_f32 v7, v110, v110
    v_mul_f32 v9, v104, v104
    v_mul_f32 v8, 0x3b124925, v8
    v_fmac_f32 v9, v106, v106
    v_fmac_f32 v8, 0x3e124925, v7
    v_fmac_f32 v9, v108, v108
    s_waitcnt lgkmcnt(0)
    v_pk_add_f32 v[120:121], v[120:121], v[6:7] op_sel_hi:[1,0] neg_lo:[0,1] neg_hi:[0,1]
    v_fmac_f32 v8, 0x3e924925, v9
    v_pk_add_f32 v[122:123], v[122:123], v[6:7] op_sel_hi:[1,0] neg_lo:[0,1] neg_hi:[0,1]
    v_add_f32 v7, 0x3727c5ac, v8
    v_fmac_f32 v8, 0x3727c5ac, v7
    v_rsq_f32 v8, v8
    s_nop 0
    v_pk_mul_f32 v[120:121], v[120:121], v[8:9] op_sel_hi:[1,0]
    v_pk_mul_f32 v[122:123], v[122:123], v[8:9] op_sel_hi:[1,0]
    v_cvt_pk_bf16_f32 v30, v120, v121
    v_cvt_pk_bf16_f32 v31, v122, v123
    s_nop 0
    v_and_b32_dpp v62, v30, v44 quad_perm:[0,0,0,0] row_mask:0xf bank_mask:0xf
    v_and_b32_dpp v63, v30, v45 quad_perm:[0,0,0,0] row_mask:0xf bank_mask:0xf
    v_and_b32_dpp v64, v30, v46 quad_perm:[0,0,0,0] row_mask:0xf bank_mask:0xf
    v_and_b32_dpp v65, v30, v47 quad_perm:[0,0,0,0] row_mask:0xf bank_mask:0xf
    v_and_b32_dpp v66, v30, v44 quad_perm:[1,1,1,1] row_mask:0xf bank_mask:0xf
    v_and_b32_dpp v67, v30, v45 quad_perm:[1,1,1,1] row_mask:0xf bank_mask:0xf
    v_smfmac_f32_16x16x64_bf16 v[54:57], v[62:65], v[136:143], v48
    v_and_b32_dpp v68, v30, v46 quad_perm:[1,1,1,1] row_mask:0xf bank_mask:0xf
    v_and_b32_dpp v69, v30, v47 quad_perm:[1,1,1,1] row_mask:0xf bank_mask:0xf
    v_and_b32_dpp v62, v30, v44 quad_perm:[2,2,2,2] row_mask:0xf bank_mask:0xf
    v_and_b32_dpp v63, v30, v45 quad_perm:[2,2,2,2] row_mask:0xf bank_mask:0xf
    v_smfmac_f32_16x16x64_bf16 v[54:57], v[66:69], v[144:151], v48
    v_and_b32_dpp v64, v30, v46 quad_perm:[2,2,2,2] row_mask:0xf bank_mask:0xf
    v_and_b32_dpp v65, v30, v47 quad_perm:[2,2,2,2] row_mask:0xf bank_mask:0xf
    v_and_b32_dpp v66, v30, v44 quad_perm:[3,3,3,3] row_mask:0xf bank_mask:0xf
    v_and_b32_dpp v67, v30, v45 quad_perm:[3,3,3,3] row_mask:0xf bank_mask:0xf
    v_smfmac_f32_16x16x64_bf16 v[54:57], v[62:65], v[152:159], v48
    v_and_b32_dpp v68, v30, v46 quad_perm:[3,3,3,3] row_mask:0xf bank_mask:0xf
    v_and_b32_dpp v69, v30, v47 quad_perm:[3,3,3,3] row_mask:0xf bank_mask:0xf
    v_and_b32_dpp v62, v31, v44 quad_perm:[0,0,0,0] row_mask:0xf bank_mask:0xf
    v_and_b32_dpp v63, v31, v45 quad_perm:[0,0,0,0] row_mask:0xf bank_mask:0xf
    v_smfmac_f32_16x16x64_bf16 v[54:57], v[66:69], v[160:167], v48
    v_and_b32_dpp v64, v31, v46 quad_perm:[0,0,0,0] row_mask:0xf bank_mask:0xf
    v_and_b32_dpp v65, v31, v47 quad_perm:[0,0,0,0] row_mask:0xf bank_mask:0xf
    v_and_b32_dpp v66, v31, v44 quad_perm:[1,1,1,1] row_mask:0xf bank_mask:0xf
    v_and_b32_dpp v67, v31, v45 quad_perm:[1,1,1,1] row_mask:0xf bank_mask:0xf
    v_smfmac_f32_16x16x64_bf16 v[54:57], v[62:65], v[168:175], v48
    v_and_b32_dpp v68, v31, v46 quad_perm:[1,1,1,1] row_mask:0xf bank_mask:0xf
    v_and_b32_dpp v69, v31, v47 quad_perm:[1,1,1,1] row_mask:0xf bank_mask:0xf
    v_and_b32_dpp v62, v31, v44 quad_perm:[2,2,2,2] row_mask:0xf bank_mask:0xf
    v_and_b32_dpp v63, v31, v45 quad_perm:[2,2,2,2] row_mask:0xf bank_mask:0xf
    v_smfmac_f32_16x16x64_bf16 v[54:57], v[66:69], v[176:183], v48
    v_and_b32_dpp v64, v31, v46 quad_perm:[2,2,2,2] row_mask:0xf bank_mask:0xf
    v_and_b32_dpp v65, v31, v47 quad_perm:[2,2,2,2] row_mask:0xf bank_mask:0xf
    s_nop 1
    v_smfmac_f32_16x16x64_bf16 v[54:57], v[62:65], v[184:191], v48
    v_lshlrev_b32 v14, 16, v14
    v_lshlrev_b32 v15, 16, v15
    s_mov_b32 exec_lo, 0x00ff00ff
    s_mov_b32 exec_hi, 0xff00ff00
    s_nop 3
    ds_write_b32 v19, v54 offset:7424
    ds_write_b32 v19, v55 offset:7456
    ds_write_b32 v19, v56 offset:7488
    ds_write_b32 v19, v57 offset:7520
    s_mov_b64 exec, -1
    s_waitcnt lgkmcnt(0)
    s_barrier
    ds_read_b128 v[104:107], v20 offset:7424
    ds_read_b128 v[108:111], v20 offset:7440
    ds_read_b128 v[112:115], v20 offset:7488
    ds_read_b128 v[116:119], v20 offset:7504
    v_mov_b32 v54, 0
    v_mov_b32 v55, 0
    v_mov_b32 v56, 0
    v_mov_b32 v57, 0
    v_mov_b32 v58, 0
    v_mov_b32 v59, 0
    v_mov_b32 v60, 0
    v_mov_b32 v61, 0
    s_waitcnt lgkmcnt(2)
    v_pk_add_f32 v[104:105], v[104:105], v[106:107]
    v_pk_add_f32 v[108:109], v[108:109], v[110:111]
    v_pk_add_f32 v[104:105], v[104:105], v[108:109]
    v_add_f32 v6, v104, v105
    s_waitcnt lgkmcnt(0)
    v_pk_add_f32 v[112:113], v[112:113], v[114:115]
    v_pk_add_f32 v[116:117], v[116:117], v[118:119]
    v_pk_add_f32 v[112:113], v[112:113], v[116:117]
    v_add_f32 v7, v112, v113
    v_pk_add_f32 v[6:7], v[6:7], v[14:15]
    v_pk_mul_f32 v[8:9], v[6:7], v[6:7]
    v_pk_fma_f32 v[8:9], v[8:9], v[38:39], v[38:39] op_sel:[0,1,0] op_sel_hi:[1,1,0]
    v_pk_mul_f32 v[8:9], v[8:9], v[6:7]
    v_exp_f32 v8, v8
    v_exp_f32 v9, v9
    s_nop 0
    v_add_f32 v8, 1.0, v8
    v_add_f32 v9, 1.0, v9
    v_rcp_f32 v8, v8
    v_rcp_f32 v9, v9
    s_nop 0
    v_pk_mul_f32 v[6:7], v[6:7], v[8:9]
    v_cvt_pk_bf16_f32 v30, v6, v7
    s_nop 1
    v_and_b32_dpp v62, v30, v44 quad_perm:[0,0,0,0] row_mask:0xf bank_mask:0xf
    v_and_b32_dpp v63, v30, v45 quad_perm:[0,0,0,0] row_mask:0xf bank_mask:0xf
    v_and_b32_dpp v64, v30, v46 quad_perm:[0,0,0,0] row_mask:0xf bank_mask:0xf
    v_and_b32_dpp v65, v30, v47 quad_perm:[0,0,0,0] row_mask:0xf bank_mask:0xf
    v_and_b32_dpp v66, v30, v44 quad_perm:[1,1,1,1] row_mask:0xf bank_mask:0xf
    v_and_b32_dpp v67, v30, v45 quad_perm:[1,1,1,1] row_mask:0xf bank_mask:0xf
    v_smfmac_f32_16x16x64_bf16 v[54:57], v[62:65], v[192:199], v48
    v_and_b32_dpp v68, v30, v46 quad_perm:[1,1,1,1] row_mask:0xf bank_mask:0xf
    v_and_b32_dpp v69, v30, v47 quad_perm:[1,1,1,1] row_mask:0xf bank_mask:0xf
    v_smfmac_f32_16x16x64_bf16 v[58:61], v[62:65], v[200:207], v48
    v_and_b32_dpp v62, v30, v44 quad_perm:[2,2,2,2] row_mask:0xf bank_mask:0xf
    v_and_b32_dpp v63, v30, v45 quad_perm:[2,2,2,2] row_mask:0xf bank_mask:0xf
    v_smfmac_f32_16x16x64_bf16 v[54:57], v[66:69], v[208:215], v48
    v_and_b32_dpp v64, v30, v46 quad_perm:[2,2,2,2] row_mask:0xf bank_mask:0xf
    v_and_b32_dpp v65, v30, v47 quad_perm:[2,2,2,2] row_mask:0xf bank_mask:0xf
    v_smfmac_f32_16x16x64_bf16 v[58:61], v[66:69], v[216:223], v48
    v_and_b32_dpp v66, v30, v44 quad_perm:[3,3,3,3] row_mask:0xf bank_mask:0xf
    v_and_b32_dpp v67, v30, v45 quad_perm:[3,3,3,3] row_mask:0xf bank_mask:0xf
    v_smfmac_f32_16x16x64_bf16 v[54:57], v[62:65], v[224:231], v48
    v_and_b32_dpp v68, v30, v46 quad_perm:[3,3,3,3] row_mask:0xf bank_mask:0xf
    v_and_b32_dpp v69, v30, v47 quad_perm:[3,3,3,3] row_mask:0xf bank_mask:0xf
    v_smfmac_f32_16x16x64_bf16 v[58:61], v[62:65], v[232:239], v48
    s_nop 0
    v_smfmac_f32_16x16x64_bf16 v[54:57], v[66:69], v[240:247], v48
    v_smfmac_f32_16x16x64_bf16 v[58:61], v[66:69], v[248:255], v48
    s_nop 7
    v_permlane32_swap_b32 v54, v58
    v_permlane32_swap_b32 v55, v59
    v_permlane32_swap_b32 v56, v60
    v_permlane32_swap_b32 v57, v61
    v_add_f32_dpp v54, v58, v54 row_ror:8 row_mask:0xf bank_mask:0xf
    v_add_f32_dpp v55, v59, v55 row_ror:8 row_mask:0xf bank_mask:0xf
    v_add_f32_dpp v56, v60, v56 row_ror:8 row_mask:0xf bank_mask:0xf
    v_add_f32_dpp v57, v61, v57 row_ror:8 row_mask:0xf bank_mask:0xf
    v_bfi_b32 v62, s77, v54, v43
    v_bfi_b32 v63, s77, v55, v43
    v_bfi_b32 v64, s77, v56, v43
    v_bfi_b32 v65, s77, v57, v43
    s_mov_b32 exec_lo, 0x00ff00ff
    s_mov_b32 exec_hi, s78
    buffer_store_dwordx4 v[62:65], v42, s[32:35], s92 offen sc1
    s_mov_b64 exec, -1
    s_cmp_lg_u32 s62, s73
    s_cbranch_scc1 L_end
    v_lshlrev_b32 v7, 4, v0
    ds_write_b128 v7, v[62:65] offset:0
    ds_read_b32 v114, v35 offset:0
    s_lshl_b32 s71, s3, 5
    v_add_lshl_u32 v7, s71, v17, 1
    ds_read_b32 v113, v7 offset:5248
    v_lshlrev_b32 v112, 16, v16
    s_mul_i32 s70, s65, 896
    s_add_u32 s70, s70, s71
    s_mov_b32 s28, s56
    s_and_b32 s29, s57, 0xffff
    s_mov_b32 s30, 7168
    s_mov_b32 s31, 0x20000
    s_mov_b32 s90, 0
    s_waitcnt lgkmcnt(0)
    v_add_f32 v112, v112, v114
    v_add_f32 v112, v112, v113
    s_waitcnt vmcnt(0)
L_fpoll:
    buffer_load_dwordx4 v[104:107], v71, s[32:35], s89 offen sc1
    buffer_load_dwordx4 v[108:111], v70, s[32:35], s89 offen sc1
    s_add_u32 s90, s90, 1
    s_cmp_ge_u32 s90, 0x40000
    s_cbranch_scc1 L_fdone
L_fchk:
    s_waitcnt vmcnt(0)
    v_xor_b32 v3, v104, v36
    v_xor_b32 v4, v108, v37
    v_bitop3_b32 v3, v3, v106, v36 bitop3:0xf6
    v_bitop3_b32 v4, v4, v110, v37 bitop3:0xf6
    v_bitop3_b32 v3, v3, v4, s77 bitop3:0x54
    v_cmp_ne_u32 vcc, 0, v3
    s_mov_b32 exec_hi, 0xffff
    v_pk_add_f32 v[104:105], v[104:105], v[108:109]
    v_pk_add_f32 v[106:107], v[106:107], v[110:111]
    s_mov_b32 exec_hi, -1
    s_cbranch_vccnz L_fpoll
L_fdone:
    v_permlane16_swap_b32 v104, v105
    v_permlane16_swap_b32 v106, v107
    v_add_f32 v104, v104, v105
    v_add_f32 v106, v106, v107
    s_nop 1
    v_permlane32_swap_b32 v104, v106
    v_add_f32 v104, v104, v106
    s_nop 1
    v_add_f32_dpp v104, v104, v104 row_ror:4 row_mask:0xf bank_mask:0xf
    s_nop 1
    v_add_f32_dpp v104, v104, v104 row_ror:8 row_mask:0xf bank_mask:0xf
    v_add_f32 v104, v104, v112
    s_mov_b32 exec_lo, 0x000f000f
    v_cvt_pk_bf16_f32 v104, v104, v104
    s_mov_b32 exec_hi, 0x000f000f
    buffer_store_short v104, v17, s[28:31], s70 offen
    s_cmp_lg_u32 s3, 0
    s_cbranch_scc1 L_end
    s_lshl_b32 s71, s65, 7
    v_mov_b32 v7, s74
    s_mov_b64 exec, 1
    buffer_store_dword v7, v17, s[32:35], s71 offen
L_end:
    s_endpgm
.section .rodata,"a"
.p2align 6
.amdhsa_kernel sequential_preLN__mha_block_cached__mixer_channel_mlp__decode_kernel
  .amdhsa_next_free_vgpr 512
  .amdhsa_next_free_sgpr 102
  .amdhsa_accum_offset 256
  .amdhsa_group_segment_fixed_size 0
  .amdhsa_kernarg_size 104
  .amdhsa_user_sgpr_count 2
  .amdhsa_user_sgpr_kernarg_segment_ptr 1
  .amdhsa_system_sgpr_workgroup_id_x 1
  .amdhsa_float_denorm_mode_32 3
.end_amdhsa_kernel
```
